```python
import torch

def _softmax(x, axis=-1):
    return torch.softmax(x, dim=axis)
def _gelu(x):
    return torch.nn.functional.gelu(x, approximate="tanh")
def _silu(x):
    return torch.nn.functional.silu(x)
def _sigmoid(x):
    return torch.sigmoid(x)
def _layernorm(x, axis=-1, eps=1e-5):
    m = x.mean(dim=axis, keepdim=True)
    v = x.var(dim=axis, keepdim=True, unbiased=False)
    return (x - m) / torch.sqrt(v + eps)
def _scatter_add(tgt, idx, src, axis=0):
    return tgt.clone().index_add_(axis, idx, src)
def _segment_sum(src, seg, n):
    out = torch.zeros((n,) + src.shape[1:], dtype=src.dtype)
    return out.index_add_(0, seg, src)
def _pad(x, pw):
    flat = tuple(v for pair in reversed(pw) for v in pair)
    return torch.nn.functional.pad(x, flat)

kernel_name = 'interleave_layers__sliding_local_dilated__dense_activation_relu__prompt'

def setup_inputs():

    _w = (lambda a: (lambda t: t.to(torch.bfloat16) if t.is_floating_point() else t)(torch.as_tensor(a)))
    def _A_setup():
        B, S, D = 1, 2048, 640
        return {
            "x": _w((lambda *s: torch.randn(*s, dtype=torch.bfloat16) * 0.05)(B, S, D)),
            "wqkv": _w((lambda *s: torch.randn(*s, dtype=torch.bfloat16) * 0.05)(D, 3 * D)),
            "wo": _w((lambda *s: torch.randn(*s, dtype=torch.bfloat16) * 0.05)(D, D)),
        }
    _A_in = _A_setup()

    def _B_setup():
        B, S, D, Dff = 1, 2048, 640, 1728
        return {
            "x": _w((lambda *s: torch.randn(*s, dtype=torch.bfloat16) * 0.05)(B, S, D)),
            "w1": _w((lambda *s: torch.randn(*s, dtype=torch.bfloat16) * 0.05)(D, Dff)),
            "w2": _w((lambda *s: torch.randn(*s, dtype=torch.bfloat16) * 0.05)(Dff, D)),
        }
    _B_in = _B_setup()

    return {
        "A_x": _A_in["x"],
        "A_wqkv": _A_in["wqkv"],
        "A_wo": _A_in["wo"],
        "B_x": _B_in["x"],
        "B_w1": _B_in["w1"],
        "B_w2": _B_in["w2"],
    }

def reference(A_x, A_wqkv, A_wo, B_x, B_w1, B_w2):
    def _A_ref(x, wqkv, wo):
        B, S, D = x.shape
        H = 32; Dh = D // H
        W, dil = 8, 2
        qkv = (lambda x, *d: x.permute(*d))((x @ wqkv).reshape(B, S, 3, H, Dh), 2, 0, 3, 1, 4)
        q, k, v = qkv[0], qkv[1], qkv[2]
        scale = Dh ** -0.5
        pos = torch.arange(S)
        off = torch.arange(W) * dil
        idx = pos[:, None] - off[None, :]
        mask = idx >= 0
        idx_c = torch.where(mask, idx, 0).reshape(-1)
        kg = k[:, :, idx_c, :].reshape(B, H, S, W, Dh)
        vg = v[:, :, idx_c, :].reshape(B, H, S, W, Dh)
        logits = torch.einsum("bhsd,bhswd->bhsw", q, kg) * scale
        logits = torch.where(mask[None, None, :, :], logits, -1e9)
        attn = _softmax(logits, axis=-1)
        o = torch.einsum("bhsw,bhswd->bhsd", attn, vg)
        return (lambda x, *d: x.permute(*d))(o, 0, 2, 1, 3).reshape(B, S, D) @ wo

    def _B_ref(x, w1, w2):
        h = torch.einsum("bsd,df->bsf", x, w1)
        zero = torch.zeros_like(h)
        h = torch.maximum(h, zero)
        return torch.einsum("bsf,fd->bsd", h, w2)

    x = A_x
    x = x + _A_ref(_layernorm(x, axis=-1), A_wqkv, A_wo)
    x = x + _B_ref(_layernorm(x, axis=-1), B_w1, B_w2)
    x = x + _A_ref(_layernorm(x, axis=-1), A_wqkv, A_wo)
    x = x + _B_ref(_layernorm(x, axis=-1), B_w1, B_w2)
    return x
```

```asm
; @launch grid=(256,1,1) block=(256,1,1) lds=163840
.amdgcn_target "amdgcn-amd-amdhsa--gfx950"
.text
.globl interleave_layers__sliding_local_dilated__dense_activation_relu__prompt_kernel
.p2align 8
.type interleave_layers__sliding_local_dilated__dense_activation_relu__prompt_kernel,@function
interleave_layers__sliding_local_dilated__dense_activation_relu__prompt_kernel:
s_cmp_ge_u32 s2, 256
s_cbranch_scc1 L_end
s_load_dwordx2 s[22:23], s[0:1], 64
s_load_dwordx16 s[72:87], s[0:1], 0
s_lshr_b32 s5, s2, 3
s_and_b32 s5, s5, 15
s_and_b32 s4, s2, 7
s_lshr_b32 s3, s2, 7
s_lshl_b32 s3, s3, 3
s_add_u32 s4, s4, s3
v_lshrrev_b32 v5, 6, v0
v_and_b32 v1, 63, v0
v_lshlrev_b32 v2, 4, v1
v_and_b32 v3, 15, v1
v_lshrrev_b32 v4, 4, v1
v_readfirstlane_b32 s6, v5
s_getpc_b64 s[24:25]
L_pc:
s_sub_u32 s24, s24, L_pc-interleave_layers__sliding_local_dilated__dense_activation_relu__prompt_kernel
s_subb_u32 s25, s25, 0
v_lshlrev_b32 v12, 7, v0
v_min_u32 v13, L_end-interleave_layers__sliding_local_dilated__dense_activation_relu__prompt_kernel, v12
v_add_co_u32 v10, vcc, s24, v13
v_mov_b32 v11, s25
v_addc_co_u32 v11, vcc, 0, v11, vcc
global_load_dword v254, v[10:11], off
v_add_u32 v12, 0x8000, v12
v_min_u32 v13, L_end-interleave_layers__sliding_local_dilated__dense_activation_relu__prompt_kernel, v12
v_add_co_u32 v10, vcc, s24, v13
v_mov_b32 v11, s25
v_addc_co_u32 v11, vcc, 0, v11, vcc
global_load_dword v254, v[10:11], off
s_waitcnt lgkmcnt(0)
s_mov_b32 s8, s22
s_mov_b32 s9, s23
s_mov_b32 s10, 268435456
s_mov_b32 s11, 0x20000
s_mov_b32 s16, s86
s_mov_b32 s17, s87
s_mov_b32 s18, 256
s_mov_b32 s19, 0x20000
s_mov_b32 s24, 53551104
buffer_load_dword v250, off, s[8:11], s24 sc1
s_lshl_b32 s20, s4, 8
s_add_u32 s20, s20, 53477376
v_lshlrev_b32 v253, 7, v1
s_mov_b32 s91, s4
s_mov_b32 s92, s5
s_mov_b32 s93, s20
s_and_b32 s24, s2, 7
s_lshr_b32 s25, s2, 3
s_lshr_b32 s26, s24, 1
s_lshl_b32 s26, s26, 2
s_and_b32 s27, s25, 3
s_add_u32 s88, s26, s27
s_and_b32 s26, s24, 1
s_lshl_b32 s26, s26, 3
s_lshr_b32 s27, s25, 2
s_add_u32 s89, s26, s27
s_lshl_b32 s90, s88, 8
s_add_u32 s90, s90, 53477376
s_mov_b32 s62, 0x3f803f80
s_mov_b32 s64, 0xffff
s_mov_b32 s65, 0
s_mov_b32 s66, 0xffff0000
s_mov_b32 s67, 0
s_mov_b32 s68, 0
s_mov_b32 s69, 0xffff
s_mov_b32 s70, 0
s_mov_b32 s71, 0xffff0000
s_mov_b32 s12, s72
s_mov_b32 s13, s73
s_mov_b32 s14, 2621440
s_mov_b32 s15, 0x20000
s_lshr_b32 s24, s2, 1
s_and_b32 s25, s2, 1
s_mul_i32 s26, s25, 10
s_add_u32 s26, s26, s6
s_lshl_b32 s27, s24, 4
v_add_u32 v5, s27, v3
s_movk_i32 s28, 1280
v_mul_lo_u32 v5, v5, s28
v_lshlrev_b32 v6, 3, v4
v_add_u32 v5, v5, v6
s_lshl_b32 s28, s26, 6
buffer_load_dwordx2 v[100:101], v5, s[12:15], s28 offen offset:0
buffer_load_dwordx2 v[102:103], v5, s[12:15], s28 offen offset:32
buffer_load_dwordx2 v[104:105], v5, s[12:15], s28 offen offset:256
buffer_load_dwordx2 v[106:107], v5, s[12:15], s28 offen offset:288
s_cmp_ge_u32 s6, 2
s_cbranch_scc1 L_x3_1
buffer_load_dwordx2 v[108:109], v5, s[12:15], s28 offen offset:512
buffer_load_dwordx2 v[110:111], v5, s[12:15], s28 offen offset:544
L_x3_1:
s_lshl_b32 s32, s4, 2
s_add_u32 s32, s32, s6
s_mov_b32 s31, s5
s_cmp_lt_u32 s32, 20
s_cbranch_scc1 L_pwq
s_cmp_lt_u32 s32, 40
s_cbranch_scc1 L_pw1
s_sub_u32 s30, s32, 40
s_lshl_b32 s30, s30, 4
s_add_u32 s30, s30, s5
s_cmp_lt_u32 s30, 224
s_cbranch_scc1 L_pw2
s_cmp_lt_u32 s30, 304
s_cbranch_scc1 L_pwo
s_waitcnt vmcnt(0)
s_branch L_pdone
L_pwq:
s_mov_b32 s12, s74
s_mov_b32 s13, s75
s_mov_b32 s14, 2457600
s_mov_b32 s15, 0x20000
s_lshl_b32 s33, s32, 5
v_lshlrev_b32 v6, 2, v4
v_add_u32 v6, s33, v6
s_movk_i32 s33, 3840
v_mul_lo_u32 v6, v6, s33
s_mov_b32 s40, 0
s_mov_b32 s41, 3840
s_mov_b32 s42, 7680
s_mov_b32 s43, 11520
s_mov_b32 s44, 61440
s_mov_b32 s45, 65280
s_mov_b32 s46, 69120
s_mov_b32 s47, 72960
s_mul_i32 s33, s31, 80
v_lshlrev_b32 v7, 1, v3
v_add_u32 v6, v6, v7
v_add_u32 v6, s33, v6
v_cmp_le_u32 vcc, 8, v3
v_mov_b32 v9, 0
v_mov_b32 v7, 1200
v_cndmask_b32 v7, v9, v7, vcc
v_add_u32 v7, v6, v7
v_mov_b32 v8, 16
v_cndmask_b32 v8, v9, v8, vcc
v_sub_u32 v8, v6, v8
buffer_load_ushort v16, v6, s[12:15], s40 offen offset:1280
buffer_load_ushort v17, v6, s[12:15], s41 offen offset:1280
buffer_load_ushort v18, v6, s[12:15], s42 offen offset:1280
buffer_load_ushort v19, v6, s[12:15], s43 offen offset:1280
buffer_load_ushort v20, v6, s[12:15], s44 offen offset:1280
buffer_load_ushort v21, v6, s[12:15], s45 offen offset:1280
buffer_load_ushort v22, v6, s[12:15], s46 offen offset:1280
buffer_load_ushort v23, v6, s[12:15], s47 offen offset:1280
buffer_load_ushort v24, v6, s[12:15], s40 offen offset:1312
buffer_load_ushort v25, v6, s[12:15], s41 offen offset:1312
buffer_load_ushort v26, v6, s[12:15], s42 offen offset:1312
buffer_load_ushort v27, v6, s[12:15], s43 offen offset:1312
buffer_load_ushort v28, v6, s[12:15], s44 offen offset:1312
buffer_load_ushort v29, v6, s[12:15], s45 offen offset:1312
buffer_load_ushort v30, v6, s[12:15], s46 offen offset:1312
buffer_load_ushort v31, v6, s[12:15], s47 offen offset:1312
buffer_load_ushort v32, v7, s[12:15], s40 offen offset:1344
buffer_load_ushort v33, v7, s[12:15], s41 offen offset:1344
buffer_load_ushort v34, v7, s[12:15], s42 offen offset:1344
buffer_load_ushort v35, v7, s[12:15], s43 offen offset:1344
buffer_load_ushort v36, v7, s[12:15], s44 offen offset:1344
buffer_load_ushort v37, v7, s[12:15], s45 offen offset:1344
buffer_load_ushort v38, v7, s[12:15], s46 offen offset:1344
buffer_load_ushort v39, v7, s[12:15], s47 offen offset:1344
buffer_load_ushort v40, v6, s[12:15], s40 offen offset:2576
buffer_load_ushort v41, v6, s[12:15], s41 offen offset:2576
buffer_load_ushort v42, v6, s[12:15], s42 offen offset:2576
buffer_load_ushort v43, v6, s[12:15], s43 offen offset:2576
buffer_load_ushort v44, v6, s[12:15], s44 offen offset:2576
buffer_load_ushort v45, v6, s[12:15], s45 offen offset:2576
buffer_load_ushort v46, v6, s[12:15], s46 offen offset:2576
buffer_load_ushort v47, v6, s[12:15], s47 offen offset:2576
buffer_load_ushort v48, v6, s[12:15], s40 offen offset:2608
buffer_load_ushort v49, v6, s[12:15], s41 offen offset:2608
buffer_load_ushort v50, v6, s[12:15], s42 offen offset:2608
buffer_load_ushort v51, v6, s[12:15], s43 offen offset:2608
buffer_load_ushort v52, v6, s[12:15], s44 offen offset:2608
buffer_load_ushort v53, v6, s[12:15], s45 offen offset:2608
buffer_load_ushort v54, v6, s[12:15], s46 offen offset:2608
buffer_load_ushort v55, v6, s[12:15], s47 offen offset:2608
buffer_load_ushort v56, v6, s[12:15], s40 offen offset:0
buffer_load_ushort v57, v6, s[12:15], s41 offen offset:0
buffer_load_ushort v58, v6, s[12:15], s42 offen offset:0
buffer_load_ushort v59, v6, s[12:15], s43 offen offset:0
buffer_load_ushort v60, v6, s[12:15], s44 offen offset:0
buffer_load_ushort v61, v6, s[12:15], s45 offen offset:0
buffer_load_ushort v62, v6, s[12:15], s46 offen offset:0
buffer_load_ushort v63, v6, s[12:15], s47 offen offset:0
buffer_load_ushort v64, v6, s[12:15], s40 offen offset:32
buffer_load_ushort v65, v6, s[12:15], s41 offen offset:32
buffer_load_ushort v66, v6, s[12:15], s42 offen offset:32
buffer_load_ushort v67, v6, s[12:15], s43 offen offset:32
buffer_load_ushort v68, v6, s[12:15], s44 offen offset:32
buffer_load_ushort v69, v6, s[12:15], s45 offen offset:32
buffer_load_ushort v70, v6, s[12:15], s46 offen offset:32
buffer_load_ushort v71, v6, s[12:15], s47 offen offset:32
buffer_load_ushort v72, v8, s[12:15], s40 offen offset:64
buffer_load_ushort v73, v8, s[12:15], s41 offen offset:64
buffer_load_ushort v74, v8, s[12:15], s42 offen offset:64
buffer_load_ushort v75, v8, s[12:15], s43 offen offset:64
buffer_load_ushort v76, v8, s[12:15], s44 offen offset:64
buffer_load_ushort v77, v8, s[12:15], s45 offen offset:64
buffer_load_ushort v78, v8, s[12:15], s46 offen offset:64
buffer_load_ushort v79, v8, s[12:15], s47 offen offset:64
s_mul_i32 s34, s31, 163840
s_lshl_b32 s33, s32, 13
s_add_u32 s34, s34, s33
s_add_u32 s34, s34, 0
s_add_u32 s35, s34, 4096
s_waitcnt vmcnt(56)
v_lshl_or_b32 v112, v17, 16, v16
v_lshl_or_b32 v113, v19, 16, v18
v_lshl_or_b32 v114, v21, 16, v20
v_lshl_or_b32 v115, v23, 16, v22
s_nop 0
buffer_store_dwordx4 v[112:115], v2, s[8:11], s34 offen offset:0 sc1
s_waitcnt vmcnt(48)
v_lshl_or_b32 v116, v25, 16, v24
v_lshl_or_b32 v117, v27, 16, v26
v_lshl_or_b32 v118, v29, 16, v28
v_lshl_or_b32 v119, v31, 16, v30
s_nop 0
buffer_store_dwordx4 v[116:119], v2, s[8:11], s34 offen offset:1024 sc1
s_waitcnt vmcnt(40)
v_lshl_or_b32 v120, v33, 16, v32
v_lshl_or_b32 v121, v35, 16, v34
v_lshl_or_b32 v122, v37, 16, v36
v_lshl_or_b32 v123, v39, 16, v38
s_nop 0
buffer_store_dwordx4 v[120:123], v2, s[8:11], s34 offen offset:2048 sc1
s_waitcnt vmcnt(32)
v_lshl_or_b32 v124, v41, 16, v40
v_lshl_or_b32 v125, v43, 16, v42
v_lshl_or_b32 v126, v45, 16, v44
v_lshl_or_b32 v127, v47, 16, v46
s_nop 0
buffer_store_dwordx4 v[124:127], v2, s[8:11], s34 offen offset:3072 sc1
s_waitcnt vmcnt(24)
v_lshl_or_b32 v128, v49, 16, v48
v_lshl_or_b32 v129, v51, 16, v50
v_lshl_or_b32 v130, v53, 16, v52
v_lshl_or_b32 v131, v55, 16, v54
s_nop 0
buffer_store_dwordx4 v[128:131], v2, s[8:11], s35 offen offset:0 sc1
s_waitcnt vmcnt(16)
v_lshl_or_b32 v132, v57, 16, v56
v_lshl_or_b32 v133, v59, 16, v58
v_lshl_or_b32 v134, v61, 16, v60
v_lshl_or_b32 v135, v63, 16, v62
s_nop 0
buffer_store_dwordx4 v[132:135], v2, s[8:11], s35 offen offset:1024 sc1
s_waitcnt vmcnt(8)
v_lshl_or_b32 v136, v65, 16, v64
v_lshl_or_b32 v137, v67, 16, v66
v_lshl_or_b32 v138, v69, 16, v68
v_lshl_or_b32 v139, v71, 16, v70
s_nop 0
buffer_store_dwordx4 v[136:139], v2, s[8:11], s35 offen offset:2048 sc1
s_waitcnt vmcnt(0)
v_lshl_or_b32 v140, v73, 16, v72
v_lshl_or_b32 v141, v75, 16, v74
v_lshl_or_b32 v142, v77, 16, v76
v_lshl_or_b32 v143, v79, 16, v78
s_nop 0
buffer_store_dwordx4 v[140:143], v2, s[8:11], s35 offen offset:3072 sc1
v_dot2_f32_bf16 v80, v112, s62, 0
v_dot2_f32_bf16 v80, v113, s62, v80
v_dot2_f32_bf16 v80, v114, s62, v80
v_dot2_f32_bf16 v80, v115, s62, v80
s_nop 2
v_mov_b32 v92, v80
s_nop 1
v_permlane32_swap_b32 v80, v92
s_nop 1
v_add_f32 v80, v80, v92
v_mov_b32 v92, v80
s_nop 1
v_permlane16_swap_b32 v80, v92
s_nop 1
v_add_f32 v80, v80, v92
v_dot2_f32_bf16 v81, v116, s62, 0
v_dot2_f32_bf16 v81, v117, s62, v81
v_dot2_f32_bf16 v81, v118, s62, v81
v_dot2_f32_bf16 v81, v119, s62, v81
s_nop 2
v_mov_b32 v92, v81
s_nop 1
v_permlane32_swap_b32 v81, v92
s_nop 1
v_add_f32 v81, v81, v92
v_mov_b32 v92, v81
s_nop 1
v_permlane16_swap_b32 v81, v92
s_nop 1
v_add_f32 v81, v81, v92
v_dot2_f32_bf16 v82, v120, s62, 0
v_dot2_f32_bf16 v82, v121, s62, v82
v_dot2_f32_bf16 v82, v122, s62, v82
v_dot2_f32_bf16 v82, v123, s62, v82
s_nop 2
v_mov_b32 v92, v82
s_nop 1
v_permlane32_swap_b32 v82, v92
s_nop 1
v_add_f32 v82, v82, v92
v_mov_b32 v92, v82
s_nop 1
v_permlane16_swap_b32 v82, v92
s_nop 1
v_add_f32 v82, v82, v92
v_dot2_f32_bf16 v83, v124, s62, 0
v_dot2_f32_bf16 v83, v125, s62, v83
v_dot2_f32_bf16 v83, v126, s62, v83
v_dot2_f32_bf16 v83, v127, s62, v83
s_nop 2
v_mov_b32 v92, v83
s_nop 1
v_permlane32_swap_b32 v83, v92
s_nop 1
v_add_f32 v83, v83, v92
v_mov_b32 v92, v83
s_nop 1
v_permlane16_swap_b32 v83, v92
s_nop 1
v_add_f32 v83, v83, v92
v_dot2_f32_bf16 v84, v128, s62, 0
v_dot2_f32_bf16 v84, v129, s62, v84
v_dot2_f32_bf16 v84, v130, s62, v84
v_dot2_f32_bf16 v84, v131, s62, v84
s_nop 2
v_mov_b32 v92, v84
s_nop 1
v_permlane32_swap_b32 v84, v92
s_nop 1
v_add_f32 v84, v84, v92
v_mov_b32 v92, v84
s_nop 1
v_permlane16_swap_b32 v84, v92
s_nop 1
v_add_f32 v84, v84, v92
v_dot2_f32_bf16 v85, v132, s62, 0
v_dot2_f32_bf16 v85, v133, s62, v85
v_dot2_f32_bf16 v85, v134, s62, v85
v_dot2_f32_bf16 v85, v135, s62, v85
s_nop 2
v_mov_b32 v92, v85
s_nop 1
v_permlane32_swap_b32 v85, v92
s_nop 1
v_add_f32 v85, v85, v92
v_mov_b32 v92, v85
s_nop 1
v_permlane16_swap_b32 v85, v92
s_nop 1
v_add_f32 v85, v85, v92
v_dot2_f32_bf16 v86, v136, s62, 0
v_dot2_f32_bf16 v86, v137, s62, v86
v_dot2_f32_bf16 v86, v138, s62, v86
v_dot2_f32_bf16 v86, v139, s62, v86
s_nop 2
v_mov_b32 v92, v86
s_nop 1
v_permlane32_swap_b32 v86, v92
s_nop 1
v_add_f32 v86, v86, v92
v_mov_b32 v92, v86
s_nop 1
v_permlane16_swap_b32 v86, v92
s_nop 1
v_add_f32 v86, v86, v92
v_dot2_f32_bf16 v87, v140, s62, 0
v_dot2_f32_bf16 v87, v141, s62, v87
v_dot2_f32_bf16 v87, v142, s62, v87
v_dot2_f32_bf16 v87, v143, s62, v87
s_nop 2
v_mov_b32 v92, v87
s_nop 1
v_permlane32_swap_b32 v87, v92
s_nop 1
v_add_f32 v87, v87, v92
v_mov_b32 v92, v87
s_nop 1
v_permlane16_swap_b32 v87, v92
s_nop 1
v_add_f32 v87, v87, v92
v_mov_b32 v90, v80
v_cndmask_b32 v90, v90, v81, s[66:67]
v_cndmask_b32 v90, v90, v82, s[68:69]
v_cndmask_b32 v90, v90, v83, s[70:71]
v_mov_b32 v91, v84
v_cndmask_b32 v91, v91, v85, s[66:67]
v_cndmask_b32 v91, v91, v86, s[68:69]
v_cndmask_b32 v91, v91, v87, s[70:71]
s_mul_i32 s33, s31, 20
s_add_u32 s33, s33, s32
s_lshl_b32 s33, s33, 9
s_add_u32 s33, s33, 10485760
v_lshlrev_b32 v7, 2, v1
buffer_store_dword v90, v7, s[8:11], s33 offen sc1
buffer_store_dword v91, v7, s[8:11], s33 offen offset:256 sc1
s_branch L_pdone
L_pw1:
s_mov_b32 s12, s80
s_mov_b32 s13, s81
s_mov_b32 s14, 2211840
s_mov_b32 s15, 0x20000
s_sub_u32 s32, s32, 20
s_lshl_b32 s33, s32, 5
v_lshlrev_b32 v6, 2, v4
v_add_u32 v6, s33, v6
s_movk_i32 s33, 3456
v_mul_lo_u32 v6, v6, s33
s_mov_b32 s40, 0
s_mov_b32 s41, 3456
s_mov_b32 s42, 6912
s_mov_b32 s43, 10368
s_mov_b32 s44, 55296
s_mov_b32 s45, 58752
s_mov_b32 s46, 62208
s_mov_b32 s47, 65664
s_and_b32 s36, s31, 1
s_mul_i32 s37, s31, 7
s_add_u32 s33, s37, s36
s_lshl_b32 s33, s33, 5
v_lshlrev_b32 v7, 1, v3
v_add_u32 v6, v6, v7
v_add_u32 v7, s33, v6
s_xor_b32 s36, s36, 1
s_mul_i32 s36, s36, 6
s_add_u32 s33, s37, s36
s_lshl_b32 s33, s33, 5
v_add_u32 v8, s33, v6
buffer_load_ushort v16, v7, s[12:15], s40 offen offset:0
buffer_load_ushort v17, v7, s[12:15], s41 offen offset:0
buffer_load_ushort v18, v7, s[12:15], s42 offen offset:0
buffer_load_ushort v19, v7, s[12:15], s43 offen offset:0
buffer_load_ushort v20, v7, s[12:15], s44 offen offset:0
buffer_load_ushort v21, v7, s[12:15], s45 offen offset:0
buffer_load_ushort v22, v7, s[12:15], s46 offen offset:0
buffer_load_ushort v23, v7, s[12:15], s47 offen offset:0
buffer_load_ushort v24, v7, s[12:15], s40 offen offset:32
buffer_load_ushort v25, v7, s[12:15], s41 offen offset:32
buffer_load_ushort v26, v7, s[12:15], s42 offen offset:32
buffer_load_ushort v27, v7, s[12:15], s43 offen offset:32
buffer_load_ushort v28, v7, s[12:15], s44 offen offset:32
buffer_load_ushort v29, v7, s[12:15], s45 offen offset:32
buffer_load_ushort v30, v7, s[12:15], s46 offen offset:32
buffer_load_ushort v31, v7, s[12:15], s47 offen offset:32
buffer_load_ushort v32, v7, s[12:15], s40 offen offset:64
buffer_load_ushort v33, v7, s[12:15], s41 offen offset:64
buffer_load_ushort v34, v7, s[12:15], s42 offen offset:64
buffer_load_ushort v35, v7, s[12:15], s43 offen offset:64
buffer_load_ushort v36, v7, s[12:15], s44 offen offset:64
buffer_load_ushort v37, v7, s[12:15], s45 offen offset:64
buffer_load_ushort v38, v7, s[12:15], s46 offen offset:64
buffer_load_ushort v39, v7, s[12:15], s47 offen offset:64
buffer_load_ushort v40, v7, s[12:15], s40 offen offset:96
buffer_load_ushort v41, v7, s[12:15], s41 offen offset:96
buffer_load_ushort v42, v7, s[12:15], s42 offen offset:96
buffer_load_ushort v43, v7, s[12:15], s43 offen offset:96
buffer_load_ushort v44, v7, s[12:15], s44 offen offset:96
buffer_load_ushort v45, v7, s[12:15], s45 offen offset:96
buffer_load_ushort v46, v7, s[12:15], s46 offen offset:96
buffer_load_ushort v47, v7, s[12:15], s47 offen offset:96
buffer_load_ushort v48, v7, s[12:15], s40 offen offset:128
buffer_load_ushort v49, v7, s[12:15], s41 offen offset:128
buffer_load_ushort v50, v7, s[12:15], s42 offen offset:128
buffer_load_ushort v51, v7, s[12:15], s43 offen offset:128
buffer_load_ushort v52, v7, s[12:15], s44 offen offset:128
buffer_load_ushort v53, v7, s[12:15], s45 offen offset:128
buffer_load_ushort v54, v7, s[12:15], s46 offen offset:128
buffer_load_ushort v55, v7, s[12:15], s47 offen offset:128
buffer_load_ushort v56, v7, s[12:15], s40 offen offset:160
buffer_load_ushort v57, v7, s[12:15], s41 offen offset:160
buffer_load_ushort v58, v7, s[12:15], s42 offen offset:160
buffer_load_ushort v59, v7, s[12:15], s43 offen offset:160
buffer_load_ushort v60, v7, s[12:15], s44 offen offset:160
buffer_load_ushort v61, v7, s[12:15], s45 offen offset:160
buffer_load_ushort v62, v7, s[12:15], s46 offen offset:160
buffer_load_ushort v63, v7, s[12:15], s47 offen offset:160
buffer_load_ushort v64, v8, s[12:15], s40 offen offset:0
buffer_load_ushort v65, v8, s[12:15], s41 offen offset:0
buffer_load_ushort v66, v8, s[12:15], s42 offen offset:0
buffer_load_ushort v67, v8, s[12:15], s43 offen offset:0
buffer_load_ushort v68, v8, s[12:15], s44 offen offset:0
buffer_load_ushort v69, v8, s[12:15], s45 offen offset:0
buffer_load_ushort v70, v8, s[12:15], s46 offen offset:0
buffer_load_ushort v71, v8, s[12:15], s47 offen offset:0
s_mul_i32 s34, s31, 143360
s_mul_i32 s33, s32, 7168
s_add_u32 s34, s34, s33
s_add_u32 s34, s34, 3145728
s_add_u32 s35, s34, 4096
s_waitcnt vmcnt(0)
s_cmp_lg_u32 s31, 15
s_cbranch_scc1 L_z_2
v_mov_b32 v32, 0
v_mov_b32 v33, 0
v_mov_b32 v34, 0
v_mov_b32 v35, 0
v_mov_b32 v36, 0
v_mov_b32 v37, 0
v_mov_b32 v38, 0
v_mov_b32 v39, 0
v_mov_b32 v40, 0
v_mov_b32 v41, 0
v_mov_b32 v42, 0
v_mov_b32 v43, 0
v_mov_b32 v44, 0
v_mov_b32 v45, 0
v_mov_b32 v46, 0
v_mov_b32 v47, 0
v_mov_b32 v48, 0
v_mov_b32 v49, 0
v_mov_b32 v50, 0
v_mov_b32 v51, 0
v_mov_b32 v52, 0
v_mov_b32 v53, 0
v_mov_b32 v54, 0
v_mov_b32 v55, 0
v_mov_b32 v56, 0
v_mov_b32 v57, 0
v_mov_b32 v58, 0
v_mov_b32 v59, 0
v_mov_b32 v60, 0
v_mov_b32 v61, 0
v_mov_b32 v62, 0
v_mov_b32 v63, 0
L_z_2:
v_lshl_or_b32 v112, v17, 16, v16
v_lshl_or_b32 v113, v19, 16, v18
v_lshl_or_b32 v114, v21, 16, v20
v_lshl_or_b32 v115, v23, 16, v22
s_nop 0
buffer_store_dwordx4 v[112:115], v2, s[8:11], s34 offen offset:0 sc1
v_lshl_or_b32 v116, v25, 16, v24
v_lshl_or_b32 v117, v27, 16, v26
v_lshl_or_b32 v118, v29, 16, v28
v_lshl_or_b32 v119, v31, 16, v30
s_nop 0
buffer_store_dwordx4 v[116:119], v2, s[8:11], s34 offen offset:1024 sc1
v_lshl_or_b32 v120, v33, 16, v32
v_lshl_or_b32 v121, v35, 16, v34
v_lshl_or_b32 v122, v37, 16, v36
v_lshl_or_b32 v123, v39, 16, v38
s_nop 0
buffer_store_dwordx4 v[120:123], v2, s[8:11], s34 offen offset:2048 sc1
v_lshl_or_b32 v124, v41, 16, v40
v_lshl_or_b32 v125, v43, 16, v42
v_lshl_or_b32 v126, v45, 16, v44
v_lshl_or_b32 v127, v47, 16, v46
s_nop 0
buffer_store_dwordx4 v[124:127], v2, s[8:11], s34 offen offset:3072 sc1
v_lshl_or_b32 v128, v49, 16, v48
v_lshl_or_b32 v129, v51, 16, v50
v_lshl_or_b32 v130, v53, 16, v52
v_lshl_or_b32 v131, v55, 16, v54
s_nop 0
buffer_store_dwordx4 v[128:131], v2, s[8:11], s35 offen offset:0 sc1
v_lshl_or_b32 v132, v57, 16, v56
v_lshl_or_b32 v133, v59, 16, v58
v_lshl_or_b32 v134, v61, 16, v60
v_lshl_or_b32 v135, v63, 16, v62
s_nop 0
buffer_store_dwordx4 v[132:135], v2, s[8:11], s35 offen offset:1024 sc1
v_lshl_or_b32 v136, v65, 16, v64
v_lshl_or_b32 v137, v67, 16, v66
v_lshl_or_b32 v138, v69, 16, v68
v_lshl_or_b32 v139, v71, 16, v70
s_nop 0
buffer_store_dwordx4 v[136:139], v2, s[8:11], s35 offen offset:2048 sc1
v_dot2_f32_bf16 v80, v112, s62, 0
v_dot2_f32_bf16 v80, v113, s62, v80
v_dot2_f32_bf16 v80, v114, s62, v80
v_dot2_f32_bf16 v80, v115, s62, v80
s_nop 2
v_mov_b32 v92, v80
s_nop 1
v_permlane32_swap_b32 v80, v92
s_nop 1
v_add_f32 v80, v80, v92
v_mov_b32 v92, v80
s_nop 1
v_permlane16_swap_b32 v80, v92
s_nop 1
v_add_f32 v80, v80, v92
v_dot2_f32_bf16 v81, v116, s62, 0
v_dot2_f32_bf16 v81, v117, s62, v81
v_dot2_f32_bf16 v81, v118, s62, v81
v_dot2_f32_bf16 v81, v119, s62, v81
s_nop 2
v_mov_b32 v92, v81
s_nop 1
v_permlane32_swap_b32 v81, v92
s_nop 1
v_add_f32 v81, v81, v92
v_mov_b32 v92, v81
s_nop 1
v_permlane16_swap_b32 v81, v92
s_nop 1
v_add_f32 v81, v81, v92
v_dot2_f32_bf16 v82, v120, s62, 0
v_dot2_f32_bf16 v82, v121, s62, v82
v_dot2_f32_bf16 v82, v122, s62, v82
v_dot2_f32_bf16 v82, v123, s62, v82
s_nop 2
v_mov_b32 v92, v82
s_nop 1
v_permlane32_swap_b32 v82, v92
s_nop 1
v_add_f32 v82, v82, v92
v_mov_b32 v92, v82
s_nop 1
v_permlane16_swap_b32 v82, v92
s_nop 1
v_add_f32 v82, v82, v92
v_dot2_f32_bf16 v83, v124, s62, 0
v_dot2_f32_bf16 v83, v125, s62, v83
v_dot2_f32_bf16 v83, v126, s62, v83
v_dot2_f32_bf16 v83, v127, s62, v83
s_nop 2
v_mov_b32 v92, v83
s_nop 1
v_permlane32_swap_b32 v83, v92
s_nop 1
v_add_f32 v83, v83, v92
v_mov_b32 v92, v83
s_nop 1
v_permlane16_swap_b32 v83, v92
s_nop 1
v_add_f32 v83, v83, v92
v_dot2_f32_bf16 v84, v128, s62, 0
v_dot2_f32_bf16 v84, v129, s62, v84
v_dot2_f32_bf16 v84, v130, s62, v84
v_dot2_f32_bf16 v84, v131, s62, v84
s_nop 2
v_mov_b32 v92, v84
s_nop 1
v_permlane32_swap_b32 v84, v92
s_nop 1
v_add_f32 v84, v84, v92
v_mov_b32 v92, v84
s_nop 1
v_permlane16_swap_b32 v84, v92
s_nop 1
v_add_f32 v84, v84, v92
v_dot2_f32_bf16 v85, v132, s62, 0
v_dot2_f32_bf16 v85, v133, s62, v85
v_dot2_f32_bf16 v85, v134, s62, v85
v_dot2_f32_bf16 v85, v135, s62, v85
s_nop 2
v_mov_b32 v92, v85
s_nop 1
v_permlane32_swap_b32 v85, v92
s_nop 1
v_add_f32 v85, v85, v92
v_mov_b32 v92, v85
s_nop 1
v_permlane16_swap_b32 v85, v92
s_nop 1
v_add_f32 v85, v85, v92
v_dot2_f32_bf16 v86, v136, s62, 0
v_dot2_f32_bf16 v86, v137, s62, v86
v_dot2_f32_bf16 v86, v138, s62, v86
v_dot2_f32_bf16 v86, v139, s62, v86
s_nop 2
v_mov_b32 v92, v86
s_nop 1
v_permlane32_swap_b32 v86, v92
s_nop 1
v_add_f32 v86, v86, v92
v_mov_b32 v92, v86
s_nop 1
v_permlane16_swap_b32 v86, v92
s_nop 1
v_add_f32 v86, v86, v92
v_mov_b32 v90, v80
v_cndmask_b32 v90, v90, v81, s[66:67]
v_cndmask_b32 v90, v90, v82, s[68:69]
v_cndmask_b32 v90, v90, v83, s[70:71]
v_mov_b32 v91, v84
v_cndmask_b32 v91, v91, v85, s[66:67]
v_cndmask_b32 v91, v91, v86, s[68:69]
s_mul_i32 s33, s31, 20
s_add_u32 s33, s33, s32
s_lshl_b32 s33, s33, 9
s_add_u32 s33, s33, 10747904
v_lshlrev_b32 v7, 2, v1
buffer_store_dword v90, v7, s[8:11], s33 offen sc1
buffer_store_dword v91, v7, s[8:11], s33 offen offset:256 sc1
s_branch L_pdone
L_pw2:
s_mov_b32 s12, s82
s_mov_b32 s13, s83
s_mov_b32 s14, 2211840
s_mov_b32 s15, 0x20000
s_sub_u32 s30, s30, 0
s_and_b32 s31, s30, 7
s_lshr_b32 s32, s30, 3
s_lshl_b32 s32, s32, 1
s_and_b32 s38, s31, 1
s_mul_i32 s39, s31, 5
s_add_u32 s36, s39, s38
s_lshl_b32 s36, s36, 5
s_xor_b32 s38, s38, 1
s_lshl_b32 s38, s38, 2
s_add_u32 s37, s39, s38
s_lshl_b32 s37, s37, 5
v_lshlrev_b32 v9, 1, v3
s_add_u32 s33, s32, 0
s_lshl_b32 s33, s33, 5
v_lshlrev_b32 v6, 2, v4
v_add_u32 v6, s33, v6
v_mov_b32 v10, v6
v_add_u32 v11, 16, v6
s_movk_i32 s33, 1280
v_mul_lo_u32 v10, v10, s33
v_mul_lo_u32 v11, v11, s33
v_add_u32 v10, v10, v9
v_add_u32 v11, v11, v9
buffer_load_ushort v16, v10, s[12:15], s36 offen offset:0
buffer_load_ushort v17, v10, s[12:15], s36 offen offset:1280
buffer_load_ushort v18, v10, s[12:15], s36 offen offset:2560
buffer_load_ushort v19, v10, s[12:15], s36 offen offset:3840
buffer_load_ushort v20, v11, s[12:15], s36 offen offset:0
buffer_load_ushort v21, v11, s[12:15], s36 offen offset:1280
buffer_load_ushort v22, v11, s[12:15], s36 offen offset:2560
buffer_load_ushort v23, v11, s[12:15], s36 offen offset:3840
buffer_load_ushort v24, v10, s[12:15], s36 offen offset:32
buffer_load_ushort v25, v10, s[12:15], s36 offen offset:1312
buffer_load_ushort v26, v10, s[12:15], s36 offen offset:2592
buffer_load_ushort v27, v10, s[12:15], s36 offen offset:3872
buffer_load_ushort v28, v11, s[12:15], s36 offen offset:32
buffer_load_ushort v29, v11, s[12:15], s36 offen offset:1312
buffer_load_ushort v30, v11, s[12:15], s36 offen offset:2592
buffer_load_ushort v31, v11, s[12:15], s36 offen offset:3872
buffer_load_ushort v32, v10, s[12:15], s36 offen offset:64
buffer_load_ushort v33, v10, s[12:15], s36 offen offset:1344
buffer_load_ushort v34, v10, s[12:15], s36 offen offset:2624
buffer_load_ushort v35, v10, s[12:15], s36 offen offset:3904
buffer_load_ushort v36, v11, s[12:15], s36 offen offset:64
buffer_load_ushort v37, v11, s[12:15], s36 offen offset:1344
buffer_load_ushort v38, v11, s[12:15], s36 offen offset:2624
buffer_load_ushort v39, v11, s[12:15], s36 offen offset:3904
buffer_load_ushort v40, v10, s[12:15], s36 offen offset:96
buffer_load_ushort v41, v10, s[12:15], s36 offen offset:1376
buffer_load_ushort v42, v10, s[12:15], s36 offen offset:2656
buffer_load_ushort v43, v10, s[12:15], s36 offen offset:3936
buffer_load_ushort v44, v11, s[12:15], s36 offen offset:96
buffer_load_ushort v45, v11, s[12:15], s36 offen offset:1376
buffer_load_ushort v46, v11, s[12:15], s36 offen offset:2656
buffer_load_ushort v47, v11, s[12:15], s36 offen offset:3936
buffer_load_ushort v48, v10, s[12:15], s37 offen offset:0
buffer_load_ushort v49, v10, s[12:15], s37 offen offset:1280
buffer_load_ushort v50, v10, s[12:15], s37 offen offset:2560
buffer_load_ushort v51, v10, s[12:15], s37 offen offset:3840
buffer_load_ushort v52, v11, s[12:15], s37 offen offset:0
buffer_load_ushort v53, v11, s[12:15], s37 offen offset:1280
buffer_load_ushort v54, v11, s[12:15], s37 offen offset:2560
buffer_load_ushort v55, v11, s[12:15], s37 offen offset:3840
s_nop 0
s_add_u32 s33, s32, 1
s_lshl_b32 s33, s33, 5
v_lshlrev_b32 v6, 2, v4
v_add_u32 v6, s33, v6
v_mov_b32 v10, v6
v_add_u32 v11, 16, v6
s_movk_i32 s33, 1280
v_mul_lo_u32 v10, v10, s33
v_mul_lo_u32 v11, v11, s33
v_add_u32 v10, v10, v9
v_add_u32 v11, v11, v9
buffer_load_ushort v56, v10, s[12:15], s36 offen offset:0
buffer_load_ushort v57, v10, s[12:15], s36 offen offset:1280
buffer_load_ushort v58, v10, s[12:15], s36 offen offset:2560
buffer_load_ushort v59, v10, s[12:15], s36 offen offset:3840
buffer_load_ushort v60, v11, s[12:15], s36 offen offset:0
buffer_load_ushort v61, v11, s[12:15], s36 offen offset:1280
buffer_load_ushort v62, v11, s[12:15], s36 offen offset:2560
buffer_load_ushort v63, v11, s[12:15], s36 offen offset:3840
buffer_load_ushort v64, v10, s[12:15], s36 offen offset:32
buffer_load_ushort v65, v10, s[12:15], s36 offen offset:1312
buffer_load_ushort v66, v10, s[12:15], s36 offen offset:2592
buffer_load_ushort v67, v10, s[12:15], s36 offen offset:3872
buffer_load_ushort v68, v11, s[12:15], s36 offen offset:32
buffer_load_ushort v69, v11, s[12:15], s36 offen offset:1312
buffer_load_ushort v70, v11, s[12:15], s36 offen offset:2592
buffer_load_ushort v71, v11, s[12:15], s36 offen offset:3872
buffer_load_ushort v72, v10, s[12:15], s36 offen offset:64
buffer_load_ushort v73, v10, s[12:15], s36 offen offset:1344
buffer_load_ushort v74, v10, s[12:15], s36 offen offset:2624
buffer_load_ushort v75, v10, s[12:15], s36 offen offset:3904
buffer_load_ushort v76, v11, s[12:15], s36 offen offset:64
buffer_load_ushort v77, v11, s[12:15], s36 offen offset:1344
buffer_load_ushort v78, v11, s[12:15], s36 offen offset:2624
buffer_load_ushort v79, v11, s[12:15], s36 offen offset:3904
buffer_load_ushort v80, v10, s[12:15], s36 offen offset:96
buffer_load_ushort v81, v10, s[12:15], s36 offen offset:1376
buffer_load_ushort v82, v10, s[12:15], s36 offen offset:2656
buffer_load_ushort v83, v10, s[12:15], s36 offen offset:3936
buffer_load_ushort v84, v11, s[12:15], s36 offen offset:96
buffer_load_ushort v85, v11, s[12:15], s36 offen offset:1376
buffer_load_ushort v86, v11, s[12:15], s36 offen offset:2656
buffer_load_ushort v87, v11, s[12:15], s36 offen offset:3936
buffer_load_ushort v88, v10, s[12:15], s37 offen offset:0
buffer_load_ushort v89, v10, s[12:15], s37 offen offset:1280
buffer_load_ushort v90, v10, s[12:15], s37 offen offset:2560
buffer_load_ushort v91, v10, s[12:15], s37 offen offset:3840
buffer_load_ushort v92, v11, s[12:15], s37 offen offset:0
buffer_load_ushort v93, v11, s[12:15], s37 offen offset:1280
buffer_load_ushort v94, v11, s[12:15], s37 offen offset:2560
buffer_load_ushort v95, v11, s[12:15], s37 offen offset:3840
s_mul_i32 s34, s31, 286720
s_mul_i32 s33, s32, 5120
s_add_u32 s34, s34, s33
s_add_u32 s34, s34, 7340032
s_add_u32 s35, s34, 4096
s_add_u32 s39, s34, 8192
s_waitcnt vmcnt(0)
s_cmp_lt_u32 s32, 54
s_cbranch_scc1 L_z_3
v_mov_b32 v16, 0
v_mov_b32 v17, 0
v_mov_b32 v18, 0
v_mov_b32 v19, 0
v_mov_b32 v20, 0
v_mov_b32 v21, 0
v_mov_b32 v22, 0
v_mov_b32 v23, 0
v_mov_b32 v24, 0
v_mov_b32 v25, 0
v_mov_b32 v26, 0
v_mov_b32 v27, 0
v_mov_b32 v28, 0
v_mov_b32 v29, 0
v_mov_b32 v30, 0
v_mov_b32 v31, 0
v_mov_b32 v32, 0
v_mov_b32 v33, 0
v_mov_b32 v34, 0
v_mov_b32 v35, 0
v_mov_b32 v36, 0
v_mov_b32 v37, 0
v_mov_b32 v38, 0
v_mov_b32 v39, 0
v_mov_b32 v40, 0
v_mov_b32 v41, 0
v_mov_b32 v42, 0
v_mov_b32 v43, 0
v_mov_b32 v44, 0
v_mov_b32 v45, 0
v_mov_b32 v46, 0
v_mov_b32 v47, 0
v_mov_b32 v48, 0
v_mov_b32 v49, 0
v_mov_b32 v50, 0
v_mov_b32 v51, 0
v_mov_b32 v52, 0
v_mov_b32 v53, 0
v_mov_b32 v54, 0
v_mov_b32 v55, 0
v_mov_b32 v56, 0
v_mov_b32 v57, 0
v_mov_b32 v58, 0
v_mov_b32 v59, 0
v_mov_b32 v60, 0
v_mov_b32 v61, 0
v_mov_b32 v62, 0
v_mov_b32 v63, 0
v_mov_b32 v64, 0
v_mov_b32 v65, 0
v_mov_b32 v66, 0
v_mov_b32 v67, 0
v_mov_b32 v68, 0
v_mov_b32 v69, 0
v_mov_b32 v70, 0
v_mov_b32 v71, 0
v_mov_b32 v72, 0
v_mov_b32 v73, 0
v_mov_b32 v74, 0
v_mov_b32 v75, 0
v_mov_b32 v76, 0
v_mov_b32 v77, 0
v_mov_b32 v78, 0
v_mov_b32 v79, 0
v_mov_b32 v80, 0
v_mov_b32 v81, 0
v_mov_b32 v82, 0
v_mov_b32 v83, 0
v_mov_b32 v84, 0
v_mov_b32 v85, 0
v_mov_b32 v86, 0
v_mov_b32 v87, 0
v_mov_b32 v88, 0
v_mov_b32 v89, 0
v_mov_b32 v90, 0
v_mov_b32 v91, 0
v_mov_b32 v92, 0
v_mov_b32 v93, 0
v_mov_b32 v94, 0
v_mov_b32 v95, 0
L_z_3:
v_lshl_or_b32 v112, v17, 16, v16
v_lshl_or_b32 v113, v19, 16, v18
v_lshl_or_b32 v114, v21, 16, v20
v_lshl_or_b32 v115, v23, 16, v22
s_nop 0
buffer_store_dwordx4 v[112:115], v2, s[8:11], s34 offen offset:0 sc1
v_lshl_or_b32 v116, v25, 16, v24
v_lshl_or_b32 v117, v27, 16, v26
v_lshl_or_b32 v118, v29, 16, v28
v_lshl_or_b32 v119, v31, 16, v30
s_nop 0
buffer_store_dwordx4 v[116:119], v2, s[8:11], s34 offen offset:1024 sc1
v_lshl_or_b32 v120, v33, 16, v32
v_lshl_or_b32 v121, v35, 16, v34
v_lshl_or_b32 v122, v37, 16, v36
v_lshl_or_b32 v123, v39, 16, v38
s_nop 0
buffer_store_dwordx4 v[120:123], v2, s[8:11], s34 offen offset:2048 sc1
v_lshl_or_b32 v124, v41, 16, v40
v_lshl_or_b32 v125, v43, 16, v42
v_lshl_or_b32 v126, v45, 16, v44
v_lshl_or_b32 v127, v47, 16, v46
s_nop 0
buffer_store_dwordx4 v[124:127], v2, s[8:11], s34 offen offset:3072 sc1
v_lshl_or_b32 v128, v49, 16, v48
v_lshl_or_b32 v129, v51, 16, v50
v_lshl_or_b32 v130, v53, 16, v52
v_lshl_or_b32 v131, v55, 16, v54
s_nop 0
buffer_store_dwordx4 v[128:131], v2, s[8:11], s35 offen offset:0 sc1
v_lshl_or_b32 v132, v57, 16, v56
v_lshl_or_b32 v133, v59, 16, v58
v_lshl_or_b32 v134, v61, 16, v60
v_lshl_or_b32 v135, v63, 16, v62
s_nop 0
buffer_store_dwordx4 v[132:135], v2, s[8:11], s35 offen offset:1024 sc1
v_lshl_or_b32 v136, v65, 16, v64
v_lshl_or_b32 v137, v67, 16, v66
v_lshl_or_b32 v138, v69, 16, v68
v_lshl_or_b32 v139, v71, 16, v70
s_nop 0
buffer_store_dwordx4 v[136:139], v2, s[8:11], s35 offen offset:2048 sc1
v_lshl_or_b32 v140, v73, 16, v72
v_lshl_or_b32 v141, v75, 16, v74
v_lshl_or_b32 v142, v77, 16, v76
v_lshl_or_b32 v143, v79, 16, v78
s_nop 0
buffer_store_dwordx4 v[140:143], v2, s[8:11], s35 offen offset:3072 sc1
v_lshl_or_b32 v144, v81, 16, v80
v_lshl_or_b32 v145, v83, 16, v82
v_lshl_or_b32 v146, v85, 16, v84
v_lshl_or_b32 v147, v87, 16, v86
s_nop 0
buffer_store_dwordx4 v[144:147], v2, s[8:11], s39 offen offset:0 sc1
v_lshl_or_b32 v148, v89, 16, v88
v_lshl_or_b32 v149, v91, 16, v90
v_lshl_or_b32 v150, v93, 16, v92
v_lshl_or_b32 v151, v95, 16, v94
s_nop 0
buffer_store_dwordx4 v[148:151], v2, s[8:11], s39 offen offset:1024 sc1
s_branch L_pdone
L_pwo:
s_mov_b32 s12, s76
s_mov_b32 s13, s77
s_mov_b32 s14, 819200
s_mov_b32 s15, 0x20000
s_sub_u32 s30, s30, 224
s_and_b32 s31, s30, 7
s_lshr_b32 s32, s30, 3
s_lshl_b32 s32, s32, 1
s_and_b32 s38, s31, 1
s_mul_i32 s39, s31, 5
s_add_u32 s36, s39, s38
s_lshl_b32 s36, s36, 5
s_xor_b32 s38, s38, 1
s_lshl_b32 s38, s38, 2
s_add_u32 s37, s39, s38
s_lshl_b32 s37, s37, 5
v_lshlrev_b32 v9, 1, v3
s_add_u32 s33, s32, 0
s_lshl_b32 s33, s33, 2
v_add_u32 v6, s33, v4
v_mul_u32_u24 v7, 205, v6
v_lshrrev_b32 v7, 10, v7
v_mul_u32_u24 v8, 5, v7
v_sub_u32 v8, v6, v8
v_mul_u32_u24 v7, 40, v7
v_lshrrev_b32 v10, 1, v8
v_mul_u32_u24 v10, 20, v10
v_and_b32 v11, 1, v8
v_lshlrev_b32 v11, 3, v11
v_add_u32 v10, v10, v11
v_add_u32 v11, 4, v10
v_cmp_eq_u32 vcc, 4, v8
v_mov_b32 v6, 16
v_mov_b32 v12, 36
v_cndmask_b32 v10, v10, v6, vcc
v_cndmask_b32 v11, v11, v12, vcc
v_add_u32 v10, v10, v7
v_add_u32 v11, v11, v7
s_movk_i32 s33, 1280
v_mul_lo_u32 v10, v10, s33
v_mul_lo_u32 v11, v11, s33
v_add_u32 v10, v10, v9
v_add_u32 v11, v11, v9
buffer_load_ushort v16, v10, s[12:15], s36 offen offset:0
buffer_load_ushort v17, v10, s[12:15], s36 offen offset:1280
buffer_load_ushort v18, v10, s[12:15], s36 offen offset:2560
buffer_load_ushort v19, v10, s[12:15], s36 offen offset:3840
buffer_load_ushort v20, v11, s[12:15], s36 offen offset:0
buffer_load_ushort v21, v11, s[12:15], s36 offen offset:1280
buffer_load_ushort v22, v11, s[12:15], s36 offen offset:2560
buffer_load_ushort v23, v11, s[12:15], s36 offen offset:3840
buffer_load_ushort v24, v10, s[12:15], s36 offen offset:32
buffer_load_ushort v25, v10, s[12:15], s36 offen offset:1312
buffer_load_ushort v26, v10, s[12:15], s36 offen offset:2592
buffer_load_ushort v27, v10, s[12:15], s36 offen offset:3872
buffer_load_ushort v28, v11, s[12:15], s36 offen offset:32
buffer_load_ushort v29, v11, s[12:15], s36 offen offset:1312
buffer_load_ushort v30, v11, s[12:15], s36 offen offset:2592
buffer_load_ushort v31, v11, s[12:15], s36 offen offset:3872
buffer_load_ushort v32, v10, s[12:15], s36 offen offset:64
buffer_load_ushort v33, v10, s[12:15], s36 offen offset:1344
buffer_load_ushort v34, v10, s[12:15], s36 offen offset:2624
buffer_load_ushort v35, v10, s[12:15], s36 offen offset:3904
buffer_load_ushort v36, v11, s[12:15], s36 offen offset:64
buffer_load_ushort v37, v11, s[12:15], s36 offen offset:1344
buffer_load_ushort v38, v11, s[12:15], s36 offen offset:2624
buffer_load_ushort v39, v11, s[12:15], s36 offen offset:3904
buffer_load_ushort v40, v10, s[12:15], s36 offen offset:96
buffer_load_ushort v41, v10, s[12:15], s36 offen offset:1376
buffer_load_ushort v42, v10, s[12:15], s36 offen offset:2656
buffer_load_ushort v43, v10, s[12:15], s36 offen offset:3936
buffer_load_ushort v44, v11, s[12:15], s36 offen offset:96
buffer_load_ushort v45, v11, s[12:15], s36 offen offset:1376
buffer_load_ushort v46, v11, s[12:15], s36 offen offset:2656
buffer_load_ushort v47, v11, s[12:15], s36 offen offset:3936
buffer_load_ushort v48, v10, s[12:15], s37 offen offset:0
buffer_load_ushort v49, v10, s[12:15], s37 offen offset:1280
buffer_load_ushort v50, v10, s[12:15], s37 offen offset:2560
buffer_load_ushort v51, v10, s[12:15], s37 offen offset:3840
buffer_load_ushort v52, v11, s[12:15], s37 offen offset:0
buffer_load_ushort v53, v11, s[12:15], s37 offen offset:1280
buffer_load_ushort v54, v11, s[12:15], s37 offen offset:2560
buffer_load_ushort v55, v11, s[12:15], s37 offen offset:3840
s_nop 0
s_add_u32 s33, s32, 1
s_lshl_b32 s33, s33, 2
v_add_u32 v6, s33, v4
v_mul_u32_u24 v7, 205, v6
v_lshrrev_b32 v7, 10, v7
v_mul_u32_u24 v8, 5, v7
v_sub_u32 v8, v6, v8
v_mul_u32_u24 v7, 40, v7
v_lshrrev_b32 v10, 1, v8
v_mul_u32_u24 v10, 20, v10
v_and_b32 v11, 1, v8
v_lshlrev_b32 v11, 3, v11
v_add_u32 v10, v10, v11
v_add_u32 v11, 4, v10
v_cmp_eq_u32 vcc, 4, v8
v_mov_b32 v6, 16
v_mov_b32 v12, 36
v_cndmask_b32 v10, v10, v6, vcc
v_cndmask_b32 v11, v11, v12, vcc
v_add_u32 v10, v10, v7
v_add_u32 v11, v11, v7
s_movk_i32 s33, 1280
v_mul_lo_u32 v10, v10, s33
v_mul_lo_u32 v11, v11, s33
v_add_u32 v10, v10, v9
v_add_u32 v11, v11, v9
buffer_load_ushort v56, v10, s[12:15], s36 offen offset:0
buffer_load_ushort v57, v10, s[12:15], s36 offen offset:1280
buffer_load_ushort v58, v10, s[12:15], s36 offen offset:2560
buffer_load_ushort v59, v10, s[12:15], s36 offen offset:3840
buffer_load_ushort v60, v11, s[12:15], s36 offen offset:0
buffer_load_ushort v61, v11, s[12:15], s36 offen offset:1280
buffer_load_ushort v62, v11, s[12:15], s36 offen offset:2560
buffer_load_ushort v63, v11, s[12:15], s36 offen offset:3840
buffer_load_ushort v64, v10, s[12:15], s36 offen offset:32
buffer_load_ushort v65, v10, s[12:15], s36 offen offset:1312
buffer_load_ushort v66, v10, s[12:15], s36 offen offset:2592
buffer_load_ushort v67, v10, s[12:15], s36 offen offset:3872
buffer_load_ushort v68, v11, s[12:15], s36 offen offset:32
buffer_load_ushort v69, v11, s[12:15], s36 offen offset:1312
buffer_load_ushort v70, v11, s[12:15], s36 offen offset:2592
buffer_load_ushort v71, v11, s[12:15], s36 offen offset:3872
buffer_load_ushort v72, v10, s[12:15], s36 offen offset:64
buffer_load_ushort v73, v10, s[12:15], s36 offen offset:1344
buffer_load_ushort v74, v10, s[12:15], s36 offen offset:2624
buffer_load_ushort v75, v10, s[12:15], s36 offen offset:3904
buffer_load_ushort v76, v11, s[12:15], s36 offen offset:64
buffer_load_ushort v77, v11, s[12:15], s36 offen offset:1344
buffer_load_ushort v78, v11, s[12:15], s36 offen offset:2624
buffer_load_ushort v79, v11, s[12:15], s36 offen offset:3904
buffer_load_ushort v80, v10, s[12:15], s36 offen offset:96
buffer_load_ushort v81, v10, s[12:15], s36 offen offset:1376
buffer_load_ushort v82, v10, s[12:15], s36 offen offset:2656
buffer_load_ushort v83, v10, s[12:15], s36 offen offset:3936
buffer_load_ushort v84, v11, s[12:15], s36 offen offset:96
buffer_load_ushort v85, v11, s[12:15], s36 offen offset:1376
buffer_load_ushort v86, v11, s[12:15], s36 offen offset:2656
buffer_load_ushort v87, v11, s[12:15], s36 offen offset:3936
buffer_load_ushort v88, v10, s[12:15], s37 offen offset:0
buffer_load_ushort v89, v10, s[12:15], s37 offen offset:1280
buffer_load_ushort v90, v10, s[12:15], s37 offen offset:2560
buffer_load_ushort v91, v10, s[12:15], s37 offen offset:3840
buffer_load_ushort v92, v11, s[12:15], s37 offen offset:0
buffer_load_ushort v93, v11, s[12:15], s37 offen offset:1280
buffer_load_ushort v94, v11, s[12:15], s37 offen offset:2560
buffer_load_ushort v95, v11, s[12:15], s37 offen offset:3840
s_mul_i32 s34, s31, 102400
s_mul_i32 s33, s32, 5120
s_add_u32 s34, s34, s33
s_add_u32 s34, s34, 6291456
s_add_u32 s35, s34, 4096
s_add_u32 s39, s34, 8192
s_waitcnt vmcnt(0)
v_lshl_or_b32 v112, v17, 16, v16
v_lshl_or_b32 v113, v19, 16, v18
v_lshl_or_b32 v114, v21, 16, v20
v_lshl_or_b32 v115, v23, 16, v22
s_nop 0
buffer_store_dwordx4 v[112:115], v2, s[8:11], s34 offen offset:0 sc1
v_lshl_or_b32 v116, v25, 16, v24
v_lshl_or_b32 v117, v27, 16, v26
v_lshl_or_b32 v118, v29, 16, v28
v_lshl_or_b32 v119, v31, 16, v30
s_nop 0
buffer_store_dwordx4 v[116:119], v2, s[8:11], s34 offen offset:1024 sc1
v_lshl_or_b32 v120, v33, 16, v32
v_lshl_or_b32 v121, v35, 16, v34
v_lshl_or_b32 v122, v37, 16, v36
v_lshl_or_b32 v123, v39, 16, v38
s_nop 0
buffer_store_dwordx4 v[120:123], v2, s[8:11], s34 offen offset:2048 sc1
v_lshl_or_b32 v124, v41, 16, v40
v_lshl_or_b32 v125, v43, 16, v42
v_lshl_or_b32 v126, v45, 16, v44
v_lshl_or_b32 v127, v47, 16, v46
s_nop 0
buffer_store_dwordx4 v[124:127], v2, s[8:11], s34 offen offset:3072 sc1
v_lshl_or_b32 v128, v49, 16, v48
v_lshl_or_b32 v129, v51, 16, v50
v_lshl_or_b32 v130, v53, 16, v52
v_lshl_or_b32 v131, v55, 16, v54
s_nop 0
buffer_store_dwordx4 v[128:131], v2, s[8:11], s35 offen offset:0 sc1
v_lshl_or_b32 v132, v57, 16, v56
v_lshl_or_b32 v133, v59, 16, v58
v_lshl_or_b32 v134, v61, 16, v60
v_lshl_or_b32 v135, v63, 16, v62
s_nop 0
buffer_store_dwordx4 v[132:135], v2, s[8:11], s35 offen offset:1024 sc1
v_lshl_or_b32 v136, v65, 16, v64
v_lshl_or_b32 v137, v67, 16, v66
v_lshl_or_b32 v138, v69, 16, v68
v_lshl_or_b32 v139, v71, 16, v70
s_nop 0
buffer_store_dwordx4 v[136:139], v2, s[8:11], s35 offen offset:2048 sc1
v_lshl_or_b32 v140, v73, 16, v72
v_lshl_or_b32 v141, v75, 16, v74
v_lshl_or_b32 v142, v77, 16, v76
v_lshl_or_b32 v143, v79, 16, v78
s_nop 0
buffer_store_dwordx4 v[140:143], v2, s[8:11], s35 offen offset:3072 sc1
v_lshl_or_b32 v144, v81, 16, v80
v_lshl_or_b32 v145, v83, 16, v82
v_lshl_or_b32 v146, v85, 16, v84
v_lshl_or_b32 v147, v87, 16, v86
s_nop 0
buffer_store_dwordx4 v[144:147], v2, s[8:11], s39 offen offset:0 sc1
v_lshl_or_b32 v148, v89, 16, v88
v_lshl_or_b32 v149, v91, 16, v90
v_lshl_or_b32 v150, v93, 16, v92
v_lshl_or_b32 v151, v95, 16, v94
s_nop 0
buffer_store_dwordx4 v[148:151], v2, s[8:11], s39 offen offset:1024 sc1
L_pdone:
s_lshr_b32 s24, s2, 1
s_and_b32 s25, s2, 1
s_mul_i32 s26, s25, 10
s_add_u32 s26, s26, s6
s_mul_i32 s27, s24, 20480
s_lshl_b32 s28, s26, 10
s_add_u32 s27, s27, s28
s_add_u32 s27, s27, 16777216
v_mov_b32 v6, 0
v_mov_b32 v7, 0
buffer_store_dwordx4 v[100:103], v2, s[8:11], s27 offen sc1
v_dot2_f32_bf16 v6, v100, s62, v6
v_dot2_f32_bf16 v7, v100, v100, v7
v_dot2_f32_bf16 v6, v101, s62, v6
v_dot2_f32_bf16 v7, v101, v101, v7
v_dot2_f32_bf16 v6, v102, s62, v6
v_dot2_f32_bf16 v7, v102, v102, v7
v_dot2_f32_bf16 v6, v103, s62, v6
v_dot2_f32_bf16 v7, v103, v103, v7
s_add_u32 s27, s27, 4096
buffer_store_dwordx4 v[104:107], v2, s[8:11], s27 offen sc1
v_dot2_f32_bf16 v6, v104, s62, v6
v_dot2_f32_bf16 v7, v104, v104, v7
v_dot2_f32_bf16 v6, v105, s62, v6
v_dot2_f32_bf16 v7, v105, v105, v7
v_dot2_f32_bf16 v6, v106, s62, v6
v_dot2_f32_bf16 v7, v106, v106, v7
v_dot2_f32_bf16 v6, v107, s62, v6
v_dot2_f32_bf16 v7, v107, v107, v7
s_add_u32 s27, s27, 4096
s_cmp_ge_u32 s6, 2
s_cbranch_scc1 L_x3b_4
buffer_store_dwordx4 v[108:111], v2, s[8:11], s27 offen sc1
v_dot2_f32_bf16 v6, v108, s62, v6
v_dot2_f32_bf16 v7, v108, v108, v7
v_dot2_f32_bf16 v6, v109, s62, v6
v_dot2_f32_bf16 v7, v109, v109, v7
v_dot2_f32_bf16 v6, v110, s62, v6
v_dot2_f32_bf16 v7, v110, v110, v7
v_dot2_f32_bf16 v6, v111, s62, v6
v_dot2_f32_bf16 v7, v111, v111, v7
s_add_u32 s27, s27, 4096
L_x3b_4:
s_nop 2
v_mov_b32 v8, v6
s_nop 1
v_permlane32_swap_b32 v6, v8
s_nop 1
v_add_f32 v6, v6, v8
v_mov_b32 v8, v6
s_nop 1
v_permlane16_swap_b32 v6, v8
s_nop 1
v_add_f32 v6, v6, v8
v_mov_b32 v8, v7
s_nop 1
v_permlane32_swap_b32 v7, v8
s_nop 1
v_add_f32 v7, v7, v8
v_mov_b32 v8, v7
s_nop 1
v_permlane16_swap_b32 v7, v8
s_nop 1
v_add_f32 v7, v7, v8
s_lshl_b32 s27, s24, 10
s_lshl_b32 s28, s25, 2
s_add_u32 s28, s28, s6
s_lshl_b32 s28, s28, 7
s_add_u32 s27, s27, s28
s_add_u32 s27, s27, 52428800
v_lshlrev_b32 v8, 3, v3
s_mov_b64 exec, 0xffff
buffer_store_dwordx2 v[6:7], v8, s[8:11], s27 offen sc1
s_mov_b64 exec, -1
s_and_b32 s27, s2, 15
s_or_b32 s27, s27, s6
s_cmp_lg_u32 s27, 0
s_cbranch_scc1 L_zc_5
s_lshr_b32 s27, s2, 4
s_lshl_b32 s27, s27, 8
s_add_u32 s27, s27, 53477376
v_mov_b32 v8, 0
v_mov_b32 v9, s27
s_mov_b64 exec, 1
buffer_store_dword v8, v9, s[8:11], 0 offen sc1
s_mov_b64 exec, -1
L_zc_5:
v_readfirstlane_b32 s63, v250
s_add_u32 s63, s63, 1
s_waitcnt vmcnt(0)
s_barrier
s_cmp_lg_u32 s6, 0
s_cbranch_scc1 L_gb_6
s_lshl_b32 s27, s5, 8
s_lshl_b32 s28, s4, 2
s_add_u32 s27, s27, s28
s_add_u32 s27, s27, 53542912
s_lshr_b32 s28, s2, 4
s_lshl_b32 s28, s28, 8
s_and_b32 s29, s2, 15
s_lshl_b32 s29, s29, 2
s_add_u32 s28, s28, s29
s_add_u32 s28, s28, 53547008
v_mov_b32 v9, s27
v_mov_b32 v7, s28
v_cmp_eq_u32 vcc, 1, v1
v_mov_b32 v8, s63
v_cndmask_b32 v9, v9, v7, vcc
s_mov_b64 exec, 3
buffer_store_dword v8, v9, s[8:11], 0 offen sc1
s_mov_b64 exec, -1
s_and_b32 s27, s2, 15
s_and_b32 s28, s27, 3
s_lshl_b32 s28, s28, 6
s_lshr_b32 s27, s27, 2
s_lshl_b32 s27, s27, 2
s_add_u32 s27, s27, s28
v_mov_b32 v8, 1
v_mov_b32 v9, s27
s_mov_b64 exec, 1
buffer_atomic_add v8, v9, s[16:19], 0 offen sc1
s_mov_b64 exec, -1
s_mov_b32 s4, s88
s_mov_b32 s5, s89
s_mov_b32 s20, s90
v_min_u32 v7, 9, v3
v_lshlrev_b32 v7, 2, v7
s_lshl_b32 s27, s5, 8
s_add_u32 s27, s27, 53542912
v_add_u32 v7, s27, v7
v_lshlrev_b32 v8, 2, v3
s_lshl_b32 s27, s4, 8
s_add_u32 s27, s27, 53547008
v_add_u32 v8, s27, v8
v_and_b32 v9, 1, v3
v_lshlrev_b32 v9, 2, v9
s_max_u32 s28, s4, 1
s_sub_u32 s28, s28, 1
s_lshl_b32 s28, s28, 8
s_add_u32 s28, s28, 53547064
v_add_u32 v9, s28, v9
v_cndmask_b32 v9, v8, v9, s[68:69]
v_cndmask_b32 v9, v9, v7, s[64:65]
s_mov_b32 s22, 0
L_gp_7:
buffer_load_dword v6, v9, s[8:11], 0 offen sc1
s_waitcnt vmcnt(0)
v_cmp_ne_u32 vcc, s63, v6
s_cbranch_vccz L_gd_8
s_add_u32 s22, s22, 1
s_cmp_lt_u32 s22, 40000
s_cbranch_scc1 L_gp_7
L_gd_8:
L_gb_6:
s_mov_b32 s4, s88
s_mov_b32 s5, s89
s_mov_b32 s20, s90
s_barrier
s_mov_b32 s4, s88
s_mov_b32 s5, s89
s_mov_b32 s20, s90
s_mul_i32 s30, s5, 163840
s_add_u32 s30, s30, 0
s_lshl_b32 s31, s2, 10
s_add_u32 s31, s31, 11010048
s_lshl_b32 s32, s4, 3
s_lshl_b32 s33, s6, 1
s_add_u32 s32, s32, s33
s_add_u32 s33, s32, 1
s_lshl_b32 s34, s4, 3
s_max_u32 s34, s34, 1
s_sub_u32 s34, s34, 1
s_lshl_b32 s35, s6, 1
s_min_u32 s35, s35, 4
s_lshl_b32 s36, s6, 1
s_add_u32 s36, s36, 1
s_min_u32 s36, s36, 4
s_mul_i32 s24, s32, 20480
v_add_u32 v10, s24, v2
s_mul_i32 s24, s33, 20480
v_add_u32 v11, s24, v2
s_mul_i32 s24, s34, 20480
v_add_u32 v12, s24, v2
s_mov_b32 s45, 16777216
buffer_load_dwordx4 a[0:3], v10, s[8:11], s45 offen offset:0 sc1
buffer_load_dwordx4 a[4:7], v11, s[8:11], s45 offen offset:0 sc1
buffer_load_dwordx4 a[8:11], v12, s[8:11], s45 offen offset:0 sc1
buffer_load_dwordx4 a[12:15], v10, s[8:11], s45 offen offset:1024 sc1
buffer_load_dwordx4 a[16:19], v11, s[8:11], s45 offen offset:1024 sc1
buffer_load_dwordx4 a[20:23], v12, s[8:11], s45 offen offset:1024 sc1
buffer_load_dwordx4 a[24:27], v10, s[8:11], s45 offen offset:2048 sc1
buffer_load_dwordx4 a[28:31], v11, s[8:11], s45 offen offset:2048 sc1
buffer_load_dwordx4 a[32:35], v12, s[8:11], s45 offen offset:2048 sc1
buffer_load_dwordx4 a[36:39], v10, s[8:11], s45 offen offset:3072 sc1
buffer_load_dwordx4 a[40:43], v11, s[8:11], s45 offen offset:3072 sc1
buffer_load_dwordx4 a[44:47], v12, s[8:11], s45 offen offset:3072 sc1
s_add_u32 s45, s45, 4096
buffer_load_dwordx4 a[48:51], v10, s[8:11], s45 offen offset:0 sc1
buffer_load_dwordx4 a[52:55], v11, s[8:11], s45 offen offset:0 sc1
buffer_load_dwordx4 a[56:59], v12, s[8:11], s45 offen offset:0 sc1
s_cmp_lt_u32 s6, 2
s_cbranch_scc1 L_cs_9
v_and_b32 v5, 127, v0
v_lshlrev_b32 v5, 2, v5
s_mul_i32 s24, s5, 10240
s_add_u32 s25, s24, 10747904
s_add_u32 s24, s24, 10485760
buffer_load_dword v16, v5, s[8:11], s24 offen offset:0
buffer_load_dword v17, v5, s[8:11], s24 offen offset:512
buffer_load_dword v18, v5, s[8:11], s24 offen offset:1024
buffer_load_dword v19, v5, s[8:11], s24 offen offset:1536
buffer_load_dword v20, v5, s[8:11], s24 offen offset:2048
buffer_load_dword v21, v5, s[8:11], s24 offen offset:2560
buffer_load_dword v22, v5, s[8:11], s24 offen offset:3072
buffer_load_dword v23, v5, s[8:11], s24 offen offset:3584
s_add_u32 s24, s24, 4096
buffer_load_dword v24, v5, s[8:11], s24 offen offset:0
buffer_load_dword v25, v5, s[8:11], s24 offen offset:512
buffer_load_dword v26, v5, s[8:11], s24 offen offset:1024
buffer_load_dword v27, v5, s[8:11], s24 offen offset:1536
buffer_load_dword v28, v5, s[8:11], s24 offen offset:2048
buffer_load_dword v29, v5, s[8:11], s24 offen offset:2560
buffer_load_dword v30, v5, s[8:11], s24 offen offset:3072
buffer_load_dword v31, v5, s[8:11], s24 offen offset:3584
s_add_u32 s24, s24, 4096
buffer_load_dword v32, v5, s[8:11], s24 offen offset:0
buffer_load_dword v33, v5, s[8:11], s24 offen offset:512
buffer_load_dword v34, v5, s[8:11], s24 offen offset:1024
buffer_load_dword v35, v5, s[8:11], s24 offen offset:1536
buffer_load_dword v36, v5, s[8:11], s25 offen offset:0
buffer_load_dword v37, v5, s[8:11], s25 offen offset:512
buffer_load_dword v38, v5, s[8:11], s25 offen offset:1024
buffer_load_dword v39, v5, s[8:11], s25 offen offset:1536
buffer_load_dword v40, v5, s[8:11], s25 offen offset:2048
buffer_load_dword v41, v5, s[8:11], s25 offen offset:2560
buffer_load_dword v42, v5, s[8:11], s25 offen offset:3072
buffer_load_dword v43, v5, s[8:11], s25 offen offset:3584
s_add_u32 s25, s25, 4096
buffer_load_dword v44, v5, s[8:11], s25 offen offset:0
buffer_load_dword v45, v5, s[8:11], s25 offen offset:512
buffer_load_dword v46, v5, s[8:11], s25 offen offset:1024
buffer_load_dword v47, v5, s[8:11], s25 offen offset:1536
buffer_load_dword v48, v5, s[8:11], s25 offen offset:2048
buffer_load_dword v49, v5, s[8:11], s25 offen offset:2560
buffer_load_dword v50, v5, s[8:11], s25 offen offset:3072
buffer_load_dword v51, v5, s[8:11], s25 offen offset:3584
s_add_u32 s25, s25, 4096
buffer_load_dword v52, v5, s[8:11], s25 offen offset:0
buffer_load_dword v53, v5, s[8:11], s25 offen offset:512
buffer_load_dword v54, v5, s[8:11], s25 offen offset:1024
buffer_load_dword v55, v5, s[8:11], s25 offen offset:1536
L_cs_9:
s_mul_i32 s24, s6, 20480
s_add_u32 s25, s30, s24
s_mov_b32 m0, s24
s_nop 0
buffer_load_dwordx4 v2, s[8:11], s25 offen offset:0 lds
buffer_load_dwordx4 v2, s[8:11], s25 offen offset:1024 lds
buffer_load_dwordx4 v2, s[8:11], s25 offen offset:2048 lds
buffer_load_dwordx4 v2, s[8:11], s25 offen offset:3072 lds
s_add_u32 s24, s24, 4096
s_add_u32 s25, s25, 4096
s_mov_b32 m0, s24
s_nop 0
buffer_load_dwordx4 v2, s[8:11], s25 offen offset:0 lds
buffer_load_dwordx4 v2, s[8:11], s25 offen offset:1024 lds
buffer_load_dwordx4 v2, s[8:11], s25 offen offset:2048 lds
buffer_load_dwordx4 v2, s[8:11], s25 offen offset:3072 lds
s_add_u32 s24, s24, 4096
s_add_u32 s25, s25, 4096
s_mov_b32 m0, s24
s_nop 0
buffer_load_dwordx4 v2, s[8:11], s25 offen offset:0 lds
buffer_load_dwordx4 v2, s[8:11], s25 offen offset:1024 lds
buffer_load_dwordx4 v2, s[8:11], s25 offen offset:2048 lds
buffer_load_dwordx4 v2, s[8:11], s25 offen offset:3072 lds
s_add_u32 s24, s24, 4096
s_add_u32 s25, s25, 4096
s_mov_b32 m0, s24
s_nop 0
buffer_load_dwordx4 v2, s[8:11], s25 offen offset:0 lds
buffer_load_dwordx4 v2, s[8:11], s25 offen offset:1024 lds
buffer_load_dwordx4 v2, s[8:11], s25 offen offset:2048 lds
buffer_load_dwordx4 v2, s[8:11], s25 offen offset:3072 lds
s_add_u32 s24, s24, 4096
s_add_u32 s25, s25, 4096
s_mov_b32 m0, s24
s_nop 0
buffer_load_dwordx4 v2, s[8:11], s25 offen offset:0 lds
buffer_load_dwordx4 v2, s[8:11], s25 offen offset:1024 lds
buffer_load_dwordx4 v2, s[8:11], s25 offen offset:2048 lds
buffer_load_dwordx4 v2, s[8:11], s25 offen offset:3072 lds
s_mul_i32 s24, s6, 20480
s_add_u32 s24, s24, 81920
s_add_u32 s25, s30, s24
s_mov_b32 m0, s24
s_nop 0
buffer_load_dwordx4 v2, s[8:11], s25 offen offset:0 lds
buffer_load_dwordx4 v2, s[8:11], s25 offen offset:1024 lds
buffer_load_dwordx4 v2, s[8:11], s25 offen offset:2048 lds
buffer_load_dwordx4 v2, s[8:11], s25 offen offset:3072 lds
s_add_u32 s24, s24, 4096
s_add_u32 s25, s25, 4096
s_mov_b32 m0, s24
s_nop 0
buffer_load_dwordx4 v2, s[8:11], s25 offen offset:0 lds
buffer_load_dwordx4 v2, s[8:11], s25 offen offset:1024 lds
buffer_load_dwordx4 v2, s[8:11], s25 offen offset:2048 lds
buffer_load_dwordx4 v2, s[8:11], s25 offen offset:3072 lds
s_add_u32 s24, s24, 4096
s_add_u32 s25, s25, 4096
s_mov_b32 m0, s24
s_nop 0
buffer_load_dwordx4 v2, s[8:11], s25 offen offset:0 lds
buffer_load_dwordx4 v2, s[8:11], s25 offen offset:1024 lds
buffer_load_dwordx4 v2, s[8:11], s25 offen offset:2048 lds
buffer_load_dwordx4 v2, s[8:11], s25 offen offset:3072 lds
s_add_u32 s24, s24, 4096
s_add_u32 s25, s25, 4096
s_mov_b32 m0, s24
s_nop 0
buffer_load_dwordx4 v2, s[8:11], s25 offen offset:0 lds
buffer_load_dwordx4 v2, s[8:11], s25 offen offset:1024 lds
buffer_load_dwordx4 v2, s[8:11], s25 offen offset:2048 lds
buffer_load_dwordx4 v2, s[8:11], s25 offen offset:3072 lds
s_add_u32 s24, s24, 4096
s_add_u32 s25, s25, 4096
s_mov_b32 m0, s24
s_nop 0
buffer_load_dwordx4 v2, s[8:11], s25 offen offset:0 lds
buffer_load_dwordx4 v2, s[8:11], s25 offen offset:1024 lds
buffer_load_dwordx4 v2, s[8:11], s25 offen offset:2048 lds
buffer_load_dwordx4 v2, s[8:11], s25 offen offset:3072 lds
s_cmp_lt_u32 s6, 2
s_cbranch_scc1 L_cs_10
s_waitcnt vmcnt(40)
v_add_f32 v16, v16, v17
v_add_f32 v16, v16, v18
v_add_f32 v16, v16, v19
v_add_f32 v16, v16, v20
v_add_f32 v16, v16, v21
v_add_f32 v16, v16, v22
v_add_f32 v16, v16, v23
v_add_f32 v16, v16, v24
v_add_f32 v16, v16, v25
v_add_f32 v16, v16, v26
v_add_f32 v16, v16, v27
v_add_f32 v16, v16, v28
v_add_f32 v16, v16, v29
v_add_f32 v16, v16, v30
v_add_f32 v16, v16, v31
v_add_f32 v16, v16, v32
v_add_f32 v16, v16, v33
v_add_f32 v16, v16, v34
v_add_f32 v16, v16, v35
buffer_store_dword v16, v5, s[8:11], s31 offen offset:0 sc1
v_add_f32 v36, v36, v37
v_add_f32 v36, v36, v38
v_add_f32 v36, v36, v39
v_add_f32 v36, v36, v40
v_add_f32 v36, v36, v41
v_add_f32 v36, v36, v42
v_add_f32 v36, v36, v43
v_add_f32 v36, v36, v44
v_add_f32 v36, v36, v45
v_add_f32 v36, v36, v46
v_add_f32 v36, v36, v47
v_add_f32 v36, v36, v48
v_add_f32 v36, v36, v49
v_add_f32 v36, v36, v50
v_add_f32 v36, v36, v51
v_add_f32 v36, v36, v52
v_add_f32 v36, v36, v53
v_add_f32 v36, v36, v54
v_add_f32 v36, v36, v55
buffer_store_dword v36, v5, s[8:11], s31 offen offset:512 sc1
s_waitcnt vmcnt(22)
s_branch L_cs_11
L_cs_10:
s_waitcnt vmcnt(20)
L_cs_11:
s_barrier
v_lshlrev_b32 v5, 8, v4
v_lshlrev_b32 v6, 3, v3
v_add_u32 v5, v5, v6
s_lshl_b32 s46, s32, 10
s_add_u32 s46, s46, 52428800
s_lshl_b32 s47, s33, 10
s_add_u32 s47, s47, 52428800
s_lshl_b32 s48, s34, 10
s_add_u32 s48, s48, 52428800
v_lshlrev_b32 v6, 4, v4
s_add_u32 s49, s31, 0
s_lshl_b32 s50, s35, 6
s_add_u32 s50, s50, s49
s_lshl_b32 s51, s36, 6
s_add_u32 s51, s51, s49
s_and_b32 s52, s88, 3
s_and_b32 s53, s89, 1
s_lshl_b32 s53, s53, 2
s_add_u32 s53, s53, s52
s_lshr_b32 s54, s89, 1
s_mul_i32 s56, s54, 102400
s_mul_i32 s60, s53, 12800
s_add_u32 s56, s56, s60
s_mul_i32 s60, s6, 3200
s_add_u32 s56, s56, s60
s_add_u32 s56, s56, 6291456
s_mul_i32 s57, s89, 143360
s_mul_i32 s60, s52, 35840
s_add_u32 s57, s57, s60
s_mul_i32 s60, s6, 8960
s_add_u32 s57, s57, s60
s_add_u32 s57, s57, 3145728
v_mov_b32 v13, v2
s_lshl_b32 s25, s35, 10
v_add_u32 v14, s25, v2
s_lshl_b32 s25, s36, 10
v_add_u32 v15, s25, v2
v_lshlrev_b32 v252, 2, v1
ds_read_b128 v[88:91], v13 offset:0
ds_read_b128 v[92:95], v13 offset:1024
ds_read_b128 v[96:99], v13 offset:2048
ds_read_b128 v[100:103], v13 offset:3072
ds_read_b128 v[104:107], v13 offset:4096
ds_read_b128 v[108:111], v13 offset:5120
ds_read_b128 v[112:115], v13 offset:6144
ds_read_b128 v[116:119], v13 offset:7168
ds_read_b128 v[120:123], v14 offset:0
ds_read_b128 v[124:127], v15 offset:0
s_waitcnt vmcnt(52) lgkmcnt(0)
v_mfma_f32_16x16x32_bf16 v[16:19], v[88:91], a[0:3], 0
ds_read_b128 v[128:131], v13 offset:8192
v_mfma_f32_16x16x32_bf16 v[48:51], v[88:91], a[4:7], 0
ds_read_b128 v[132:135], v13 offset:9216
buffer_load_dwordx4 a[60:63], v10, s[8:11], s45 offen offset:1024 sc1
v_mfma_f32_16x16x32_bf16 v[20:23], v[92:95], a[0:3], 0
ds_read_b128 v[136:139], v13 offset:10240
v_mfma_f32_16x16x32_bf16 v[52:55], v[92:95], a[4:7], 0
ds_read_b128 v[140:143], v13 offset:11264
v_mfma_f32_16x16x32_bf16 v[24:27], v[96:99], a[0:3], 0
ds_read_b128 v[144:147], v13 offset:12288
v_mfma_f32_16x16x32_bf16 v[56:59], v[96:99], a[4:7], 0
ds_read_b128 v[148:151], v13 offset:13312
v_mfma_f32_16x16x32_bf16 v[28:31], v[100:103], a[0:3], 0
ds_read_b128 v[152:155], v13 offset:14336
v_mfma_f32_16x16x32_bf16 v[60:63], v[100:103], a[4:7], 0
ds_read_b128 v[156:159], v13 offset:15360
buffer_load_dwordx4 a[64:67], v11, s[8:11], s45 offen offset:1024 sc1
v_mfma_f32_16x16x32_bf16 v[32:35], v[104:107], a[0:3], 0
ds_read_b128 v[160:163], v14 offset:8192
v_mfma_f32_16x16x32_bf16 v[64:67], v[104:107], a[4:7], 0
ds_read_b128 v[164:167], v15 offset:8192
v_mfma_f32_16x16x32_bf16 v[36:39], v[108:111], a[0:3], 0
v_mfma_f32_16x16x32_bf16 v[68:71], v[108:111], a[4:7], 0
v_mfma_f32_16x16x32_bf16 v[40:43], v[112:115], a[0:3], 0
v_mfma_f32_16x16x32_bf16 v[72:75], v[112:115], a[4:7], 0
buffer_load_dwordx4 a[68:71], v12, s[8:11], s45 offen offset:1024 sc1
v_mfma_f32_16x16x32_bf16 v[44:47], v[116:119], a[0:3], 0
v_mfma_f32_16x16x32_bf16 v[76:79], v[116:119], a[4:7], 0
v_mfma_f32_16x16x32_bf16 v[80:83], v[120:123], a[8:11], 0
v_mfma_f32_16x16x32_bf16 v[84:87], v[124:127], a[8:11], 0
s_waitcnt vmcnt(52) lgkmcnt(0)
v_mfma_f32_16x16x32_bf16 v[16:19], v[128:131], a[12:15], v[16:19]
ds_read_b128 v[88:91], v13 offset:16384
v_mfma_f32_16x16x32_bf16 v[48:51], v[128:131], a[16:19], v[48:51]
ds_read_b128 v[92:95], v13 offset:17408
buffer_load_dwordx4 a[72:75], v10, s[8:11], s45 offen offset:2048 sc1
v_mfma_f32_16x16x32_bf16 v[20:23], v[132:135], a[12:15], v[20:23]
ds_read_b128 v[96:99], v13 offset:18432
v_mfma_f32_16x16x32_bf16 v[52:55], v[132:135], a[16:19], v[52:55]
ds_read_b128 v[100:103], v13 offset:19456
v_mfma_f32_16x16x32_bf16 v[24:27], v[136:139], a[12:15], v[24:27]
ds_read_b128 v[104:107], v13 offset:20480
buffer_load_dwordx4 a[76:79], v11, s[8:11], s45 offen offset:2048 sc1
v_mfma_f32_16x16x32_bf16 v[56:59], v[136:139], a[16:19], v[56:59]
ds_read_b128 v[108:111], v13 offset:21504
v_mfma_f32_16x16x32_bf16 v[28:31], v[140:143], a[12:15], v[28:31]
ds_read_b128 v[112:115], v13 offset:22528
v_mfma_f32_16x16x32_bf16 v[60:63], v[140:143], a[16:19], v[60:63]
ds_read_b128 v[116:119], v13 offset:23552
v_mfma_f32_16x16x32_bf16 v[32:35], v[144:147], a[12:15], v[32:35]
ds_read_b128 v[120:123], v14 offset:16384
buffer_load_dwordx4 a[80:83], v12, s[8:11], s45 offen offset:2048 sc1
v_mfma_f32_16x16x32_bf16 v[64:67], v[144:147], a[16:19], v[64:67]
ds_read_b128 v[124:127], v15 offset:16384
v_mfma_f32_16x16x32_bf16 v[36:39], v[148:151], a[12:15], v[36:39]
v_mfma_f32_16x16x32_bf16 v[68:71], v[148:151], a[16:19], v[68:71]
buffer_load_dwordx2 v[168:169], v5, s[8:11], s46 offen sc1
v_mfma_f32_16x16x32_bf16 v[40:43], v[152:155], a[12:15], v[40:43]
v_mfma_f32_16x16x32_bf16 v[72:75], v[152:155], a[16:19], v[72:75]
v_mfma_f32_16x16x32_bf16 v[44:47], v[156:159], a[12:15], v[44:47]
v_mfma_f32_16x16x32_bf16 v[76:79], v[156:159], a[16:19], v[76:79]
buffer_load_dwordx2 v[170:171], v5, s[8:11], s46 offen offset:128 sc1
v_mfma_f32_16x16x32_bf16 v[80:83], v[160:163], a[20:23], v[80:83]
v_mfma_f32_16x16x32_bf16 v[84:87], v[164:167], a[20:23], v[84:87]
s_waitcnt vmcnt(54) lgkmcnt(0)
v_mfma_f32_16x16x32_bf16 v[16:19], v[88:91], a[24:27], v[16:19]
ds_read_b128 v[128:131], v13 offset:24576
v_mfma_f32_16x16x32_bf16 v[48:51], v[88:91], a[28:31], v[48:51]
ds_read_b128 v[132:135], v13 offset:25600
buffer_load_dwordx4 a[84:87], v10, s[8:11], s45 offen offset:3072 sc1
v_mfma_f32_16x16x32_bf16 v[20:23], v[92:95], a[24:27], v[20:23]
ds_read_b128 v[136:139], v13 offset:26624
v_mfma_f32_16x16x32_bf16 v[52:55], v[92:95], a[28:31], v[52:55]
ds_read_b128 v[140:143], v13 offset:27648
v_mfma_f32_16x16x32_bf16 v[24:27], v[96:99], a[24:27], v[24:27]
ds_read_b128 v[144:147], v13 offset:28672
buffer_load_dwordx4 a[88:91], v11, s[8:11], s45 offen offset:3072 sc1
v_mfma_f32_16x16x32_bf16 v[56:59], v[96:99], a[28:31], v[56:59]
ds_read_b128 v[148:151], v13 offset:29696
v_mfma_f32_16x16x32_bf16 v[28:31], v[100:103], a[24:27], v[28:31]
ds_read_b128 v[152:155], v13 offset:30720
v_mfma_f32_16x16x32_bf16 v[60:63], v[100:103], a[28:31], v[60:63]
ds_read_b128 v[156:159], v13 offset:31744
v_mfma_f32_16x16x32_bf16 v[32:35], v[104:107], a[24:27], v[32:35]
ds_read_b128 v[160:163], v14 offset:24576
buffer_load_dwordx4 a[92:95], v12, s[8:11], s45 offen offset:3072 sc1
v_mfma_f32_16x16x32_bf16 v[64:67], v[104:107], a[28:31], v[64:67]
ds_read_b128 v[164:167], v15 offset:24576
v_mfma_f32_16x16x32_bf16 v[36:39], v[108:111], a[24:27], v[36:39]
s_lshl_b32 s24, s6, 5
s_add_u32 s24, s24, 16
v_mfma_f32_16x16x32_bf16 v[68:71], v[108:111], a[28:31], v[68:71]
buffer_load_dwordx2 v[172:173], v5, s[8:11], s47 offen sc1
v_add_u32 v245, s24, v3
v_mul_u32_u24 v7, 48, v245
v_mfma_f32_16x16x32_bf16 v[40:43], v[112:115], a[24:27], v[40:43]
v_mul_u32_u24 v8, 80, v245
v_add_u32 v8, 27648, v8
v_mfma_f32_16x16x32_bf16 v[72:75], v[112:115], a[28:31], v[72:75]
v_add_u32 v245, 0, v4
v_mul_u32_u24 v246, 13, v245
v_mfma_f32_16x16x32_bf16 v[44:47], v[116:119], a[24:27], v[44:47]
v_lshrrev_b32 v246, 6, v246
v_mul_u32_u24 v247, 5, v246
v_mfma_f32_16x16x32_bf16 v[76:79], v[116:119], a[28:31], v[76:79]
buffer_load_dwordx2 v[174:175], v5, s[8:11], s47 offen offset:128 sc1
v_sub_u32 v247, v245, v247
v_add_u32 v248, -2, v246
v_mfma_f32_16x16x32_bf16 v[80:83], v[120:123], a[32:35], v[80:83]
v_cmp_le_u32 vcc, 4, v246
s_nop 1
v_mfma_f32_16x16x32_bf16 v[84:87], v[124:127], a[32:35], v[84:87]
v_cndmask_b32 v249, v246, v248, vcc
v_mul_u32_u24 v249, 6912, v249
s_waitcnt vmcnt(56) lgkmcnt(0)
v_mfma_f32_16x16x32_bf16 v[16:19], v[128:131], a[36:39], v[16:19]
ds_read_b128 v[88:91], v13 offset:32768
v_mfma_f32_16x16x32_bf16 v[48:51], v[128:131], a[40:43], v[48:51]
ds_read_b128 v[92:95], v13 offset:33792
s_add_u32 s45, s45, 4096
buffer_load_dwordx4 a[96:99], v10, s[8:11], s45 offen offset:0 sc1
v_mfma_f32_16x16x32_bf16 v[20:23], v[132:135], a[36:39], v[20:23]
ds_read_b128 v[96:99], v13 offset:34816
v_mfma_f32_16x16x32_bf16 v[52:55], v[132:135], a[40:43], v[52:55]
ds_read_b128 v[100:103], v13 offset:35840
v_mfma_f32_16x16x32_bf16 v[24:27], v[136:139], a[36:39], v[24:27]
ds_read_b128 v[104:107], v13 offset:36864
buffer_load_dwordx4 a[100:103], v11, s[8:11], s45 offen offset:0 sc1
v_mfma_f32_16x16x32_bf16 v[56:59], v[136:139], a[40:43], v[56:59]
ds_read_b128 v[108:111], v13 offset:37888
v_mfma_f32_16x16x32_bf16 v[28:31], v[140:143], a[36:39], v[28:31]
ds_read_b128 v[112:115], v13 offset:38912
v_mfma_f32_16x16x32_bf16 v[60:63], v[140:143], a[40:43], v[60:63]
ds_read_b128 v[116:119], v13 offset:39936
v_mfma_f32_16x16x32_bf16 v[32:35], v[144:147], a[36:39], v[32:35]
ds_read_b128 v[120:123], v14 offset:32768
buffer_load_dwordx4 a[104:107], v12, s[8:11], s45 offen offset:0 sc1
v_mfma_f32_16x16x32_bf16 v[64:67], v[144:147], a[40:43], v[64:67]
ds_read_b128 v[124:127], v15 offset:32768
v_mfma_f32_16x16x32_bf16 v[36:39], v[148:151], a[36:39], v[36:39]
v_lshl_add_u32 v232, v247, 3, v249
v_add_u32 v232, v232, v7
v_mfma_f32_16x16x32_bf16 v[68:71], v[148:151], a[40:43], v[68:71]
buffer_load_dwordx2 v[176:177], v5, s[8:11], s48 offen sc1
v_add_u32 v245, 4, v4
v_mul_u32_u24 v246, 13, v245
v_mfma_f32_16x16x32_bf16 v[40:43], v[152:155], a[36:39], v[40:43]
v_lshrrev_b32 v246, 6, v246
v_mul_u32_u24 v247, 5, v246
v_mfma_f32_16x16x32_bf16 v[72:75], v[152:155], a[40:43], v[72:75]
v_sub_u32 v247, v245, v247
v_add_u32 v248, -2, v246
v_mfma_f32_16x16x32_bf16 v[44:47], v[156:159], a[36:39], v[44:47]
v_cmp_le_u32 vcc, 4, v246
s_nop 1
v_mfma_f32_16x16x32_bf16 v[76:79], v[156:159], a[40:43], v[76:79]
buffer_load_dwordx2 v[178:179], v5, s[8:11], s48 offen offset:128 sc1
v_cndmask_b32 v249, v246, v248, vcc
v_mul_u32_u24 v249, 6912, v249
v_mfma_f32_16x16x32_bf16 v[80:83], v[160:163], a[44:47], v[80:83]
v_lshl_add_u32 v233, v247, 3, v249
v_add_u32 v233, v233, v7
v_mfma_f32_16x16x32_bf16 v[84:87], v[164:167], a[44:47], v[84:87]
v_add_u32 v245, 8, v4
v_mul_u32_u24 v246, 13, v245
s_waitcnt vmcnt(58) lgkmcnt(0)
v_mfma_f32_16x16x32_bf16 v[16:19], v[88:91], a[48:51], v[16:19]
ds_read_b128 v[128:131], v13 offset:40960
v_mfma_f32_16x16x32_bf16 v[48:51], v[88:91], a[52:55], v[48:51]
ds_read_b128 v[132:135], v13 offset:41984
buffer_load_dwordx4 a[108:111], v10, s[8:11], s45 offen offset:1024 sc1
v_mfma_f32_16x16x32_bf16 v[20:23], v[92:95], a[48:51], v[20:23]
ds_read_b128 v[136:139], v13 offset:43008
v_mfma_f32_16x16x32_bf16 v[52:55], v[92:95], a[52:55], v[52:55]
ds_read_b128 v[140:143], v13 offset:44032
v_mfma_f32_16x16x32_bf16 v[24:27], v[96:99], a[48:51], v[24:27]
ds_read_b128 v[144:147], v13 offset:45056
v_mfma_f32_16x16x32_bf16 v[56:59], v[96:99], a[52:55], v[56:59]
ds_read_b128 v[148:151], v13 offset:46080
v_mfma_f32_16x16x32_bf16 v[28:31], v[100:103], a[48:51], v[28:31]
ds_read_b128 v[152:155], v13 offset:47104
v_mfma_f32_16x16x32_bf16 v[60:63], v[100:103], a[52:55], v[60:63]
ds_read_b128 v[156:159], v13 offset:48128
buffer_load_dwordx4 a[112:115], v11, s[8:11], s45 offen offset:1024 sc1
v_mfma_f32_16x16x32_bf16 v[32:35], v[104:107], a[48:51], v[32:35]
ds_read_b128 v[160:163], v14 offset:40960
v_mfma_f32_16x16x32_bf16 v[64:67], v[104:107], a[52:55], v[64:67]
ds_read_b128 v[164:167], v15 offset:40960
v_mfma_f32_16x16x32_bf16 v[36:39], v[108:111], a[48:51], v[36:39]
v_lshrrev_b32 v246, 6, v246
v_mul_u32_u24 v247, 5, v246
v_mfma_f32_16x16x32_bf16 v[68:71], v[108:111], a[52:55], v[68:71]
v_sub_u32 v247, v245, v247
v_add_u32 v248, -2, v246
v_mfma_f32_16x16x32_bf16 v[40:43], v[112:115], a[48:51], v[40:43]
v_cmp_le_u32 vcc, 4, v246
s_nop 1
v_mfma_f32_16x16x32_bf16 v[72:75], v[112:115], a[52:55], v[72:75]
buffer_load_dwordx4 a[116:119], v12, s[8:11], s45 offen offset:1024 sc1
v_cndmask_b32 v249, v246, v248, vcc
v_mul_u32_u24 v249, 6912, v249
v_mfma_f32_16x16x32_bf16 v[44:47], v[116:119], a[48:51], v[44:47]
v_lshl_add_u32 v234, v247, 3, v249
v_add_u32 v234, v234, v7
v_mfma_f32_16x16x32_bf16 v[76:79], v[116:119], a[52:55], v[76:79]
v_and_b32 v248, 1, v246
v_mul_u32_u24 v248, 11520, v248
v_mfma_f32_16x16x32_bf16 v[80:83], v[120:123], a[56:59], v[80:83]
v_lshl_add_u32 v238, v247, 4, v248
v_add_u32 v238, v238, v8
v_mfma_f32_16x16x32_bf16 v[84:87], v[124:127], a[56:59], v[84:87]
v_add_u32 v245, 12, v4
v_mul_u32_u24 v246, 13, v245
s_waitcnt vmcnt(18) lgkmcnt(0)
v_mfma_f32_16x16x32_bf16 v[16:19], v[128:131], a[60:63], v[16:19]
ds_read_b128 v[88:91], v13 offset:49152
v_mfma_f32_16x16x32_bf16 v[48:51], v[128:131], a[64:67], v[48:51]
ds_read_b128 v[92:95], v13 offset:50176
buffer_load_dwordx4 a[120:123], v10, s[8:11], s45 offen offset:2048 sc1
v_mfma_f32_16x16x32_bf16 v[20:23], v[132:135], a[60:63], v[20:23]
ds_read_b128 v[96:99], v13 offset:51200
v_mfma_f32_16x16x32_bf16 v[52:55], v[132:135], a[64:67], v[52:55]
ds_read_b128 v[100:103], v13 offset:52224
v_mfma_f32_16x16x32_bf16 v[24:27], v[136:139], a[60:63], v[24:27]
ds_read_b128 v[104:107], v13 offset:53248
v_mfma_f32_16x16x32_bf16 v[56:59], v[136:139], a[64:67], v[56:59]
ds_read_b128 v[108:111], v13 offset:54272
v_mfma_f32_16x16x32_bf16 v[28:31], v[140:143], a[60:63], v[28:31]
ds_read_b128 v[112:115], v13 offset:55296
v_mfma_f32_16x16x32_bf16 v[60:63], v[140:143], a[64:67], v[60:63]
ds_read_b128 v[116:119], v13 offset:56320
buffer_load_dwordx4 a[124:127], v11, s[8:11], s45 offen offset:2048 sc1
v_mfma_f32_16x16x32_bf16 v[32:35], v[144:147], a[60:63], v[32:35]
ds_read_b128 v[120:123], v14 offset:49152
v_mfma_f32_16x16x32_bf16 v[64:67], v[144:147], a[64:67], v[64:67]
ds_read_b128 v[124:127], v15 offset:49152
v_mfma_f32_16x16x32_bf16 v[36:39], v[148:151], a[60:63], v[36:39]
v_lshrrev_b32 v246, 6, v246
v_mul_u32_u24 v247, 5, v246
v_mfma_f32_16x16x32_bf16 v[68:71], v[148:151], a[64:67], v[68:71]
v_sub_u32 v247, v245, v247
v_and_b32 v248, 1, v246
v_mfma_f32_16x16x32_bf16 v[40:43], v[152:155], a[60:63], v[40:43]
v_mul_u32_u24 v248, 11520, v248
v_lshl_add_u32 v239, v247, 4, v248
v_mfma_f32_16x16x32_bf16 v[72:75], v[152:155], a[64:67], v[72:75]
buffer_load_dwordx4 a[128:131], v12, s[8:11], s45 offen offset:2048 sc1
v_add_u32 v239, v239, v8
v_add_u32 v245, 16, v4
v_mfma_f32_16x16x32_bf16 v[44:47], v[156:159], a[60:63], v[44:47]
v_mul_u32_u24 v246, 13, v245
v_lshrrev_b32 v246, 6, v246
v_mfma_f32_16x16x32_bf16 v[76:79], v[156:159], a[64:67], v[76:79]
v_mul_u32_u24 v247, 5, v246
v_sub_u32 v247, v245, v247
v_mfma_f32_16x16x32_bf16 v[80:83], v[160:163], a[68:71], v[80:83]
v_and_b32 v248, 1, v246
v_mul_u32_u24 v248, 11520, v248
v_mfma_f32_16x16x32_bf16 v[84:87], v[164:167], a[68:71], v[84:87]
v_lshl_add_u32 v240, v247, 4, v248
v_add_u32 v240, v240, v8
s_waitcnt vmcnt(18) lgkmcnt(0)
v_mfma_f32_16x16x32_bf16 v[16:19], v[88:91], a[72:75], v[16:19]
ds_read_b128 v[128:131], v13 offset:57344
v_mfma_f32_16x16x32_bf16 v[48:51], v[88:91], a[76:79], v[48:51]
ds_read_b128 v[132:135], v13 offset:58368
buffer_load_dwordx4 a[132:135], v10, s[8:11], s45 offen offset:3072 sc1
v_mfma_f32_16x16x32_bf16 v[20:23], v[92:95], a[72:75], v[20:23]
ds_read_b128 v[136:139], v13 offset:59392
v_mfma_f32_16x16x32_bf16 v[52:55], v[92:95], a[76:79], v[52:55]
ds_read_b128 v[140:143], v13 offset:60416
v_mfma_f32_16x16x32_bf16 v[24:27], v[96:99], a[72:75], v[24:27]
ds_read_b128 v[144:147], v13 offset:61440
v_mfma_f32_16x16x32_bf16 v[56:59], v[96:99], a[76:79], v[56:59]
ds_read_b128 v[148:151], v13 offset:62464
v_mfma_f32_16x16x32_bf16 v[28:31], v[100:103], a[72:75], v[28:31]
ds_read_b128 v[152:155], v13 offset:63488
v_mfma_f32_16x16x32_bf16 v[60:63], v[100:103], a[76:79], v[60:63]
ds_read_b128 v[156:159], v13 offset:64512
buffer_load_dwordx4 a[136:139], v11, s[8:11], s45 offen offset:3072 sc1
v_mfma_f32_16x16x32_bf16 v[32:35], v[104:107], a[72:75], v[32:35]
ds_read_b128 v[160:163], v14 offset:57344
v_mfma_f32_16x16x32_bf16 v[64:67], v[104:107], a[76:79], v[64:67]
ds_read_b128 v[164:167], v15 offset:57344
v_mfma_f32_16x16x32_bf16 v[36:39], v[108:111], a[72:75], v[36:39]
v_add_u32 v245, 20, v4
v_mul_u32_u24 v246, 13, v245
v_mfma_f32_16x16x32_bf16 v[68:71], v[108:111], a[76:79], v[68:71]
v_lshrrev_b32 v246, 6, v246
v_mul_u32_u24 v247, 5, v246
v_mfma_f32_16x16x32_bf16 v[40:43], v[112:115], a[72:75], v[40:43]
v_sub_u32 v247, v245, v247
v_add_u32 v248, -2, v246
v_mfma_f32_16x16x32_bf16 v[72:75], v[112:115], a[76:79], v[72:75]
buffer_load_dwordx4 a[140:143], v12, s[8:11], s45 offen offset:3072 sc1
v_cmp_le_u32 vcc, 4, v246
s_nop 1
v_mfma_f32_16x16x32_bf16 v[44:47], v[116:119], a[72:75], v[44:47]
v_cndmask_b32 v249, v246, v248, vcc
v_mul_u32_u24 v249, 6912, v249
v_mfma_f32_16x16x32_bf16 v[76:79], v[116:119], a[76:79], v[76:79]
v_lshl_add_u32 v235, v247, 3, v249
v_add_u32 v235, v235, v7
v_mfma_f32_16x16x32_bf16 v[80:83], v[120:123], a[80:83], v[80:83]
v_add_u32 v245, 24, v4
v_mul_u32_u24 v246, 13, v245
v_mfma_f32_16x16x32_bf16 v[84:87], v[124:127], a[80:83], v[84:87]
v_lshrrev_b32 v246, 6, v246
v_mul_u32_u24 v247, 5, v246
s_waitcnt vmcnt(16) lgkmcnt(0)
v_add_u32 v13, 65536, v13
v_add_u32 v14, 65536, v14
v_add_u32 v15, 65536, v15
v_mfma_f32_16x16x32_bf16 v[16:19], v[128:131], a[84:87], v[16:19]
ds_read_b128 v[88:91], v13 offset:0
v_mfma_f32_16x16x32_bf16 v[48:51], v[128:131], a[88:91], v[48:51]
ds_read_b128 v[92:95], v13 offset:1024
s_add_u32 s45, s45, 4096
buffer_load_dwordx4 a[144:147], v10, s[8:11], s45 offen offset:0 sc1
v_mfma_f32_16x16x32_bf16 v[20:23], v[132:135], a[84:87], v[20:23]
ds_read_b128 v[96:99], v13 offset:2048
v_mfma_f32_16x16x32_bf16 v[52:55], v[132:135], a[88:91], v[52:55]
ds_read_b128 v[100:103], v13 offset:3072
v_mfma_f32_16x16x32_bf16 v[24:27], v[136:139], a[84:87], v[24:27]
ds_read_b128 v[104:107], v13 offset:4096
v_mfma_f32_16x16x32_bf16 v[56:59], v[136:139], a[88:91], v[56:59]
ds_read_b128 v[108:111], v13 offset:5120
v_mfma_f32_16x16x32_bf16 v[28:31], v[140:143], a[84:87], v[28:31]
ds_read_b128 v[112:115], v13 offset:6144
v_mfma_f32_16x16x32_bf16 v[60:63], v[140:143], a[88:91], v[60:63]
ds_read_b128 v[116:119], v13 offset:7168
buffer_load_dwordx4 a[148:151], v11, s[8:11], s45 offen offset:0 sc1
v_mfma_f32_16x16x32_bf16 v[32:35], v[144:147], a[84:87], v[32:35]
ds_read_b128 v[120:123], v14 offset:0
v_mfma_f32_16x16x32_bf16 v[64:67], v[144:147], a[88:91], v[64:67]
ds_read_b128 v[124:127], v15 offset:0
v_mfma_f32_16x16x32_bf16 v[36:39], v[148:151], a[84:87], v[36:39]
v_sub_u32 v247, v245, v247
v_add_u32 v248, -2, v246
v_mfma_f32_16x16x32_bf16 v[68:71], v[148:151], a[88:91], v[68:71]
v_cmp_le_u32 vcc, 4, v246
s_nop 1
v_mfma_f32_16x16x32_bf16 v[40:43], v[152:155], a[84:87], v[40:43]
v_cndmask_b32 v249, v246, v248, vcc
v_mul_u32_u24 v249, 6912, v249
v_mfma_f32_16x16x32_bf16 v[72:75], v[152:155], a[88:91], v[72:75]
buffer_load_dwordx4 a[152:155], v12, s[8:11], s45 offen offset:0 sc1
v_lshl_add_u32 v236, v247, 3, v249
v_add_u32 v236, v236, v7
v_mfma_f32_16x16x32_bf16 v[44:47], v[156:159], a[84:87], v[44:47]
v_add_u32 v245, 28, v4
v_mul_u32_u24 v246, 13, v245
v_mfma_f32_16x16x32_bf16 v[76:79], v[156:159], a[88:91], v[76:79]
v_lshrrev_b32 v246, 6, v246
v_mul_u32_u24 v247, 5, v246
v_mfma_f32_16x16x32_bf16 v[80:83], v[160:163], a[92:95], v[80:83]
v_sub_u32 v247, v245, v247
v_add_u32 v248, -2, v246
v_mfma_f32_16x16x32_bf16 v[84:87], v[164:167], a[92:95], v[84:87]
v_cmp_le_u32 vcc, 4, v246
s_nop 1
s_waitcnt vmcnt(14) lgkmcnt(0)
s_barrier
v_mfma_f32_16x16x32_bf16 v[16:19], v[88:91], a[96:99], v[16:19]
ds_read_b128 v[128:131], v13 offset:8192
v_mfma_f32_16x16x32_bf16 v[48:51], v[88:91], a[100:103], v[48:51]
ds_read_b128 v[132:135], v13 offset:9216
buffer_load_dwordx4 a[156:159], v10, s[8:11], s45 offen offset:1024 sc1
v_mfma_f32_16x16x32_bf16 v[20:23], v[92:95], a[96:99], v[20:23]
ds_read_b128 v[136:139], v13 offset:10240
v_mfma_f32_16x16x32_bf16 v[52:55], v[92:95], a[100:103], v[52:55]
ds_read_b128 v[140:143], v13 offset:11264
v_mfma_f32_16x16x32_bf16 v[24:27], v[96:99], a[96:99], v[24:27]
ds_read_b128 v[144:147], v13 offset:12288
v_mfma_f32_16x16x32_bf16 v[56:59], v[96:99], a[100:103], v[56:59]
ds_read_b128 v[148:151], v13 offset:13312
buffer_load_dwordx4 a[160:163], v11, s[8:11], s45 offen offset:1024 sc1
v_mfma_f32_16x16x32_bf16 v[28:31], v[100:103], a[96:99], v[28:31]
ds_read_b128 v[152:155], v13 offset:14336
v_mfma_f32_16x16x32_bf16 v[60:63], v[100:103], a[100:103], v[60:63]
ds_read_b128 v[156:159], v13 offset:15360
v_mfma_f32_16x16x32_bf16 v[32:35], v[104:107], a[96:99], v[32:35]
ds_read_b128 v[160:163], v14 offset:8192
v_mfma_f32_16x16x32_bf16 v[64:67], v[104:107], a[100:103], v[64:67]
ds_read_b128 v[164:167], v15 offset:8192
v_mfma_f32_16x16x32_bf16 v[36:39], v[108:111], a[96:99], v[36:39]
buffer_load_dwordx4 a[164:167], v12, s[8:11], s45 offen offset:1024 sc1
v_cndmask_b32 v249, v246, v248, vcc
v_mul_u32_u24 v249, 6912, v249
v_mfma_f32_16x16x32_bf16 v[68:71], v[108:111], a[100:103], v[68:71]
v_lshl_add_u32 v237, v247, 3, v249
v_add_u32 v237, v237, v7
v_mfma_f32_16x16x32_bf16 v[40:43], v[112:115], a[96:99], v[40:43]
v_mul_u32_u24 v7, 48, v3
v_mul_u32_u24 v8, 80, v3
v_mfma_f32_16x16x32_bf16 v[72:75], v[112:115], a[100:103], v[72:75]
v_add_u32 v8, 27648, v8
s_lshl_b32 s24, s35, 2
v_mfma_f32_16x16x32_bf16 v[44:47], v[116:119], a[96:99], v[44:47]
buffer_load_dword v251, v252, s[16:19], 0 offen sc1
v_add_u32 v245, s24, v4
v_mul_u32_u24 v246, 13, v245
v_mfma_f32_16x16x32_bf16 v[76:79], v[116:119], a[100:103], v[76:79]
v_lshrrev_b32 v246, 6, v246
v_mul_u32_u24 v247, 5, v246
v_mfma_f32_16x16x32_bf16 v[80:83], v[120:123], a[104:107], v[80:83]
v_sub_u32 v247, v245, v247
v_add_u32 v248, -2, v246
v_mfma_f32_16x16x32_bf16 v[84:87], v[124:127], a[104:107], v[84:87]
v_cmp_le_u32 vcc, 4, v246
s_nop 1
s_waitcnt vmcnt(13) lgkmcnt(0)
v_mfma_f32_16x16x32_bf16 v[16:19], v[128:131], a[108:111], v[16:19]
ds_read_b128 v[88:91], v13 offset:16384
v_mfma_f32_16x16x32_bf16 v[48:51], v[128:131], a[112:115], v[48:51]
ds_read_b128 v[92:95], v13 offset:17408
buffer_load_dwordx4 a[168:171], v10, s[8:11], s45 offen offset:2048 sc1
v_mfma_f32_16x16x32_bf16 v[20:23], v[132:135], a[108:111], v[20:23]
ds_read_b128 v[96:99], v13 offset:18432
v_mfma_f32_16x16x32_bf16 v[52:55], v[132:135], a[112:115], v[52:55]
ds_read_b128 v[100:103], v13 offset:19456
v_mfma_f32_16x16x32_bf16 v[24:27], v[136:139], a[108:111], v[24:27]
ds_read_b128 v[104:107], v13 offset:20480
buffer_load_dwordx4 a[172:175], v11, s[8:11], s45 offen offset:2048 sc1
v_mfma_f32_16x16x32_bf16 v[56:59], v[136:139], a[112:115], v[56:59]
ds_read_b128 v[108:111], v13 offset:21504
v_mfma_f32_16x16x32_bf16 v[28:31], v[140:143], a[108:111], v[28:31]
ds_read_b128 v[112:115], v13 offset:22528
v_mfma_f32_16x16x32_bf16 v[60:63], v[140:143], a[112:115], v[60:63]
ds_read_b128 v[116:119], v13 offset:23552
buffer_load_dwordx4 a[176:179], v12, s[8:11], s45 offen offset:2048 sc1
v_mfma_f32_16x16x32_bf16 v[32:35], v[144:147], a[108:111], v[32:35]
ds_read_b128 v[120:123], v14 offset:16384
v_mfma_f32_16x16x32_bf16 v[64:67], v[144:147], a[112:115], v[64:67]
ds_read_b128 v[124:127], v15 offset:16384
v_mfma_f32_16x16x32_bf16 v[36:39], v[148:151], a[108:111], v[36:39]
buffer_load_dwordx4 v[192:195], v6, s[8:11], s49 offen offset:0 sc1
v_cndmask_b32 v249, v246, v248, vcc
v_mul_u32_u24 v249, 6912, v249
v_mfma_f32_16x16x32_bf16 v[68:71], v[148:151], a[112:115], v[68:71]
v_lshl_add_u32 v241, v247, 3, v249
v_add_u32 v241, v241, v7
v_mfma_f32_16x16x32_bf16 v[40:43], v[152:155], a[108:111], v[40:43]
v_and_b32 v248, 1, v246
v_mul_u32_u24 v248, 11520, v248
v_mfma_f32_16x16x32_bf16 v[72:75], v[152:155], a[112:115], v[72:75]
buffer_load_dwordx4 v[196:199], v6, s[8:11], s49 offen offset:64 sc1
v_lshl_add_u32 v243, v247, 4, v248
v_add_u32 v243, v243, v8
v_mfma_f32_16x16x32_bf16 v[44:47], v[156:159], a[108:111], v[44:47]
v_cmp_gt_u32 s[38:39], 10, v245
s_lshl_b32 s24, s36, 2
v_mfma_f32_16x16x32_bf16 v[76:79], v[156:159], a[112:115], v[76:79]
v_add_u32 v245, s24, v4
v_mul_u32_u24 v246, 13, v245
v_mfma_f32_16x16x32_bf16 v[80:83], v[160:163], a[116:119], v[80:83]
buffer_load_dwordx4 v[200:203], v6, s[8:11], s49 offen offset:128 sc1
v_lshrrev_b32 v246, 6, v246
v_mul_u32_u24 v247, 5, v246
v_mfma_f32_16x16x32_bf16 v[84:87], v[164:167], a[116:119], v[84:87]
v_sub_u32 v247, v245, v247
v_add_u32 v248, -2, v246
s_waitcnt vmcnt(16) lgkmcnt(0)
v_mfma_f32_16x16x32_bf16 v[16:19], v[88:91], a[120:123], v[16:19]
ds_read_b128 v[128:131], v13 offset:24576
v_mfma_f32_16x16x32_bf16 v[48:51], v[88:91], a[124:127], v[48:51]
ds_read_b128 v[132:135], v13 offset:25600
buffer_load_dwordx4 a[180:183], v10, s[8:11], s45 offen offset:3072 sc1
v_mfma_f32_16x16x32_bf16 v[20:23], v[92:95], a[120:123], v[20:23]
ds_read_b128 v[136:139], v13 offset:26624
v_mfma_f32_16x16x32_bf16 v[52:55], v[92:95], a[124:127], v[52:55]
ds_read_b128 v[140:143], v13 offset:27648
v_mfma_f32_16x16x32_bf16 v[24:27], v[96:99], a[120:123], v[24:27]
ds_read_b128 v[144:147], v13 offset:28672
buffer_load_dwordx4 a[184:187], v11, s[8:11], s45 offen offset:3072 sc1
v_mfma_f32_16x16x32_bf16 v[56:59], v[96:99], a[124:127], v[56:59]
ds_read_b128 v[148:151], v13 offset:29696
v_mfma_f32_16x16x32_bf16 v[28:31], v[100:103], a[120:123], v[28:31]
ds_read_b128 v[152:155], v13 offset:30720
v_mfma_f32_16x16x32_bf16 v[60:63], v[100:103], a[124:127], v[60:63]
ds_read_b128 v[156:159], v13 offset:31744
buffer_load_dwordx4 a[188:191], v12, s[8:11], s45 offen offset:3072 sc1
v_mfma_f32_16x16x32_bf16 v[32:35], v[104:107], a[120:123], v[32:35]
ds_read_b128 v[160:163], v14 offset:24576
v_mfma_f32_16x16x32_bf16 v[64:67], v[104:107], a[124:127], v[64:67]
ds_read_b128 v[164:167], v15 offset:24576
v_mfma_f32_16x16x32_bf16 v[36:39], v[108:111], a[120:123], v[36:39]
buffer_load_dwordx4 v[204:207], v6, s[8:11], s49 offen offset:192 sc1
v_cmp_le_u32 vcc, 4, v246
s_nop 1
v_mfma_f32_16x16x32_bf16 v[68:71], v[108:111], a[124:127], v[68:71]
v_cndmask_b32 v249, v246, v248, vcc
v_mul_u32_u24 v249, 6912, v249
v_mfma_f32_16x16x32_bf16 v[40:43], v[112:115], a[120:123], v[40:43]
v_lshl_add_u32 v242, v247, 3, v249
v_add_u32 v242, v242, v7
v_mfma_f32_16x16x32_bf16 v[72:75], v[112:115], a[124:127], v[72:75]
buffer_load_dwordx4 v[208:211], v6, s[8:11], s49 offen offset:256 sc1
v_and_b32 v248, 1, v246
v_mul_u32_u24 v248, 11520, v248
v_mfma_f32_16x16x32_bf16 v[44:47], v[116:119], a[120:123], v[44:47]
v_lshl_add_u32 v244, v247, 4, v248
v_add_u32 v244, v244, v8
v_mfma_f32_16x16x32_bf16 v[76:79], v[116:119], a[124:127], v[76:79]
v_cmp_gt_u32 s[40:41], 10, v245
v_mfma_f32_16x16x32_bf16 v[80:83], v[120:123], a[128:131], v[80:83]
buffer_load_dwordx4 v[212:215], v6, s[8:11], s49 offen offset:320 sc1
v_add_f32 v168, v168, v170
v_add_f32 v169, v169, v171
v_mfma_f32_16x16x32_bf16 v[84:87], v[124:127], a[128:131], v[84:87]
v_mov_b32 v9, v168
s_nop 1
s_waitcnt vmcnt(19) lgkmcnt(0)
v_mfma_f32_16x16x32_bf16 v[16:19], v[128:131], a[132:135], v[16:19]
ds_read_b128 v[88:91], v13 offset:32768
v_mfma_f32_16x16x32_bf16 v[48:51], v[128:131], a[136:139], v[48:51]
ds_read_b128 v[92:95], v13 offset:33792
s_add_u32 s45, s45, 4096
buffer_load_dwordx4 a[192:195], v10, s[8:11], s45 offen offset:0 sc1
v_mfma_f32_16x16x32_bf16 v[20:23], v[132:135], a[132:135], v[20:23]
ds_read_b128 v[96:99], v13 offset:34816
v_mfma_f32_16x16x32_bf16 v[52:55], v[132:135], a[136:139], v[52:55]
ds_read_b128 v[100:103], v13 offset:35840
v_mfma_f32_16x16x32_bf16 v[24:27], v[136:139], a[132:135], v[24:27]
ds_read_b128 v[104:107], v13 offset:36864
buffer_load_dwordx4 a[196:199], v11, s[8:11], s45 offen offset:0 sc1
v_mfma_f32_16x16x32_bf16 v[56:59], v[136:139], a[136:139], v[56:59]
ds_read_b128 v[108:111], v13 offset:37888
v_mfma_f32_16x16x32_bf16 v[28:31], v[140:143], a[132:135], v[28:31]
ds_read_b128 v[112:115], v13 offset:38912
v_mfma_f32_16x16x32_bf16 v[60:63], v[140:143], a[136:139], v[60:63]
ds_read_b128 v[116:119], v13 offset:39936
buffer_load_dwordx4 a[200:203], v12, s[8:11], s45 offen offset:0 sc1
v_mfma_f32_16x16x32_bf16 v[32:35], v[144:147], a[132:135], v[32:35]
ds_read_b128 v[120:123], v14 offset:32768
v_mfma_f32_16x16x32_bf16 v[64:67], v[144:147], a[136:139], v[64:67]
ds_read_b128 v[124:127], v15 offset:32768
v_mfma_f32_16x16x32_bf16 v[36:39], v[148:151], a[132:135], v[36:39]
buffer_load_dwordx4 v[216:219], v6, s[8:11], s49 offen offset:384 sc1
v_permlane32_swap_b32 v168, v9
s_nop 1
v_mfma_f32_16x16x32_bf16 v[68:71], v[148:151], a[136:139], v[68:71]
v_add_f32 v168, v168, v9
v_mov_b32 v9, v168
v_mfma_f32_16x16x32_bf16 v[40:43], v[152:155], a[132:135], v[40:43]
s_nop 1
v_permlane16_swap_b32 v168, v9
v_mfma_f32_16x16x32_bf16 v[72:75], v[152:155], a[136:139], v[72:75]
buffer_load_dwordx4 v[220:223], v6, s[8:11], s49 offen offset:448 sc1
s_nop 1
v_add_f32 v168, v168, v9
v_mfma_f32_16x16x32_bf16 v[44:47], v[156:159], a[132:135], v[44:47]
v_mov_b32 v9, v169
s_nop 1
v_mfma_f32_16x16x32_bf16 v[76:79], v[156:159], a[136:139], v[76:79]
v_permlane32_swap_b32 v169, v9
s_nop 1
v_mfma_f32_16x16x32_bf16 v[80:83], v[160:163], a[140:143], v[80:83]
buffer_load_dwordx4 v[224:227], v6, s[8:11], s50 offen sc1
v_add_f32 v169, v169, v9
v_mov_b32 v9, v169
v_mfma_f32_16x16x32_bf16 v[84:87], v[164:167], a[140:143], v[84:87]
s_nop 1
v_permlane16_swap_b32 v169, v9
s_waitcnt vmcnt(22) lgkmcnt(0)
v_mfma_f32_16x16x32_bf16 v[16:19], v[88:91], a[144:147], v[16:19]
ds_read_b128 v[128:131], v13 offset:40960
v_mfma_f32_16x16x32_bf16 v[48:51], v[88:91], a[148:151], v[48:51]
ds_read_b128 v[132:135], v13 offset:41984
buffer_load_dwordx4 a[204:207], v10, s[8:11], s45 offen offset:1024 sc1
v_mfma_f32_16x16x32_bf16 v[20:23], v[92:95], a[144:147], v[20:23]
ds_read_b128 v[136:139], v13 offset:43008
v_mfma_f32_16x16x32_bf16 v[52:55], v[92:95], a[148:151], v[52:55]
ds_read_b128 v[140:143], v13 offset:44032
v_mfma_f32_16x16x32_bf16 v[24:27], v[96:99], a[144:147], v[24:27]
ds_read_b128 v[144:147], v13 offset:45056
v_mfma_f32_16x16x32_bf16 v[56:59], v[96:99], a[148:151], v[56:59]
ds_read_b128 v[148:151], v13 offset:46080
buffer_load_dwordx4 a[208:211], v11, s[8:11], s45 offen offset:1024 sc1
v_mfma_f32_16x16x32_bf16 v[28:31], v[100:103], a[144:147], v[28:31]
ds_read_b128 v[152:155], v13 offset:47104
v_mfma_f32_16x16x32_bf16 v[60:63], v[100:103], a[148:151], v[60:63]
ds_read_b128 v[156:159], v13 offset:48128
v_mfma_f32_16x16x32_bf16 v[32:35], v[104:107], a[144:147], v[32:35]
ds_read_b128 v[160:163], v14 offset:40960
v_mfma_f32_16x16x32_bf16 v[64:67], v[104:107], a[148:151], v[64:67]
ds_read_b128 v[164:167], v15 offset:40960
v_mfma_f32_16x16x32_bf16 v[36:39], v[108:111], a[144:147], v[36:39]
buffer_load_dwordx4 a[212:215], v12, s[8:11], s45 offen offset:1024 sc1
s_nop 1
v_add_f32 v169, v169, v9
v_mfma_f32_16x16x32_bf16 v[68:71], v[108:111], a[148:151], v[68:71]
v_mul_f32 v168, 0x3acccccd, v168
v_mul_f32 v169, 0x3acccccd, v169
v_mfma_f32_16x16x32_bf16 v[40:43], v[112:115], a[144:147], v[40:43]
v_fma_f32 v169, -v168, v168, v169
v_max_f32 v169, 0, v169
v_mfma_f32_16x16x32_bf16 v[72:75], v[112:115], a[148:151], v[72:75]
v_add_f32 v169, 0x3727c5ac, v169
v_rsq_f32 v180, v169
v_mfma_f32_16x16x32_bf16 v[44:47], v[116:119], a[144:147], v[44:47]
buffer_load_dwordx4 v[228:231], v6, s[8:11], s51 offen sc1
s_nop 1
v_mul_f32 v186, v168, v180
v_mfma_f32_16x16x32_bf16 v[76:79], v[116:119], a[148:151], v[76:79]
v_sub_f32 v186, 0, v186
v_add_f32 v172, v172, v174
v_mfma_f32_16x16x32_bf16 v[80:83], v[120:123], a[152:155], v[80:83]
v_add_f32 v173, v173, v175
v_mov_b32 v9, v172
v_mfma_f32_16x16x32_bf16 v[84:87], v[124:127], a[152:155], v[84:87]
s_nop 1
v_permlane32_swap_b32 v172, v9
s_waitcnt vmcnt(23) lgkmcnt(0)
v_mfma_f32_16x16x32_bf16 v[16:19], v[128:131], a[156:159], v[16:19]
ds_read_b128 v[88:91], v13 offset:49152
v_mfma_f32_16x16x32_bf16 v[48:51], v[128:131], a[160:163], v[48:51]
ds_read_b128 v[92:95], v13 offset:50176
buffer_load_dwordx4 a[216:219], v10, s[8:11], s45 offen offset:2048 sc1
v_mfma_f32_16x16x32_bf16 v[20:23], v[132:135], a[156:159], v[20:23]
ds_read_b128 v[96:99], v13 offset:51200
v_mfma_f32_16x16x32_bf16 v[52:55], v[132:135], a[160:163], v[52:55]
ds_read_b128 v[100:103], v13 offset:52224
v_mfma_f32_16x16x32_bf16 v[24:27], v[136:139], a[156:159], v[24:27]
ds_read_b128 v[104:107], v13 offset:53248
v_mfma_f32_16x16x32_bf16 v[56:59], v[136:139], a[160:163], v[56:59]
ds_read_b128 v[108:111], v13 offset:54272
v_mfma_f32_16x16x32_bf16 v[28:31], v[140:143], a[156:159], v[28:31]
ds_read_b128 v[112:115], v13 offset:55296
v_mfma_f32_16x16x32_bf16 v[60:63], v[140:143], a[160:163], v[60:63]
ds_read_b128 v[116:119], v13 offset:56320
buffer_load_dwordx4 a[220:223], v11, s[8:11], s45 offen offset:2048 sc1
v_mfma_f32_16x16x32_bf16 v[32:35], v[144:147], a[156:159], v[32:35]
ds_read_b128 v[120:123], v14 offset:49152
v_mfma_f32_16x16x32_bf16 v[64:67], v[144:147], a[160:163], v[64:67]
ds_read_b128 v[124:127], v15 offset:49152
v_mfma_f32_16x16x32_bf16 v[36:39], v[148:151], a[156:159], v[36:39]
s_nop 1
v_add_f32 v172, v172, v9
v_mfma_f32_16x16x32_bf16 v[68:71], v[148:151], a[160:163], v[68:71]
v_mov_b32 v9, v172
s_nop 1
v_mfma_f32_16x16x32_bf16 v[40:43], v[152:155], a[156:159], v[40:43]
v_permlane16_swap_b32 v172, v9
s_nop 1
v_mfma_f32_16x16x32_bf16 v[72:75], v[152:155], a[160:163], v[72:75]
buffer_load_dwordx4 a[224:227], v12, s[8:11], s45 offen offset:2048 sc1
v_add_f32 v172, v172, v9
v_mov_b32 v9, v173
v_mfma_f32_16x16x32_bf16 v[44:47], v[156:159], a[156:159], v[44:47]
s_nop 1
v_permlane32_swap_b32 v173, v9
v_mfma_f32_16x16x32_bf16 v[76:79], v[156:159], a[160:163], v[76:79]
s_nop 1
v_add_f32 v173, v173, v9
v_mfma_f32_16x16x32_bf16 v[80:83], v[160:163], a[164:167], v[80:83]
v_mov_b32 v9, v173
s_nop 1
v_mfma_f32_16x16x32_bf16 v[84:87], v[164:167], a[164:167], v[84:87]
v_permlane16_swap_b32 v173, v9
s_nop 1
s_waitcnt vmcnt(22) lgkmcnt(0)
v_mfma_f32_16x16x32_bf16 v[16:19], v[88:91], a[168:171], v[16:19]
ds_read_b128 v[128:131], v13 offset:57344
v_mfma_f32_16x16x32_bf16 v[48:51], v[88:91], a[172:175], v[48:51]
ds_read_b128 v[132:135], v13 offset:58368
buffer_load_dwordx4 a[228:231], v10, s[8:11], s45 offen offset:3072 sc1
v_mfma_f32_16x16x32_bf16 v[20:23], v[92:95], a[168:171], v[20:23]
ds_read_b128 v[136:139], v13 offset:59392
v_mfma_f32_16x16x32_bf16 v[52:55], v[92:95], a[172:175], v[52:55]
ds_read_b128 v[140:143], v13 offset:60416
v_mfma_f32_16x16x32_bf16 v[24:27], v[96:99], a[168:171], v[24:27]
ds_read_b128 v[144:147], v13 offset:61440
v_mfma_f32_16x16x32_bf16 v[56:59], v[96:99], a[172:175], v[56:59]
ds_read_b128 v[148:151], v13 offset:62464
v_mfma_f32_16x16x32_bf16 v[28:31], v[100:103], a[168:171], v[28:31]
ds_read_b128 v[152:155], v13 offset:63488
v_mfma_f32_16x16x32_bf16 v[60:63], v[100:103], a[172:175], v[60:63]
ds_read_b128 v[156:159], v13 offset:64512
buffer_load_dwordx4 a[232:235], v11, s[8:11], s45 offen offset:3072 sc1
v_mfma_f32_16x16x32_bf16 v[32:35], v[104:107], a[168:171], v[32:35]
ds_read_b128 v[160:163], v14 offset:57344
v_mfma_f32_16x16x32_bf16 v[64:67], v[104:107], a[172:175], v[64:67]
ds_read_b128 v[164:167], v15 offset:57344
v_mfma_f32_16x16x32_bf16 v[36:39], v[108:111], a[168:171], v[36:39]
v_add_f32 v173, v173, v9
v_mul_f32 v172, 0x3acccccd, v172
v_mfma_f32_16x16x32_bf16 v[68:71], v[108:111], a[172:175], v[68:71]
v_mul_f32 v173, 0x3acccccd, v173
v_fma_f32 v173, -v172, v172, v173
v_mfma_f32_16x16x32_bf16 v[40:43], v[112:115], a[168:171], v[40:43]
v_max_f32 v173, 0, v173
v_add_f32 v173, 0x3727c5ac, v173
v_mfma_f32_16x16x32_bf16 v[72:75], v[112:115], a[172:175], v[72:75]
buffer_load_dwordx4 a[236:239], v12, s[8:11], s45 offen offset:3072 sc1
v_rsq_f32 v182, v173
s_nop 1
v_mfma_f32_16x16x32_bf16 v[44:47], v[116:119], a[168:171], v[44:47]
v_mul_f32 v188, v172, v182
v_sub_f32 v188, 0, v188
v_mfma_f32_16x16x32_bf16 v[76:79], v[116:119], a[172:175], v[76:79]
v_add_f32 v176, v176, v178
v_add_f32 v177, v177, v179
v_mfma_f32_16x16x32_bf16 v[80:83], v[120:123], a[176:179], v[80:83]
v_mov_b32 v9, v176
s_nop 1
v_mfma_f32_16x16x32_bf16 v[84:87], v[124:127], a[176:179], v[84:87]
v_permlane32_swap_b32 v176, v9
s_nop 1
s_waitcnt vmcnt(19) lgkmcnt(0)
v_add_u32 v13, 65536, v13
v_add_u32 v14, 65536, v14
v_add_u32 v15, 65536, v15
v_mfma_f32_16x16x32_bf16 v[16:19], v[128:131], a[180:183], v[16:19]
ds_read_b128 v[88:91], v13 offset:0
v_mfma_f32_16x16x32_bf16 v[48:51], v[128:131], a[184:187], v[48:51]
ds_read_b128 v[92:95], v13 offset:1024
buffer_load_dword v254, v253, s[8:11], s56 offen
v_mfma_f32_16x16x32_bf16 v[20:23], v[132:135], a[180:183], v[20:23]
ds_read_b128 v[96:99], v13 offset:2048
v_mfma_f32_16x16x32_bf16 v[52:55], v[132:135], a[184:187], v[52:55]
ds_read_b128 v[100:103], v13 offset:3072
v_mfma_f32_16x16x32_bf16 v[24:27], v[136:139], a[180:183], v[24:27]
ds_read_b128 v[104:107], v13 offset:4096
v_mfma_f32_16x16x32_bf16 v[56:59], v[136:139], a[184:187], v[56:59]
ds_read_b128 v[108:111], v13 offset:5120
v_mfma_f32_16x16x32_bf16 v[28:31], v[140:143], a[180:183], v[28:31]
ds_read_b128 v[112:115], v13 offset:6144
v_mfma_f32_16x16x32_bf16 v[60:63], v[140:143], a[184:187], v[60:63]
ds_read_b128 v[116:119], v13 offset:7168
v_mfma_f32_16x16x32_bf16 v[32:35], v[144:147], a[180:183], v[32:35]
ds_read_b128 v[120:123], v14 offset:0
v_mfma_f32_16x16x32_bf16 v[64:67], v[144:147], a[184:187], v[64:67]
ds_read_b128 v[124:127], v15 offset:0
v_mfma_f32_16x16x32_bf16 v[36:39], v[148:151], a[180:183], v[36:39]
v_add_f32 v176, v176, v9
v_mov_b32 v9, v176
v_mfma_f32_16x16x32_bf16 v[68:71], v[148:151], a[184:187], v[68:71]
s_nop 1
v_permlane16_swap_b32 v176, v9
v_mfma_f32_16x16x32_bf16 v[40:43], v[152:155], a[180:183], v[40:43]
s_nop 1
v_add_f32 v176, v176, v9
v_mfma_f32_16x16x32_bf16 v[72:75], v[152:155], a[184:187], v[72:75]
v_mov_b32 v9, v177
s_nop 1
v_mfma_f32_16x16x32_bf16 v[44:47], v[156:159], a[180:183], v[44:47]
v_permlane32_swap_b32 v177, v9
s_nop 1
v_mfma_f32_16x16x32_bf16 v[76:79], v[156:159], a[184:187], v[76:79]
v_add_f32 v177, v177, v9
v_mov_b32 v9, v177
v_mfma_f32_16x16x32_bf16 v[80:83], v[160:163], a[188:191], v[80:83]
s_nop 1
v_permlane16_swap_b32 v177, v9
v_mfma_f32_16x16x32_bf16 v[84:87], v[164:167], a[188:191], v[84:87]
s_nop 1
v_add_f32 v177, v177, v9
s_waitcnt vmcnt(14) lgkmcnt(0)
v_mfma_f32_16x16x32_bf16 v[16:19], v[88:91], a[192:195], v[16:19]
ds_read_b128 v[128:131], v13 offset:8192
v_mfma_f32_16x16x32_bf16 v[48:51], v[88:91], a[196:199], v[48:51]
ds_read_b128 v[132:135], v13 offset:9216
v_mfma_f32_16x16x32_bf16 v[20:23], v[92:95], a[192:195], v[20:23]
ds_read_b128 v[136:139], v13 offset:10240
v_mfma_f32_16x16x32_bf16 v[52:55], v[92:95], a[196:199], v[52:55]
ds_read_b128 v[140:143], v13 offset:11264
v_mfma_f32_16x16x32_bf16 v[24:27], v[96:99], a[192:195], v[24:27]
ds_read_b128 v[144:147], v13 offset:12288
v_mfma_f32_16x16x32_bf16 v[56:59], v[96:99], a[196:199], v[56:59]
ds_read_b128 v[148:151], v13 offset:13312
v_mfma_f32_16x16x32_bf16 v[28:31], v[100:103], a[192:195], v[28:31]
ds_read_b128 v[152:155], v13 offset:14336
v_mfma_f32_16x16x32_bf16 v[60:63], v[100:103], a[196:199], v[60:63]
ds_read_b128 v[156:159], v13 offset:15360
v_mfma_f32_16x16x32_bf16 v[32:35], v[104:107], a[192:195], v[32:35]
ds_read_b128 v[160:163], v14 offset:8192
v_mfma_f32_16x16x32_bf16 v[64:67], v[104:107], a[196:199], v[64:67]
ds_read_b128 v[164:167], v15 offset:8192
v_mfma_f32_16x16x32_bf16 v[36:39], v[108:111], a[192:195], v[36:39]
v_mul_f32 v176, 0x3acccccd, v176
v_mul_f32 v177, 0x3acccccd, v177
v_mfma_f32_16x16x32_bf16 v[68:71], v[108:111], a[196:199], v[68:71]
v_fma_f32 v177, -v176, v176, v177
v_max_f32 v177, 0, v177
v_mfma_f32_16x16x32_bf16 v[40:43], v[112:115], a[192:195], v[40:43]
v_add_f32 v177, 0x3727c5ac, v177
v_rsq_f32 v184, v177
v_mfma_f32_16x16x32_bf16 v[72:75], v[112:115], a[196:199], v[72:75]
s_nop 1
v_mul_f32 v190, v176, v184
v_mfma_f32_16x16x32_bf16 v[44:47], v[116:119], a[192:195], v[44:47]
v_sub_f32 v190, 0, v190
v_mfma_f32_16x16x32_bf16 v[76:79], v[116:119], a[196:199], v[76:79]
v_mfma_f32_16x16x32_bf16 v[80:83], v[120:123], a[200:203], v[80:83]
v_mfma_f32_16x16x32_bf16 v[84:87], v[124:127], a[200:203], v[84:87]
s_waitcnt vmcnt(8) lgkmcnt(0)
v_mfma_f32_16x16x32_bf16 v[16:19], v[128:131], a[204:207], v[16:19]
ds_read_b128 v[88:91], v13 offset:16384
v_mfma_f32_16x16x32_bf16 v[48:51], v[128:131], a[208:211], v[48:51]
ds_read_b128 v[92:95], v13 offset:17408
buffer_load_dword v254, v253, s[8:11], s57 offen
v_mfma_f32_16x16x32_bf16 v[20:23], v[132:135], a[204:207], v[20:23]
ds_read_b128 v[96:99], v13 offset:18432
v_mfma_f32_16x16x32_bf16 v[52:55], v[132:135], a[208:211], v[52:55]
ds_read_b128 v[100:103], v13 offset:19456
v_mfma_f32_16x16x32_bf16 v[24:27], v[136:139], a[204:207], v[24:27]
ds_read_b128 v[104:107], v13 offset:20480
v_mfma_f32_16x16x32_bf16 v[56:59], v[136:139], a[208:211], v[56:59]
ds_read_b128 v[108:111], v13 offset:21504
v_mfma_f32_16x16x32_bf16 v[28:31], v[140:143], a[204:207], v[28:31]
ds_read_b128 v[112:115], v13 offset:22528
v_mfma_f32_16x16x32_bf16 v[60:63], v[140:143], a[208:211], v[60:63]
ds_read_b128 v[116:119], v13 offset:23552
v_mfma_f32_16x16x32_bf16 v[32:35], v[144:147], a[204:207], v[32:35]
ds_read_b128 v[120:123], v14 offset:16384
v_mfma_f32_16x16x32_bf16 v[64:67], v[144:147], a[208:211], v[64:67]
ds_read_b128 v[124:127], v15 offset:16384
v_mfma_f32_16x16x32_bf16 v[36:39], v[148:151], a[204:207], v[36:39]
v_mfma_f32_16x16x32_bf16 v[68:71], v[148:151], a[208:211], v[68:71]
v_mfma_f32_16x16x32_bf16 v[40:43], v[152:155], a[204:207], v[40:43]
v_mfma_f32_16x16x32_bf16 v[72:75], v[152:155], a[208:211], v[72:75]
v_mfma_f32_16x16x32_bf16 v[44:47], v[156:159], a[204:207], v[44:47]
v_mfma_f32_16x16x32_bf16 v[76:79], v[156:159], a[208:211], v[76:79]
v_mfma_f32_16x16x32_bf16 v[80:83], v[160:163], a[212:215], v[80:83]
v_mfma_f32_16x16x32_bf16 v[84:87], v[164:167], a[212:215], v[84:87]
s_waitcnt vmcnt(5) lgkmcnt(0)
v_mfma_f32_16x16x32_bf16 v[16:19], v[88:91], a[216:219], v[16:19]
ds_read_b128 v[128:131], v13 offset:24576
v_mfma_f32_16x16x32_bf16 v[48:51], v[88:91], a[220:223], v[48:51]
ds_read_b128 v[132:135], v13 offset:25600
v_mfma_f32_16x16x32_bf16 v[20:23], v[92:95], a[216:219], v[20:23]
ds_read_b128 v[136:139], v13 offset:26624
v_mfma_f32_16x16x32_bf16 v[52:55], v[92:95], a[220:223], v[52:55]
ds_read_b128 v[140:143], v13 offset:27648
v_mfma_f32_16x16x32_bf16 v[24:27], v[96:99], a[216:219], v[24:27]
ds_read_b128 v[144:147], v13 offset:28672
v_mfma_f32_16x16x32_bf16 v[56:59], v[96:99], a[220:223], v[56:59]
ds_read_b128 v[148:151], v13 offset:29696
v_mfma_f32_16x16x32_bf16 v[28:31], v[100:103], a[216:219], v[28:31]
ds_read_b128 v[152:155], v13 offset:30720
v_mfma_f32_16x16x32_bf16 v[60:63], v[100:103], a[220:223], v[60:63]
ds_read_b128 v[156:159], v13 offset:31744
v_mfma_f32_16x16x32_bf16 v[32:35], v[104:107], a[216:219], v[32:35]
ds_read_b128 v[160:163], v14 offset:24576
v_mfma_f32_16x16x32_bf16 v[64:67], v[104:107], a[220:223], v[64:67]
ds_read_b128 v[164:167], v15 offset:24576
v_mfma_f32_16x16x32_bf16 v[36:39], v[108:111], a[216:219], v[36:39]
v_mfma_f32_16x16x32_bf16 v[68:71], v[108:111], a[220:223], v[68:71]
v_mfma_f32_16x16x32_bf16 v[40:43], v[112:115], a[216:219], v[40:43]
v_mfma_f32_16x16x32_bf16 v[72:75], v[112:115], a[220:223], v[72:75]
v_mfma_f32_16x16x32_bf16 v[44:47], v[116:119], a[216:219], v[44:47]
v_mfma_f32_16x16x32_bf16 v[76:79], v[116:119], a[220:223], v[76:79]
v_mfma_f32_16x16x32_bf16 v[80:83], v[120:123], a[224:227], v[80:83]
v_mfma_f32_16x16x32_bf16 v[84:87], v[124:127], a[224:227], v[84:87]
s_waitcnt vmcnt(2) lgkmcnt(0)
v_mfma_f32_16x16x32_bf16 v[16:19], v[128:131], a[228:231], v[16:19]
v_mfma_f32_16x16x32_bf16 v[48:51], v[128:131], a[232:235], v[48:51]
v_mfma_f32_16x16x32_bf16 v[20:23], v[132:135], a[228:231], v[20:23]
v_mfma_f32_16x16x32_bf16 v[52:55], v[132:135], a[232:235], v[52:55]
v_mfma_f32_16x16x32_bf16 v[24:27], v[136:139], a[228:231], v[24:27]
v_mfma_f32_16x16x32_bf16 v[56:59], v[136:139], a[232:235], v[56:59]
v_mfma_f32_16x16x32_bf16 v[28:31], v[140:143], a[228:231], v[28:31]
v_mfma_f32_16x16x32_bf16 v[60:63], v[140:143], a[232:235], v[60:63]
v_mfma_f32_16x16x32_bf16 v[32:35], v[144:147], a[228:231], v[32:35]
v_mfma_f32_16x16x32_bf16 v[64:67], v[144:147], a[232:235], v[64:67]
v_mfma_f32_16x16x32_bf16 v[36:39], v[148:151], a[228:231], v[36:39]
v_mfma_f32_16x16x32_bf16 v[68:71], v[148:151], a[232:235], v[68:71]
v_mfma_f32_16x16x32_bf16 v[40:43], v[152:155], a[228:231], v[40:43]
v_mfma_f32_16x16x32_bf16 v[72:75], v[152:155], a[232:235], v[72:75]
v_mfma_f32_16x16x32_bf16 v[44:47], v[156:159], a[228:231], v[44:47]
v_mfma_f32_16x16x32_bf16 v[76:79], v[156:159], a[232:235], v[76:79]
v_mfma_f32_16x16x32_bf16 v[80:83], v[160:163], a[236:239], v[80:83]
v_mfma_f32_16x16x32_bf16 v[84:87], v[164:167], a[236:239], v[84:87]
s_waitcnt vmcnt(2)
v_and_b32 v8, 15, v1
v_cmp_gt_u32 vcc, 4, v8
v_mov_b32 v8, 0
v_mov_b32 v7, 16
v_cndmask_b32 v8, v8, v7, vcc
s_mov_b32 s22, 0
L_gp_12:
v_cmp_ne_u32 vcc, v8, v251
s_cbranch_vccz L_gd_13
buffer_load_dword v251, v252, s[16:19], 0 offen sc1
s_waitcnt vmcnt(0)
s_add_u32 s22, s22, 1
s_cmp_lt_u32 s22, 40000
s_cbranch_scc1 L_gp_12
L_gd_13:
s_or_b32 s27, s2, s6
s_cmp_lg_u32 s27, 0
s_cbranch_scc1 L_ep_14
v_mov_b32 v8, s63
s_mov_b32 s27, 53551104
s_mov_b64 exec, 1
buffer_store_dword v8, off, s[8:11], s27 sc1
s_mov_b64 exec, -1
L_ep_14:
s_and_b32 s52, s88, 3
s_and_b32 s53, s89, 1
s_lshl_b32 s53, s53, 2
s_add_u32 s53, s53, s52
s_lshr_b32 s54, s89, 1
s_nop 7
v_pk_mul_f32 v[16:17], v[16:17], v[180:181] op_sel_hi:[1,0]
v_pk_mul_f32 v[18:19], v[18:19], v[180:181] op_sel_hi:[1,0]
v_pk_fma_f32 v[16:17], v[192:193], v[186:187], v[16:17] op_sel_hi:[1,0,1]
v_pk_fma_f32 v[18:19], v[194:195], v[186:187], v[18:19] op_sel_hi:[1,0,1]
v_pk_mul_f32 v[20:21], v[20:21], v[180:181] op_sel_hi:[1,0]
v_pk_mul_f32 v[22:23], v[22:23], v[180:181] op_sel_hi:[1,0]
v_pk_fma_f32 v[20:21], v[196:197], v[186:187], v[20:21] op_sel_hi:[1,0,1]
v_pk_fma_f32 v[22:23], v[198:199], v[186:187], v[22:23] op_sel_hi:[1,0,1]
v_pk_mul_f32 v[24:25], v[24:25], v[180:181] op_sel_hi:[1,0]
v_pk_mul_f32 v[26:27], v[26:27], v[180:181] op_sel_hi:[1,0]
v_pk_fma_f32 v[24:25], v[200:201], v[186:187], v[24:25] op_sel_hi:[1,0,1]
v_pk_fma_f32 v[26:27], v[202:203], v[186:187], v[26:27] op_sel_hi:[1,0,1]
v_pk_mul_f32 v[28:29], v[28:29], v[180:181] op_sel_hi:[1,0]
v_pk_mul_f32 v[30:31], v[30:31], v[180:181] op_sel_hi:[1,0]
v_pk_fma_f32 v[28:29], v[204:205], v[186:187], v[28:29] op_sel_hi:[1,0,1]
v_pk_fma_f32 v[30:31], v[206:207], v[186:187], v[30:31] op_sel_hi:[1,0,1]
v_pk_mul_f32 v[32:33], v[32:33], v[180:181] op_sel_hi:[1,0]
v_pk_mul_f32 v[34:35], v[34:35], v[180:181] op_sel_hi:[1,0]
v_pk_fma_f32 v[32:33], v[208:209], v[186:187], v[32:33] op_sel_hi:[1,0,1]
v_pk_fma_f32 v[34:35], v[210:211], v[186:187], v[34:35] op_sel_hi:[1,0,1]
v_pk_mul_f32 v[36:37], v[36:37], v[180:181] op_sel_hi:[1,0]
v_pk_mul_f32 v[38:39], v[38:39], v[180:181] op_sel_hi:[1,0]
v_pk_fma_f32 v[36:37], v[212:213], v[186:187], v[36:37] op_sel_hi:[1,0,1]
v_pk_fma_f32 v[38:39], v[214:215], v[186:187], v[38:39] op_sel_hi:[1,0,1]
v_pk_mul_f32 v[40:41], v[40:41], v[180:181] op_sel_hi:[1,0]
v_pk_mul_f32 v[42:43], v[42:43], v[180:181] op_sel_hi:[1,0]
v_pk_fma_f32 v[40:41], v[216:217], v[186:187], v[40:41] op_sel_hi:[1,0,1]
v_pk_fma_f32 v[42:43], v[218:219], v[186:187], v[42:43] op_sel_hi:[1,0,1]
v_pk_mul_f32 v[44:45], v[44:45], v[180:181] op_sel_hi:[1,0]
v_pk_mul_f32 v[46:47], v[46:47], v[180:181] op_sel_hi:[1,0]
v_pk_fma_f32 v[44:45], v[220:221], v[186:187], v[44:45] op_sel_hi:[1,0,1]
v_pk_fma_f32 v[46:47], v[222:223], v[186:187], v[46:47] op_sel_hi:[1,0,1]
v_pk_mul_f32 v[48:49], v[48:49], v[182:183] op_sel_hi:[1,0]
v_pk_mul_f32 v[50:51], v[50:51], v[182:183] op_sel_hi:[1,0]
v_pk_fma_f32 v[48:49], v[192:193], v[188:189], v[48:49] op_sel_hi:[1,0,1]
v_pk_fma_f32 v[50:51], v[194:195], v[188:189], v[50:51] op_sel_hi:[1,0,1]
v_pk_mul_f32 v[52:53], v[52:53], v[182:183] op_sel_hi:[1,0]
v_pk_mul_f32 v[54:55], v[54:55], v[182:183] op_sel_hi:[1,0]
v_pk_fma_f32 v[52:53], v[196:197], v[188:189], v[52:53] op_sel_hi:[1,0,1]
v_pk_fma_f32 v[54:55], v[198:199], v[188:189], v[54:55] op_sel_hi:[1,0,1]
v_pk_mul_f32 v[56:57], v[56:57], v[182:183] op_sel_hi:[1,0]
v_pk_mul_f32 v[58:59], v[58:59], v[182:183] op_sel_hi:[1,0]
v_pk_fma_f32 v[56:57], v[200:201], v[188:189], v[56:57] op_sel_hi:[1,0,1]
v_pk_fma_f32 v[58:59], v[202:203], v[188:189], v[58:59] op_sel_hi:[1,0,1]
v_pk_mul_f32 v[60:61], v[60:61], v[182:183] op_sel_hi:[1,0]
v_pk_mul_f32 v[62:63], v[62:63], v[182:183] op_sel_hi:[1,0]
v_pk_fma_f32 v[60:61], v[204:205], v[188:189], v[60:61] op_sel_hi:[1,0,1]
v_pk_fma_f32 v[62:63], v[206:207], v[188:189], v[62:63] op_sel_hi:[1,0,1]
v_pk_mul_f32 v[64:65], v[64:65], v[182:183] op_sel_hi:[1,0]
v_pk_mul_f32 v[66:67], v[66:67], v[182:183] op_sel_hi:[1,0]
v_pk_fma_f32 v[64:65], v[208:209], v[188:189], v[64:65] op_sel_hi:[1,0,1]
v_pk_fma_f32 v[66:67], v[210:211], v[188:189], v[66:67] op_sel_hi:[1,0,1]
v_pk_mul_f32 v[68:69], v[68:69], v[182:183] op_sel_hi:[1,0]
v_pk_mul_f32 v[70:71], v[70:71], v[182:183] op_sel_hi:[1,0]
v_pk_fma_f32 v[68:69], v[212:213], v[188:189], v[68:69] op_sel_hi:[1,0,1]
v_pk_fma_f32 v[70:71], v[214:215], v[188:189], v[70:71] op_sel_hi:[1,0,1]
v_pk_mul_f32 v[72:73], v[72:73], v[182:183] op_sel_hi:[1,0]
v_pk_mul_f32 v[74:75], v[74:75], v[182:183] op_sel_hi:[1,0]
v_pk_fma_f32 v[72:73], v[216:217], v[188:189], v[72:73] op_sel_hi:[1,0,1]
v_pk_fma_f32 v[74:75], v[218:219], v[188:189], v[74:75] op_sel_hi:[1,0,1]
v_pk_mul_f32 v[76:77], v[76:77], v[182:183] op_sel_hi:[1,0]
v_pk_mul_f32 v[78:79], v[78:79], v[182:183] op_sel_hi:[1,0]
v_pk_fma_f32 v[76:77], v[220:221], v[188:189], v[76:77] op_sel_hi:[1,0,1]
v_pk_fma_f32 v[78:79], v[222:223], v[188:189], v[78:79] op_sel_hi:[1,0,1]
v_pk_mul_f32 v[80:81], v[80:81], v[184:185] op_sel_hi:[1,0]
v_pk_mul_f32 v[82:83], v[82:83], v[184:185] op_sel_hi:[1,0]
v_pk_fma_f32 v[80:81], v[224:225], v[190:191], v[80:81] op_sel_hi:[1,0,1]
v_pk_fma_f32 v[82:83], v[226:227], v[190:191], v[82:83] op_sel_hi:[1,0,1]
v_pk_mul_f32 v[84:85], v[84:85], v[184:185] op_sel_hi:[1,0]
v_pk_mul_f32 v[86:87], v[86:87], v[184:185] op_sel_hi:[1,0]
v_pk_fma_f32 v[84:85], v[228:229], v[190:191], v[84:85] op_sel_hi:[1,0,1]
v_pk_fma_f32 v[86:87], v[230:231], v[190:191], v[86:87] op_sel_hi:[1,0,1]
s_mov_b32 s26, -1
s_mov_b32 s27, 0
s_mov_b32 s28, 0
s_mov_b32 s29, -1
s_not_b64 s[22:23], s[38:39]
s_not_b64 s[42:43], s[40:41]
s_barrier
v_cvt_pk_bf16_f32 v88, v16, v17
v_cvt_pk_bf16_f32 v89, v18, v19
ds_write_b64 v232, v[88:89] offset:0
v_cvt_pk_bf16_f32 v90, v48, v49
v_cvt_pk_bf16_f32 v91, v50, v51
ds_write_b64 v232, v[90:91] offset:768
v_cvt_pk_bf16_f32 v92, v20, v21
v_cvt_pk_bf16_f32 v93, v22, v23
ds_write_b64 v233, v[92:93] offset:0
v_cvt_pk_bf16_f32 v94, v52, v53
v_cvt_pk_bf16_f32 v95, v54, v55
ds_write_b64 v233, v[94:95] offset:768
v_cvt_pk_bf16_f32 v96, v36, v37
v_cvt_pk_bf16_f32 v97, v38, v39
ds_write_b64 v235, v[96:97] offset:0
v_cvt_pk_bf16_f32 v98, v68, v69
v_cvt_pk_bf16_f32 v99, v70, v71
ds_write_b64 v235, v[98:99] offset:768
v_cvt_pk_bf16_f32 v100, v40, v41
v_cvt_pk_bf16_f32 v101, v42, v43
ds_write_b64 v236, v[100:101] offset:0
v_cvt_pk_bf16_f32 v102, v72, v73
v_cvt_pk_bf16_f32 v103, v74, v75
ds_write_b64 v236, v[102:103] offset:768
ds_write_b128 v239, v[28:31] offset:0
ds_write_b128 v239, v[60:63] offset:1280
ds_write_b128 v240, v[32:35] offset:0
ds_write_b128 v240, v[64:67] offset:1280
v_cvt_pk_bf16_f32 v88, v24, v25
v_cvt_pk_bf16_f32 v89, v26, v27
v_cvt_pk_bf16_f32 v90, v56, v57
v_cvt_pk_bf16_f32 v91, v58, v59
v_cvt_pk_bf16_f32 v92, v44, v45
v_cvt_pk_bf16_f32 v93, v46, v47
v_cvt_pk_bf16_f32 v94, v76, v77
v_cvt_pk_bf16_f32 v95, v78, v79
v_cvt_pk_bf16_f32 v96, v80, v81
v_cvt_pk_bf16_f32 v97, v82, v83
v_cvt_pk_bf16_f32 v98, v84, v85
v_cvt_pk_bf16_f32 v99, v86, v87
s_mov_b64 exec, s[26:27]
ds_write_b64 v234, v[88:89] offset:0
ds_write_b64 v234, v[90:91] offset:768
ds_write_b64 v237, v[92:93] offset:0
ds_write_b64 v237, v[94:95] offset:768
s_mov_b64 exec, s[28:29]
ds_write_b128 v238, v[24:27] offset:0
ds_write_b128 v238, v[56:59] offset:1280
s_mov_b64 exec, s[38:39]
ds_write_b64 v241, v[96:97]
s_mov_b64 exec, s[22:23]
ds_write_b128 v243, v[80:83]
s_mov_b64 exec, s[40:41]
ds_write_b64 v242, v[98:99]
s_mov_b64 exec, s[42:43]
ds_write_b128 v244, v[84:87]
s_mov_b64 exec, -1
s_waitcnt lgkmcnt(0)
s_barrier
v_and_b32 v10, 127, v0
v_lshrrev_b32 v11, 7, v0
v_add_u32 v12, 2, v10
v_mul_u32_u24 v13, 48, v12
v_mul_u32_u24 v14, 6912, v11
v_add_u32 v13, v13, v14
v_add_u32 v15, 14496, v13
v_mul_u32_u24 v14, 80, v12
v_mul_u32_u24 v9, 11520, v11
v_add_u32 v14, v14, v9
v_add_u32 v14, 27648, v14
ds_read_b128 v[16:19], v15 offset:0
ds_read_b128 v[20:23], v15 offset:16
ds_read_b128 v[24:27], v15 offset:32
ds_read_b128 v[28:31], v13 offset:672
ds_read_b128 v[32:35], v13 offset:688
ds_read_b128 v[36:39], v13 offset:704
ds_read_b128 v[40:43], v13 offset:576
ds_read_b128 v[44:47], v13 offset:592
ds_read_b128 v[48:51], v13 offset:608
ds_read_b128 v[52:55], v13 offset:480
ds_read_b128 v[56:59], v13 offset:496
ds_read_b128 v[60:63], v13 offset:512
ds_read_b128 v[64:67], v13 offset:384
ds_read_b128 v[68:71], v13 offset:400
ds_read_b128 v[72:75], v13 offset:416
ds_read_b128 v[76:79], v13 offset:288
ds_read_b128 v[80:83], v13 offset:304
ds_read_b128 v[84:87], v13 offset:320
ds_read_b128 v[88:91], v13 offset:192
ds_read_b128 v[92:95], v13 offset:208
ds_read_b128 v[96:99], v13 offset:224
ds_read_b128 v[100:103], v13 offset:96
ds_read_b128 v[104:107], v13 offset:112
ds_read_b128 v[108:111], v13 offset:128
ds_read_b128 v[112:115], v13 offset:0
ds_read_b128 v[116:119], v13 offset:16
ds_read_b128 v[120:123], v13 offset:32
s_waitcnt lgkmcnt(0)
ds_read_b128 v[124:127], v14 offset:1120
ds_read_b128 v[128:131], v14 offset:1136
ds_read_b128 v[132:135], v14 offset:1152
ds_read_b128 v[136:139], v14 offset:1168
ds_read_b128 v[140:143], v14 offset:1184
ds_read_b128 v[144:147], v14 offset:960
ds_read_b128 v[148:151], v14 offset:976
ds_read_b128 v[152:155], v14 offset:992
ds_read_b128 v[156:159], v14 offset:1008
ds_read_b128 v[160:163], v14 offset:1024
ds_read_b128 v[164:167], v14 offset:800
ds_read_b128 v[168:171], v14 offset:816
ds_read_b128 v[172:175], v14 offset:832
ds_read_b128 v[176:179], v14 offset:848
ds_read_b128 v[180:183], v14 offset:864
ds_read_b128 v[184:187], v14 offset:640
ds_read_b128 v[188:191], v14 offset:656
ds_read_b128 v[192:195], v14 offset:672
ds_read_b128 v[196:199], v14 offset:688
ds_read_b128 v[200:203], v14 offset:704
v_dot2_f32_bf16 v204, v16, v28, 0
v_dot2_f32_bf16 v205, v16, v40, 0
v_dot2_f32_bf16 v206, v16, v52, 0
v_dot2_f32_bf16 v207, v16, v64, 0
v_dot2_f32_bf16 v208, v16, v76, 0
v_dot2_f32_bf16 v209, v16, v88, 0
v_dot2_f32_bf16 v210, v16, v100, 0
v_dot2_f32_bf16 v211, v16, v112, 0
v_dot2_f32_bf16 v204, v17, v29, v204
v_dot2_f32_bf16 v205, v17, v41, v205
v_dot2_f32_bf16 v206, v17, v53, v206
v_dot2_f32_bf16 v207, v17, v65, v207
v_dot2_f32_bf16 v208, v17, v77, v208
v_dot2_f32_bf16 v209, v17, v89, v209
v_dot2_f32_bf16 v210, v17, v101, v210
v_dot2_f32_bf16 v211, v17, v113, v211
v_dot2_f32_bf16 v204, v18, v30, v204
v_dot2_f32_bf16 v205, v18, v42, v205
v_dot2_f32_bf16 v206, v18, v54, v206
v_dot2_f32_bf16 v207, v18, v66, v207
v_dot2_f32_bf16 v208, v18, v78, v208
v_dot2_f32_bf16 v209, v18, v90, v209
v_dot2_f32_bf16 v210, v18, v102, v210
v_dot2_f32_bf16 v211, v18, v114, v211
v_dot2_f32_bf16 v204, v19, v31, v204
v_dot2_f32_bf16 v205, v19, v43, v205
v_dot2_f32_bf16 v206, v19, v55, v206
v_dot2_f32_bf16 v207, v19, v67, v207
v_dot2_f32_bf16 v208, v19, v79, v208
v_dot2_f32_bf16 v209, v19, v91, v209
v_dot2_f32_bf16 v210, v19, v103, v210
v_dot2_f32_bf16 v211, v19, v115, v211
v_dot2_f32_bf16 v204, v20, v32, v204
v_dot2_f32_bf16 v205, v20, v44, v205
v_dot2_f32_bf16 v206, v20, v56, v206
v_dot2_f32_bf16 v207, v20, v68, v207
v_dot2_f32_bf16 v208, v20, v80, v208
v_dot2_f32_bf16 v209, v20, v92, v209
v_dot2_f32_bf16 v210, v20, v104, v210
v_dot2_f32_bf16 v211, v20, v116, v211
v_dot2_f32_bf16 v204, v21, v33, v204
v_dot2_f32_bf16 v205, v21, v45, v205
v_dot2_f32_bf16 v206, v21, v57, v206
v_dot2_f32_bf16 v207, v21, v69, v207
v_dot2_f32_bf16 v208, v21, v81, v208
v_dot2_f32_bf16 v209, v21, v93, v209
v_dot2_f32_bf16 v210, v21, v105, v210
v_dot2_f32_bf16 v211, v21, v117, v211
v_dot2_f32_bf16 v204, v22, v34, v204
v_dot2_f32_bf16 v205, v22, v46, v205
v_dot2_f32_bf16 v206, v22, v58, v206
v_dot2_f32_bf16 v207, v22, v70, v207
v_dot2_f32_bf16 v208, v22, v82, v208
v_dot2_f32_bf16 v209, v22, v94, v209
v_dot2_f32_bf16 v210, v22, v106, v210
v_dot2_f32_bf16 v211, v22, v118, v211
v_dot2_f32_bf16 v204, v23, v35, v204
v_dot2_f32_bf16 v205, v23, v47, v205
v_dot2_f32_bf16 v206, v23, v59, v206
v_dot2_f32_bf16 v207, v23, v71, v207
v_dot2_f32_bf16 v208, v23, v83, v208
v_dot2_f32_bf16 v209, v23, v95, v209
v_dot2_f32_bf16 v210, v23, v107, v210
v_dot2_f32_bf16 v211, v23, v119, v211
v_dot2_f32_bf16 v204, v24, v36, v204
v_dot2_f32_bf16 v205, v24, v48, v205
v_dot2_f32_bf16 v206, v24, v60, v206
v_dot2_f32_bf16 v207, v24, v72, v207
v_dot2_f32_bf16 v208, v24, v84, v208
v_dot2_f32_bf16 v209, v24, v96, v209
v_dot2_f32_bf16 v210, v24, v108, v210
v_dot2_f32_bf16 v211, v24, v120, v211
v_dot2_f32_bf16 v204, v25, v37, v204
v_dot2_f32_bf16 v205, v25, v49, v205
v_dot2_f32_bf16 v206, v25, v61, v206
v_dot2_f32_bf16 v207, v25, v73, v207
v_dot2_f32_bf16 v208, v25, v85, v208
v_dot2_f32_bf16 v209, v25, v97, v209
v_dot2_f32_bf16 v210, v25, v109, v210
v_dot2_f32_bf16 v211, v25, v121, v211
s_nop 2
s_waitcnt lgkmcnt(0)
ds_read_b128 v[28:31], v14 offset:480
ds_read_b128 v[32:35], v14 offset:496
ds_read_b128 v[36:39], v14 offset:512
ds_read_b128 v[40:43], v14 offset:528
ds_read_b128 v[44:47], v14 offset:544
ds_read_b128 v[48:51], v14 offset:320
ds_read_b128 v[52:55], v14 offset:336
ds_read_b128 v[56:59], v14 offset:352
ds_read_b128 v[60:63], v14 offset:368
ds_read_b128 v[64:67], v14 offset:384
ds_read_b128 v[68:71], v14 offset:160
ds_read_b128 v[72:75], v14 offset:176
ds_read_b128 v[76:79], v14 offset:192
ds_read_b128 v[80:83], v14 offset:208
ds_read_b128 v[84:87], v14 offset:224
ds_read_b128 v[88:91], v14 offset:0
ds_read_b128 v[92:95], v14 offset:16
ds_read_b128 v[96:99], v14 offset:32
ds_read_b128 v[100:103], v14 offset:48
ds_read_b128 v[104:107], v14 offset:64
s_mov_b32 s24, 0x3ea52b5c
s_lshl_b32 s25, s4, 7
v_add_u32 v9, s25, v10
v_mov_b32 v8, 0xceabfb8f
v_mul_f32 v204, s24, v204
v_mul_f32 v205, s24, v205
v_mul_f32 v206, s24, v206
v_mul_f32 v207, s24, v207
v_mul_f32 v208, s24, v208
v_mul_f32 v209, s24, v209
v_mul_f32 v210, s24, v210
v_mul_f32 v211, s24, v211
v_cmp_le_u32 vcc, 2, v9
s_nop 1
v_cndmask_b32 v205, v8, v205, vcc
v_cmp_le_u32 vcc, 4, v9
s_nop 1
v_cndmask_b32 v206, v8, v206, vcc
v_cmp_le_u32 vcc, 6, v9
s_nop 1
v_cndmask_b32 v207, v8, v207, vcc
v_cmp_le_u32 vcc, 8, v9
s_nop 1
v_cndmask_b32 v208, v8, v208, vcc
v_cmp_le_u32 vcc, 10, v9
s_nop 1
v_cndmask_b32 v209, v8, v209, vcc
v_cmp_le_u32 vcc, 12, v9
s_nop 1
v_cndmask_b32 v210, v8, v210, vcc
v_cmp_le_u32 vcc, 14, v9
s_nop 1
v_cndmask_b32 v211, v8, v211, vcc
v_max3_f32 v7, v204, v205, v206
v_max3_f32 v7, v7, v207, v208
v_max3_f32 v7, v7, v209, v210
v_max_f32 v7, v7, v211
v_sub_f32 v204, v204, v7
v_sub_f32 v205, v205, v7
v_sub_f32 v206, v206, v7
v_sub_f32 v207, v207, v7
v_sub_f32 v208, v208, v7
v_sub_f32 v209, v209, v7
v_sub_f32 v210, v210, v7
v_sub_f32 v211, v211, v7
v_exp_f32 v232, v204
v_exp_f32 v233, v205
v_exp_f32 v234, v206
v_exp_f32 v235, v207
v_exp_f32 v236, v208
v_exp_f32 v237, v209
v_exp_f32 v238, v210
v_exp_f32 v239, v211
s_nop 1
v_add_f32 v7, v232, v233
v_add_f32 v7, v7, v234
v_add_f32 v7, v7, v235
v_add_f32 v7, v7, v236
v_add_f32 v7, v7, v237
v_add_f32 v7, v7, v238
v_add_f32 v7, v7, v239
v_rcp_f32 v7, v7
v_pk_mul_f32 v[212:213], v[124:125], v[232:233] op_sel:[0,0] op_sel_hi:[1,0]
v_pk_mul_f32 v[214:215], v[126:127], v[232:233] op_sel:[0,0] op_sel_hi:[1,0]
v_pk_mul_f32 v[216:217], v[128:129], v[232:233] op_sel:[0,0] op_sel_hi:[1,0]
v_pk_mul_f32 v[218:219], v[130:131], v[232:233] op_sel:[0,0] op_sel_hi:[1,0]
v_pk_mul_f32 v[220:221], v[132:133], v[232:233] op_sel:[0,0] op_sel_hi:[1,0]
v_pk_mul_f32 v[222:223], v[134:135], v[232:233] op_sel:[0,0] op_sel_hi:[1,0]
v_pk_mul_f32 v[224:225], v[136:137], v[232:233] op_sel:[0,0] op_sel_hi:[1,0]
v_pk_mul_f32 v[226:227], v[138:139], v[232:233] op_sel:[0,0] op_sel_hi:[1,0]
v_pk_mul_f32 v[228:229], v[140:141], v[232:233] op_sel:[0,0] op_sel_hi:[1,0]
v_pk_mul_f32 v[230:231], v[142:143], v[232:233] op_sel:[0,0] op_sel_hi:[1,0]
v_pk_fma_f32 v[212:213], v[144:145], v[232:233], v[212:213] op_sel:[0,1,0] op_sel_hi:[1,1,1]
v_pk_fma_f32 v[214:215], v[146:147], v[232:233], v[214:215] op_sel:[0,1,0] op_sel_hi:[1,1,1]
v_pk_fma_f32 v[216:217], v[148:149], v[232:233], v[216:217] op_sel:[0,1,0] op_sel_hi:[1,1,1]
v_pk_fma_f32 v[218:219], v[150:151], v[232:233], v[218:219] op_sel:[0,1,0] op_sel_hi:[1,1,1]
v_pk_fma_f32 v[220:221], v[152:153], v[232:233], v[220:221] op_sel:[0,1,0] op_sel_hi:[1,1,1]
v_pk_fma_f32 v[222:223], v[154:155], v[232:233], v[222:223] op_sel:[0,1,0] op_sel_hi:[1,1,1]
v_pk_fma_f32 v[224:225], v[156:157], v[232:233], v[224:225] op_sel:[0,1,0] op_sel_hi:[1,1,1]
v_pk_fma_f32 v[226:227], v[158:159], v[232:233], v[226:227] op_sel:[0,1,0] op_sel_hi:[1,1,1]
v_pk_fma_f32 v[228:229], v[160:161], v[232:233], v[228:229] op_sel:[0,1,0] op_sel_hi:[1,1,1]
v_pk_fma_f32 v[230:231], v[162:163], v[232:233], v[230:231] op_sel:[0,1,0] op_sel_hi:[1,1,1]
v_pk_fma_f32 v[212:213], v[164:165], v[234:235], v[212:213] op_sel:[0,0,0] op_sel_hi:[1,0,1]
v_pk_fma_f32 v[214:215], v[166:167], v[234:235], v[214:215] op_sel:[0,0,0] op_sel_hi:[1,0,1]
v_pk_fma_f32 v[216:217], v[168:169], v[234:235], v[216:217] op_sel:[0,0,0] op_sel_hi:[1,0,1]
v_pk_fma_f32 v[218:219], v[170:171], v[234:235], v[218:219] op_sel:[0,0,0] op_sel_hi:[1,0,1]
v_pk_fma_f32 v[220:221], v[172:173], v[234:235], v[220:221] op_sel:[0,0,0] op_sel_hi:[1,0,1]
v_pk_fma_f32 v[222:223], v[174:175], v[234:235], v[222:223] op_sel:[0,0,0] op_sel_hi:[1,0,1]
v_pk_fma_f32 v[224:225], v[176:177], v[234:235], v[224:225] op_sel:[0,0,0] op_sel_hi:[1,0,1]
v_pk_fma_f32 v[226:227], v[178:179], v[234:235], v[226:227] op_sel:[0,0,0] op_sel_hi:[1,0,1]
v_pk_fma_f32 v[228:229], v[180:181], v[234:235], v[228:229] op_sel:[0,0,0] op_sel_hi:[1,0,1]
v_pk_fma_f32 v[230:231], v[182:183], v[234:235], v[230:231] op_sel:[0,0,0] op_sel_hi:[1,0,1]
v_pk_fma_f32 v[212:213], v[184:185], v[234:235], v[212:213] op_sel:[0,1,0] op_sel_hi:[1,1,1]
v_pk_fma_f32 v[214:215], v[186:187], v[234:235], v[214:215] op_sel:[0,1,0] op_sel_hi:[1,1,1]
v_pk_fma_f32 v[216:217], v[188:189], v[234:235], v[216:217] op_sel:[0,1,0] op_sel_hi:[1,1,1]
v_pk_fma_f32 v[218:219], v[190:191], v[234:235], v[218:219] op_sel:[0,1,0] op_sel_hi:[1,1,1]
v_pk_fma_f32 v[220:221], v[192:193], v[234:235], v[220:221] op_sel:[0,1,0] op_sel_hi:[1,1,1]
v_pk_fma_f32 v[222:223], v[194:195], v[234:235], v[222:223] op_sel:[0,1,0] op_sel_hi:[1,1,1]
v_pk_fma_f32 v[224:225], v[196:197], v[234:235], v[224:225] op_sel:[0,1,0] op_sel_hi:[1,1,1]
v_pk_fma_f32 v[226:227], v[198:199], v[234:235], v[226:227] op_sel:[0,1,0] op_sel_hi:[1,1,1]
v_pk_fma_f32 v[228:229], v[200:201], v[234:235], v[228:229] op_sel:[0,1,0] op_sel_hi:[1,1,1]
v_pk_fma_f32 v[230:231], v[202:203], v[234:235], v[230:231] op_sel:[0,1,0] op_sel_hi:[1,1,1]
s_waitcnt lgkmcnt(0)
v_pk_fma_f32 v[212:213], v[28:29], v[236:237], v[212:213] op_sel:[0,0,0] op_sel_hi:[1,0,1]
v_pk_fma_f32 v[214:215], v[30:31], v[236:237], v[214:215] op_sel:[0,0,0] op_sel_hi:[1,0,1]
v_pk_fma_f32 v[216:217], v[32:33], v[236:237], v[216:217] op_sel:[0,0,0] op_sel_hi:[1,0,1]
v_pk_fma_f32 v[218:219], v[34:35], v[236:237], v[218:219] op_sel:[0,0,0] op_sel_hi:[1,0,1]
v_pk_fma_f32 v[220:221], v[36:37], v[236:237], v[220:221] op_sel:[0,0,0] op_sel_hi:[1,0,1]
v_pk_fma_f32 v[222:223], v[38:39], v[236:237], v[222:223] op_sel:[0,0,0] op_sel_hi:[1,0,1]
v_pk_fma_f32 v[224:225], v[40:41], v[236:237], v[224:225] op_sel:[0,0,0] op_sel_hi:[1,0,1]
v_pk_fma_f32 v[226:227], v[42:43], v[236:237], v[226:227] op_sel:[0,0,0] op_sel_hi:[1,0,1]
v_pk_fma_f32 v[228:229], v[44:45], v[236:237], v[228:229] op_sel:[0,0,0] op_sel_hi:[1,0,1]
v_pk_fma_f32 v[230:231], v[46:47], v[236:237], v[230:231] op_sel:[0,0,0] op_sel_hi:[1,0,1]
v_pk_fma_f32 v[212:213], v[48:49], v[236:237], v[212:213] op_sel:[0,1,0] op_sel_hi:[1,1,1]
v_pk_fma_f32 v[214:215], v[50:51], v[236:237], v[214:215] op_sel:[0,1,0] op_sel_hi:[1,1,1]
v_pk_fma_f32 v[216:217], v[52:53], v[236:237], v[216:217] op_sel:[0,1,0] op_sel_hi:[1,1,1]
v_pk_fma_f32 v[218:219], v[54:55], v[236:237], v[218:219] op_sel:[0,1,0] op_sel_hi:[1,1,1]
v_pk_fma_f32 v[220:221], v[56:57], v[236:237], v[220:221] op_sel:[0,1,0] op_sel_hi:[1,1,1]
v_pk_fma_f32 v[222:223], v[58:59], v[236:237], v[222:223] op_sel:[0,1,0] op_sel_hi:[1,1,1]
v_pk_fma_f32 v[224:225], v[60:61], v[236:237], v[224:225] op_sel:[0,1,0] op_sel_hi:[1,1,1]
v_pk_fma_f32 v[226:227], v[62:63], v[236:237], v[226:227] op_sel:[0,1,0] op_sel_hi:[1,1,1]
v_pk_fma_f32 v[228:229], v[64:65], v[236:237], v[228:229] op_sel:[0,1,0] op_sel_hi:[1,1,1]
v_pk_fma_f32 v[230:231], v[66:67], v[236:237], v[230:231] op_sel:[0,1,0] op_sel_hi:[1,1,1]
v_pk_fma_f32 v[212:213], v[68:69], v[238:239], v[212:213] op_sel:[0,0,0] op_sel_hi:[1,0,1]
v_pk_fma_f32 v[214:215], v[70:71], v[238:239], v[214:215] op_sel:[0,0,0] op_sel_hi:[1,0,1]
v_pk_fma_f32 v[216:217], v[72:73], v[238:239], v[216:217] op_sel:[0,0,0] op_sel_hi:[1,0,1]
v_pk_fma_f32 v[218:219], v[74:75], v[238:239], v[218:219] op_sel:[0,0,0] op_sel_hi:[1,0,1]
v_pk_fma_f32 v[220:221], v[76:77], v[238:239], v[220:221] op_sel:[0,0,0] op_sel_hi:[1,0,1]
v_pk_fma_f32 v[222:223], v[78:79], v[238:239], v[222:223] op_sel:[0,0,0] op_sel_hi:[1,0,1]
v_pk_fma_f32 v[224:225], v[80:81], v[238:239], v[224:225] op_sel:[0,0,0] op_sel_hi:[1,0,1]
v_pk_fma_f32 v[226:227], v[82:83], v[238:239], v[226:227] op_sel:[0,0,0] op_sel_hi:[1,0,1]
v_pk_fma_f32 v[228:229], v[84:85], v[238:239], v[228:229] op_sel:[0,0,0] op_sel_hi:[1,0,1]
v_pk_fma_f32 v[230:231], v[86:87], v[238:239], v[230:231] op_sel:[0,0,0] op_sel_hi:[1,0,1]
v_pk_fma_f32 v[212:213], v[88:89], v[238:239], v[212:213] op_sel:[0,1,0] op_sel_hi:[1,1,1]
v_pk_fma_f32 v[214:215], v[90:91], v[238:239], v[214:215] op_sel:[0,1,0] op_sel_hi:[1,1,1]
v_pk_fma_f32 v[216:217], v[92:93], v[238:239], v[216:217] op_sel:[0,1,0] op_sel_hi:[1,1,1]
v_pk_fma_f32 v[218:219], v[94:95], v[238:239], v[218:219] op_sel:[0,1,0] op_sel_hi:[1,1,1]
v_pk_fma_f32 v[220:221], v[96:97], v[238:239], v[220:221] op_sel:[0,1,0] op_sel_hi:[1,1,1]
v_pk_fma_f32 v[222:223], v[98:99], v[238:239], v[222:223] op_sel:[0,1,0] op_sel_hi:[1,1,1]
v_pk_fma_f32 v[224:225], v[100:101], v[238:239], v[224:225] op_sel:[0,1,0] op_sel_hi:[1,1,1]
v_pk_fma_f32 v[226:227], v[102:103], v[238:239], v[226:227] op_sel:[0,1,0] op_sel_hi:[1,1,1]
v_pk_fma_f32 v[228:229], v[104:105], v[238:239], v[228:229] op_sel:[0,1,0] op_sel_hi:[1,1,1]
v_pk_fma_f32 v[230:231], v[106:107], v[238:239], v[230:231] op_sel:[0,1,0] op_sel_hi:[1,1,1]
v_mov_b32 v6, v7
v_pk_mul_f32 v[212:213], v[212:213], v[6:7]
v_pk_mul_f32 v[214:215], v[214:215], v[6:7]
v_pk_mul_f32 v[216:217], v[216:217], v[6:7]
v_pk_mul_f32 v[218:219], v[218:219], v[6:7]
v_pk_mul_f32 v[220:221], v[220:221], v[6:7]
v_pk_mul_f32 v[222:223], v[222:223], v[6:7]
v_pk_mul_f32 v[224:225], v[224:225], v[6:7]
v_pk_mul_f32 v[226:227], v[226:227], v[6:7]
v_pk_mul_f32 v[228:229], v[228:229], v[6:7]
v_pk_mul_f32 v[230:231], v[230:231], v[6:7]
v_cvt_pk_bf16_f32 v16, v212, v213
v_cvt_pk_bf16_f32 v17, v214, v215
v_cvt_pk_bf16_f32 v18, v216, v217
v_cvt_pk_bf16_f32 v19, v218, v219
v_cvt_pk_bf16_f32 v20, v220, v221
v_cvt_pk_bf16_f32 v21, v222, v223
v_cvt_pk_bf16_f32 v22, v224, v225
v_cvt_pk_bf16_f32 v23, v226, v227
v_cvt_pk_bf16_f32 v24, v228, v229
v_cvt_pk_bf16_f32 v25, v230, v231
v_lshrrev_b32 v12, 4, v10
s_lshl_b32 s24, s4, 3
v_add_u32 v12, s24, v12
v_mul_u32_u24 v12, 20480, v12
v_and_b32 v13, 15, v10
v_lshlrev_b32 v13, 4, v13
v_add_u32 v12, v12, v13
v_lshlrev_b32 v13, 9, v11
v_add_u32 v13, v12, v13
v_lshlrev_b32 v14, 3, v11
v_add_u32 v14, v12, v14
s_mul_i32 s24, s5, 1280
s_add_u32 s24, s24, 29360128
buffer_store_dwordx4 v[16:19], v13, s[8:11], s24 offen sc1
buffer_store_dwordx4 v[20:23], v13, s[8:11], s24 offen offset:256 sc1
buffer_store_dwordx2 v[24:25], v14, s[8:11], s24 offen offset:1024 sc1
s_lshr_b32 s30, s89, 1
s_mul_i32 s32, s30, 102400
s_mul_i32 s33, s6, 25600
s_add_u32 s32, s32, s33
s_add_u32 s32, s32, 6291456
s_add_u32 s33, s32, 0
buffer_load_dwordx4 a[0:3], v2, s[8:11], s33 offen offset:0
s_add_u32 s33, s32, 0
buffer_load_dwordx4 a[4:7], v2, s[8:11], s33 offen offset:1024
s_add_u32 s33, s32, 0
buffer_load_dwordx4 a[8:11], v2, s[8:11], s33 offen offset:2048
s_add_u32 s33, s32, 0
buffer_load_dwordx4 a[12:15], v2, s[8:11], s33 offen offset:3072
s_add_u32 s33, s32, 4096
buffer_load_dwordx4 a[16:19], v2, s[8:11], s33 offen offset:0
s_add_u32 s33, s32, 4096
buffer_load_dwordx4 a[20:23], v2, s[8:11], s33 offen offset:1024
s_add_u32 s33, s32, 4096
buffer_load_dwordx4 a[24:27], v2, s[8:11], s33 offen offset:2048
s_add_u32 s33, s32, 4096
buffer_load_dwordx4 a[28:31], v2, s[8:11], s33 offen offset:3072
s_add_u32 s33, s32, 8192
buffer_load_dwordx4 a[32:35], v2, s[8:11], s33 offen offset:0
s_add_u32 s33, s32, 8192
buffer_load_dwordx4 a[36:39], v2, s[8:11], s33 offen offset:1024
s_add_u32 s33, s32, 8192
buffer_load_dwordx4 a[40:43], v2, s[8:11], s33 offen offset:2048
s_add_u32 s33, s32, 8192
buffer_load_dwordx4 a[44:47], v2, s[8:11], s33 offen offset:3072
s_waitcnt vmcnt(12)
s_barrier
s_cmp_lg_u32 s6, 0
s_cbranch_scc1 L_ar_15
v_mov_b32 v8, 1
v_mov_b32 v9, s20
s_mov_b64 exec, 1
buffer_atomic_add v8, v9, s[8:11], 0 offen sc1
s_mov_b64 exec, -1
L_ar_15:
s_mov_b32 s4, s88
s_mov_b32 s5, s89
s_mov_b32 s20, s90
s_lshr_b32 s30, s5, 1
s_and_b32 s31, s5, 1
s_add_u32 s33, s32, 12288
buffer_load_dwordx4 a[48:51], v2, s[8:11], s33 offen offset:0
s_add_u32 s33, s32, 12288
buffer_load_dwordx4 a[52:55], v2, s[8:11], s33 offen offset:1024
s_add_u32 s33, s32, 12288
buffer_load_dwordx4 a[56:59], v2, s[8:11], s33 offen offset:2048
s_add_u32 s33, s32, 12288
buffer_load_dwordx4 a[60:63], v2, s[8:11], s33 offen offset:3072
s_add_u32 s33, s32, 16384
buffer_load_dwordx4 a[64:67], v2, s[8:11], s33 offen offset:0
s_add_u32 s33, s32, 16384
buffer_load_dwordx4 a[68:71], v2, s[8:11], s33 offen offset:1024
s_add_u32 s33, s32, 16384
buffer_load_dwordx4 a[72:75], v2, s[8:11], s33 offen offset:2048
s_add_u32 s33, s32, 16384
buffer_load_dwordx4 a[76:79], v2, s[8:11], s33 offen offset:3072
s_add_u32 s33, s32, 20480
buffer_load_dwordx4 a[80:83], v2, s[8:11], s33 offen offset:0
s_add_u32 s33, s32, 20480
buffer_load_dwordx4 a[84:87], v2, s[8:11], s33 offen offset:1024
s_add_u32 s33, s32, 20480
buffer_load_dwordx4 a[88:91], v2, s[8:11], s33 offen offset:2048
s_add_u32 s33, s32, 20480
buffer_load_dwordx4 a[92:95], v2, s[8:11], s33 offen offset:3072
s_add_u32 s33, s32, 24576
buffer_load_dwordx4 a[96:99], v2, s[8:11], s33 offen offset:0
s_cmp_eq_u32 s6, 0
s_cbranch_scc1 L_dm_16
s_sub_u32 s58, s6, 1
s_mul_i32 s58, s58, 28672
s_add_u32 s58, s58, 61440
s_mul_i32 s59, s89, 143360
s_add_u32 s59, s59, s58
s_add_u32 s59, s59, 3145728
s_mov_b32 m0, s58
s_nop 0
buffer_load_dwordx4 v2, s[8:11], s59 offen offset:0 lds
buffer_load_dwordx4 v2, s[8:11], s59 offen offset:1024 lds
buffer_load_dwordx4 v2, s[8:11], s59 offen offset:2048 lds
buffer_load_dwordx4 v2, s[8:11], s59 offen offset:3072 lds
s_add_u32 s58, s58, 4096
s_add_u32 s59, s59, 4096
s_mov_b32 m0, s58
s_nop 0
buffer_load_dwordx4 v2, s[8:11], s59 offen offset:0 lds
buffer_load_dwordx4 v2, s[8:11], s59 offen offset:1024 lds
buffer_load_dwordx4 v2, s[8:11], s59 offen offset:2048 lds
buffer_load_dwordx4 v2, s[8:11], s59 offen offset:3072 lds
s_add_u32 s58, s58, 4096
s_add_u32 s59, s59, 4096
s_mov_b32 m0, s58
s_nop 0
buffer_load_dwordx4 v2, s[8:11], s59 offen offset:0 lds
buffer_load_dwordx4 v2, s[8:11], s59 offen offset:1024 lds
buffer_load_dwordx4 v2, s[8:11], s59 offen offset:2048 lds
buffer_load_dwordx4 v2, s[8:11], s59 offen offset:3072 lds
s_add_u32 s58, s58, 4096
s_add_u32 s59, s59, 4096
s_mov_b32 m0, s58
s_nop 0
buffer_load_dwordx4 v2, s[8:11], s59 offen offset:0 lds
buffer_load_dwordx4 v2, s[8:11], s59 offen offset:1024 lds
buffer_load_dwordx4 v2, s[8:11], s59 offen offset:2048 lds
buffer_load_dwordx4 v2, s[8:11], s59 offen offset:3072 lds
s_add_u32 s58, s58, 4096
s_add_u32 s59, s59, 4096
s_mov_b32 m0, s58
s_nop 0
buffer_load_dwordx4 v2, s[8:11], s59 offen offset:0 lds
buffer_load_dwordx4 v2, s[8:11], s59 offen offset:1024 lds
buffer_load_dwordx4 v2, s[8:11], s59 offen offset:2048 lds
buffer_load_dwordx4 v2, s[8:11], s59 offen offset:3072 lds
s_add_u32 s58, s58, 4096
s_add_u32 s59, s59, 4096
s_mov_b32 m0, s58
s_nop 0
buffer_load_dwordx4 v2, s[8:11], s59 offen offset:0 lds
buffer_load_dwordx4 v2, s[8:11], s59 offen offset:1024 lds
buffer_load_dwordx4 v2, s[8:11], s59 offen offset:2048 lds
buffer_load_dwordx4 v2, s[8:11], s59 offen offset:3072 lds
s_add_u32 s58, s58, 4096
s_add_u32 s59, s59, 4096
s_cmp_eq_u32 s6, 3
s_cbranch_scc1 L_dx_17
s_mov_b32 m0, s58
s_nop 0
buffer_load_dwordx4 v2, s[8:11], s59 offen offset:0 lds
buffer_load_dwordx4 v2, s[8:11], s59 offen offset:1024 lds
buffer_load_dwordx4 v2, s[8:11], s59 offen offset:2048 lds
buffer_load_dwordx4 v2, s[8:11], s59 offen offset:3072 lds
s_add_u32 s58, s58, 4096
s_add_u32 s59, s59, 4096
L_dx_17:
L_dm_16:
s_cmp_lg_u32 s6, 0
s_cbranch_scc1 L_pl_18
v_mov_b32 v9, s20
s_mov_b64 exec, 1
s_mov_b32 s21, 16
s_mov_b32 s22, 0
L_lp_19:
buffer_load_dword v6, v9, s[8:11], 0 offen sc1
s_waitcnt vmcnt(0)
v_cmp_gt_u32 vcc, s21, v6
s_cbranch_vccz L_dn_20
s_add_u32 s22, s22, 1
s_cmp_lt_u32 s22, 40000
s_cbranch_scc1 L_lp_19
L_dn_20:
s_mov_b64 exec, -1
L_pl_18:
s_barrier
s_lshl_b32 s34, s4, 3
s_lshl_b32 s35, s31, 2
s_add_u32 s34, s34, s35
s_add_u32 s35, s6, 0
s_and_b32 s35, s35, 3
s_add_u32 s35, s35, s34
s_mov_b32 s36, s35
s_mul_i32 s35, s35, 20480
v_add_u32 v232, s35, v2
s_add_u32 s35, s6, 1
s_and_b32 s35, s35, 3
s_add_u32 s35, s35, s34
s_mul_i32 s35, s35, 20480
v_add_u32 v233, s35, v2
s_add_u32 s35, s6, 2
s_and_b32 s35, s35, 3
s_add_u32 s35, s35, s34
s_mul_i32 s35, s35, 20480
v_add_u32 v234, s35, v2
s_add_u32 s35, s6, 3
s_and_b32 s35, s35, 3
s_add_u32 s35, s35, s34
s_mul_i32 s35, s35, 20480
v_add_u32 v235, s35, v2
s_mul_i32 s37, s6, 5120
s_add_u32 s37, s37, 29360128
buffer_load_dwordx4 v[120:123], v232, s[8:11], s37 offen offset:0 sc1
buffer_load_dwordx4 v[124:127], v233, s[8:11], s37 offen offset:0 sc1
buffer_load_dwordx4 v[128:131], v234, s[8:11], s37 offen offset:0 sc1
buffer_load_dwordx4 v[132:135], v235, s[8:11], s37 offen offset:0 sc1
buffer_load_dwordx4 v[136:139], v232, s[8:11], s37 offen offset:1024 sc1
buffer_load_dwordx4 v[140:143], v233, s[8:11], s37 offen offset:1024 sc1
buffer_load_dwordx4 v[144:147], v234, s[8:11], s37 offen offset:1024 sc1
buffer_load_dwordx4 v[148:151], v235, s[8:11], s37 offen offset:1024 sc1
buffer_load_dwordx4 v[152:155], v232, s[8:11], s37 offen offset:2048 sc1
buffer_load_dwordx4 v[156:159], v233, s[8:11], s37 offen offset:2048 sc1
buffer_load_dwordx4 v[160:163], v234, s[8:11], s37 offen offset:2048 sc1
buffer_load_dwordx4 v[164:167], v235, s[8:11], s37 offen offset:2048 sc1
buffer_load_dwordx4 v[168:171], v232, s[8:11], s37 offen offset:3072 sc1
buffer_load_dwordx4 v[172:175], v233, s[8:11], s37 offen offset:3072 sc1
buffer_load_dwordx4 v[176:179], v234, s[8:11], s37 offen offset:3072 sc1
buffer_load_dwordx4 v[180:183], v235, s[8:11], s37 offen offset:3072 sc1
s_add_u32 s37, s37, 4096
buffer_load_dwordx4 v[184:187], v232, s[8:11], s37 offen offset:0 sc1
buffer_load_dwordx4 v[188:191], v233, s[8:11], s37 offen offset:0 sc1
buffer_load_dwordx4 v[192:195], v234, s[8:11], s37 offen offset:0 sc1
buffer_load_dwordx4 v[196:199], v235, s[8:11], s37 offen offset:0 sc1
s_and_b32 s38, s30, 1
s_mul_i32 s39, s30, 5
s_add_u32 s40, s39, s38
s_lshr_b32 s40, s40, 1
s_xor_b32 s41, s38, 1
s_lshl_b32 s41, s41, 2
s_add_u32 s41, s41, s39
s_lshr_b32 s41, s41, 1
s_lshl_b32 s40, s40, 10
s_lshl_b32 s41, s41, 10
s_lshl_b32 s42, s38, 3
s_add_u32 s41, s41, s42
s_mul_i32 s42, s36, 20480
s_add_u32 s40, s40, s42
s_add_u32 s41, s41, s42
s_add_u32 s43, s40, 16777216
s_add_u32 s44, s41, 16777216
s_and_b32 s52, s88, 3
s_and_b32 s53, s89, 1
s_lshl_b32 s53, s53, 2
s_add_u32 s53, s53, s52
s_lshr_b32 s54, s89, 1
s_mul_i32 s56, s54, 286720
s_mul_i32 s60, s53, 35840
s_add_u32 s56, s56, s60
s_mul_i32 s60, s6, 8192
s_add_u32 s56, s56, s60
s_add_u32 s56, s56, 7340032
s_waitcnt vmcnt(16)
v_mfma_f32_16x16x32_bf16 v[16:19], a[0:3], v[120:123], 0
v_mfma_f32_16x16x32_bf16 v[20:23], a[4:7], v[120:123], 0
buffer_load_dwordx4 v[240:243], v2, s[8:11], s43 offen sc1
v_mfma_f32_16x16x32_bf16 v[24:27], a[8:11], v[120:123], 0
v_mfma_f32_16x16x32_bf16 v[28:31], a[12:15], v[120:123], 0
v_mfma_f32_16x16x32_bf16 v[32:35], a[16:19], v[120:123], 0
v_mfma_f32_16x16x32_bf16 v[36:39], a[0:3], v[124:127], 0
v_mfma_f32_16x16x32_bf16 v[40:43], a[4:7], v[124:127], 0
v_mfma_f32_16x16x32_bf16 v[44:47], a[8:11], v[124:127], 0
buffer_load_dwordx4 v[244:247], v2, s[8:11], s43 offen offset:1024 sc1
v_mfma_f32_16x16x32_bf16 v[48:51], a[12:15], v[124:127], 0
v_mfma_f32_16x16x32_bf16 v[52:55], a[16:19], v[124:127], 0
v_mfma_f32_16x16x32_bf16 v[56:59], a[0:3], v[128:131], 0
v_mfma_f32_16x16x32_bf16 v[60:63], a[4:7], v[128:131], 0
v_mfma_f32_16x16x32_bf16 v[64:67], a[8:11], v[128:131], 0
v_mfma_f32_16x16x32_bf16 v[68:71], a[12:15], v[128:131], 0
v_mfma_f32_16x16x32_bf16 v[72:75], a[16:19], v[128:131], 0
buffer_load_dwordx2 v[248:249], v2, s[8:11], s44 offen sc1
v_mfma_f32_16x16x32_bf16 v[76:79], a[0:3], v[132:135], 0
v_mfma_f32_16x16x32_bf16 v[80:83], a[4:7], v[132:135], 0
v_mfma_f32_16x16x32_bf16 v[84:87], a[8:11], v[132:135], 0
v_mfma_f32_16x16x32_bf16 v[88:91], a[12:15], v[132:135], 0
v_mfma_f32_16x16x32_bf16 v[92:95], a[16:19], v[132:135], 0
s_waitcnt vmcnt(15)
v_mfma_f32_16x16x32_bf16 v[16:19], a[20:23], v[136:139], v[16:19]
v_mfma_f32_16x16x32_bf16 v[20:23], a[24:27], v[136:139], v[20:23]
buffer_load_dword v254, v253, s[8:11], s56 offen
v_mfma_f32_16x16x32_bf16 v[24:27], a[28:31], v[136:139], v[24:27]
v_mfma_f32_16x16x32_bf16 v[28:31], a[32:35], v[136:139], v[28:31]
v_mfma_f32_16x16x32_bf16 v[32:35], a[36:39], v[136:139], v[32:35]
v_mfma_f32_16x16x32_bf16 v[36:39], a[20:23], v[140:143], v[36:39]
v_mfma_f32_16x16x32_bf16 v[40:43], a[24:27], v[140:143], v[40:43]
v_mfma_f32_16x16x32_bf16 v[44:47], a[28:31], v[140:143], v[44:47]
v_mfma_f32_16x16x32_bf16 v[48:51], a[32:35], v[140:143], v[48:51]
v_mfma_f32_16x16x32_bf16 v[52:55], a[36:39], v[140:143], v[52:55]
v_mfma_f32_16x16x32_bf16 v[56:59], a[20:23], v[144:147], v[56:59]
v_mfma_f32_16x16x32_bf16 v[60:63], a[24:27], v[144:147], v[60:63]
v_mfma_f32_16x16x32_bf16 v[64:67], a[28:31], v[144:147], v[64:67]
v_mfma_f32_16x16x32_bf16 v[68:71], a[32:35], v[144:147], v[68:71]
v_mfma_f32_16x16x32_bf16 v[72:75], a[36:39], v[144:147], v[72:75]
v_mfma_f32_16x16x32_bf16 v[76:79], a[20:23], v[148:151], v[76:79]
v_mfma_f32_16x16x32_bf16 v[80:83], a[24:27], v[148:151], v[80:83]
v_mfma_f32_16x16x32_bf16 v[84:87], a[28:31], v[148:151], v[84:87]
v_mfma_f32_16x16x32_bf16 v[88:91], a[32:35], v[148:151], v[88:91]
v_mfma_f32_16x16x32_bf16 v[92:95], a[36:39], v[148:151], v[92:95]
s_waitcnt vmcnt(12)
v_mfma_f32_16x16x32_bf16 v[16:19], a[40:43], v[152:155], v[16:19]
v_mfma_f32_16x16x32_bf16 v[20:23], a[44:47], v[152:155], v[20:23]
v_mfma_f32_16x16x32_bf16 v[24:27], a[48:51], v[152:155], v[24:27]
v_mfma_f32_16x16x32_bf16 v[28:31], a[52:55], v[152:155], v[28:31]
v_mfma_f32_16x16x32_bf16 v[32:35], a[56:59], v[152:155], v[32:35]
v_mfma_f32_16x16x32_bf16 v[36:39], a[40:43], v[156:159], v[36:39]
v_mfma_f32_16x16x32_bf16 v[40:43], a[44:47], v[156:159], v[40:43]
v_mfma_f32_16x16x32_bf16 v[44:47], a[48:51], v[156:159], v[44:47]
v_mfma_f32_16x16x32_bf16 v[48:51], a[52:55], v[156:159], v[48:51]
v_mfma_f32_16x16x32_bf16 v[52:55], a[56:59], v[156:159], v[52:55]
v_mfma_f32_16x16x32_bf16 v[56:59], a[40:43], v[160:163], v[56:59]
v_mfma_f32_16x16x32_bf16 v[60:63], a[44:47], v[160:163], v[60:63]
v_mfma_f32_16x16x32_bf16 v[64:67], a[48:51], v[160:163], v[64:67]
v_mfma_f32_16x16x32_bf16 v[68:71], a[52:55], v[160:163], v[68:71]
v_mfma_f32_16x16x32_bf16 v[72:75], a[56:59], v[160:163], v[72:75]
v_mfma_f32_16x16x32_bf16 v[76:79], a[40:43], v[164:167], v[76:79]
v_mfma_f32_16x16x32_bf16 v[80:83], a[44:47], v[164:167], v[80:83]
v_mfma_f32_16x16x32_bf16 v[84:87], a[48:51], v[164:167], v[84:87]
v_mfma_f32_16x16x32_bf16 v[88:91], a[52:55], v[164:167], v[88:91]
v_mfma_f32_16x16x32_bf16 v[92:95], a[56:59], v[164:167], v[92:95]
s_waitcnt vmcnt(8)
v_mfma_f32_16x16x32_bf16 v[16:19], a[60:63], v[168:171], v[16:19]
v_mfma_f32_16x16x32_bf16 v[20:23], a[64:67], v[168:171], v[20:23]
v_mfma_f32_16x16x32_bf16 v[24:27], a[68:71], v[168:171], v[24:27]
v_mfma_f32_16x16x32_bf16 v[28:31], a[72:75], v[168:171], v[28:31]
v_mfma_f32_16x16x32_bf16 v[32:35], a[76:79], v[168:171], v[32:35]
v_mfma_f32_16x16x32_bf16 v[36:39], a[60:63], v[172:175], v[36:39]
v_mfma_f32_16x16x32_bf16 v[40:43], a[64:67], v[172:175], v[40:43]
v_mfma_f32_16x16x32_bf16 v[44:47], a[68:71], v[172:175], v[44:47]
v_mfma_f32_16x16x32_bf16 v[48:51], a[72:75], v[172:175], v[48:51]
v_mfma_f32_16x16x32_bf16 v[52:55], a[76:79], v[172:175], v[52:55]
v_mfma_f32_16x16x32_bf16 v[56:59], a[60:63], v[176:179], v[56:59]
v_mfma_f32_16x16x32_bf16 v[60:63], a[64:67], v[176:179], v[60:63]
v_mfma_f32_16x16x32_bf16 v[64:67], a[68:71], v[176:179], v[64:67]
v_mfma_f32_16x16x32_bf16 v[68:71], a[72:75], v[176:179], v[68:71]
v_mfma_f32_16x16x32_bf16 v[72:75], a[76:79], v[176:179], v[72:75]
v_mfma_f32_16x16x32_bf16 v[76:79], a[60:63], v[180:183], v[76:79]
v_mfma_f32_16x16x32_bf16 v[80:83], a[64:67], v[180:183], v[80:83]
v_mfma_f32_16x16x32_bf16 v[84:87], a[68:71], v[180:183], v[84:87]
v_mfma_f32_16x16x32_bf16 v[88:91], a[72:75], v[180:183], v[88:91]
v_mfma_f32_16x16x32_bf16 v[92:95], a[76:79], v[180:183], v[92:95]
s_waitcnt vmcnt(4)
v_mfma_f32_16x16x32_bf16 v[16:19], a[80:83], v[184:187], v[16:19]
v_mfma_f32_16x16x32_bf16 v[20:23], a[84:87], v[184:187], v[20:23]
v_mfma_f32_16x16x32_bf16 v[24:27], a[88:91], v[184:187], v[24:27]
v_mfma_f32_16x16x32_bf16 v[28:31], a[92:95], v[184:187], v[28:31]
v_mfma_f32_16x16x32_bf16 v[32:35], a[96:99], v[184:187], v[32:35]
v_mfma_f32_16x16x32_bf16 v[36:39], a[80:83], v[188:191], v[36:39]
v_mfma_f32_16x16x32_bf16 v[40:43], a[84:87], v[188:191], v[40:43]
v_mfma_f32_16x16x32_bf16 v[44:47], a[88:91], v[188:191], v[44:47]
v_mfma_f32_16x16x32_bf16 v[48:51], a[92:95], v[188:191], v[48:51]
v_mfma_f32_16x16x32_bf16 v[52:55], a[96:99], v[188:191], v[52:55]
v_mfma_f32_16x16x32_bf16 v[56:59], a[80:83], v[192:195], v[56:59]
v_mfma_f32_16x16x32_bf16 v[60:63], a[84:87], v[192:195], v[60:63]
v_mfma_f32_16x16x32_bf16 v[64:67], a[88:91], v[192:195], v[64:67]
v_mfma_f32_16x16x32_bf16 v[68:71], a[92:95], v[192:195], v[68:71]
v_mfma_f32_16x16x32_bf16 v[72:75], a[96:99], v[192:195], v[72:75]
v_mfma_f32_16x16x32_bf16 v[76:79], a[80:83], v[196:199], v[76:79]
v_mfma_f32_16x16x32_bf16 v[80:83], a[84:87], v[196:199], v[80:83]
v_mfma_f32_16x16x32_bf16 v[84:87], a[88:91], v[196:199], v[84:87]
v_mfma_f32_16x16x32_bf16 v[88:91], a[92:95], v[196:199], v[88:91]
v_mfma_f32_16x16x32_bf16 v[92:95], a[96:99], v[196:199], v[92:95]
s_nop 7
s_add_u32 s35, s6, 1
s_and_b32 s35, s35, 3
s_mul_i32 s35, s35, 15360
s_add_u32 s35, s35, 0
v_add_u32 v233, s35, v2
ds_write_b128 v233, v[36:39] offset:0
ds_write_b128 v233, v[40:43] offset:1024
ds_write_b128 v233, v[44:47] offset:2048
ds_write_b128 v233, v[48:51] offset:3072
ds_write_b128 v233, v[52:55] offset:4096
s_add_u32 s35, s6, 2
s_and_b32 s35, s35, 3
s_mul_i32 s35, s35, 15360
s_add_u32 s35, s35, 5120
v_add_u32 v234, s35, v2
ds_write_b128 v234, v[56:59] offset:0
ds_write_b128 v234, v[60:63] offset:1024
ds_write_b128 v234, v[64:67] offset:2048
ds_write_b128 v234, v[68:71] offset:3072
ds_write_b128 v234, v[72:75] offset:4096
s_add_u32 s35, s6, 3
s_and_b32 s35, s35, 3
s_mul_i32 s35, s35, 15360
s_add_u32 s35, s35, 10240
v_add_u32 v235, s35, v2
ds_write_b128 v235, v[76:79] offset:0
ds_write_b128 v235, v[80:83] offset:1024
ds_write_b128 v235, v[84:87] offset:2048
ds_write_b128 v235, v[88:91] offset:3072
ds_write_b128 v235, v[92:95] offset:4096
s_waitcnt lgkmcnt(0)
s_barrier
s_mul_i32 s35, s6, 15360
v_add_u32 v232, s35, v2
ds_read_b128 v[120:123], v232 offset:0
ds_read_b128 v[124:127], v232 offset:1024
ds_read_b128 v[128:131], v232 offset:2048
ds_read_b128 v[132:135], v232 offset:3072
ds_read_b128 v[136:139], v232 offset:4096
ds_read_b128 v[140:143], v232 offset:5120
ds_read_b128 v[144:147], v232 offset:6144
ds_read_b128 v[148:151], v232 offset:7168
ds_read_b128 v[152:155], v232 offset:8192
ds_read_b128 v[156:159], v232 offset:9216
ds_read_b128 v[160:163], v232 offset:10240
ds_read_b128 v[164:167], v232 offset:11264
ds_read_b128 v[168:171], v232 offset:12288
ds_read_b128 v[172:175], v232 offset:13312
ds_read_b128 v[176:179], v232 offset:14336
s_waitcnt lgkmcnt(10)
v_pk_add_f32 v[16:17], v[16:17], v[120:121]
v_pk_add_f32 v[18:19], v[18:19], v[122:123]
v_pk_add_f32 v[20:21], v[20:21], v[124:125]
v_pk_add_f32 v[22:23], v[22:23], v[126:127]
v_pk_add_f32 v[24:25], v[24:25], v[128:129]
v_pk_add_f32 v[26:27], v[26:27], v[130:131]
v_pk_add_f32 v[28:29], v[28:29], v[132:133]
v_pk_add_f32 v[30:31], v[30:31], v[134:135]
v_pk_add_f32 v[32:33], v[32:33], v[136:137]
v_pk_add_f32 v[34:35], v[34:35], v[138:139]
s_waitcnt lgkmcnt(5)
v_pk_add_f32 v[16:17], v[16:17], v[140:141]
v_pk_add_f32 v[18:19], v[18:19], v[142:143]
v_pk_add_f32 v[20:21], v[20:21], v[144:145]
v_pk_add_f32 v[22:23], v[22:23], v[146:147]
v_pk_add_f32 v[24:25], v[24:25], v[148:149]
v_pk_add_f32 v[26:27], v[26:27], v[150:151]
v_pk_add_f32 v[28:29], v[28:29], v[152:153]
v_pk_add_f32 v[30:31], v[30:31], v[154:155]
v_pk_add_f32 v[32:33], v[32:33], v[156:157]
v_pk_add_f32 v[34:35], v[34:35], v[158:159]
s_waitcnt vmcnt(1) lgkmcnt(0)
v_pk_add_f32 v[16:17], v[16:17], v[160:161]
v_pk_add_f32 v[18:19], v[18:19], v[162:163]
v_pk_add_f32 v[20:21], v[20:21], v[164:165]
v_pk_add_f32 v[22:23], v[22:23], v[166:167]
v_pk_add_f32 v[24:25], v[24:25], v[168:169]
v_pk_add_f32 v[26:27], v[26:27], v[170:171]
v_pk_add_f32 v[28:29], v[28:29], v[172:173]
v_pk_add_f32 v[30:31], v[30:31], v[174:175]
v_pk_add_f32 v[32:33], v[32:33], v[176:177]
v_pk_add_f32 v[34:35], v[34:35], v[178:179]
v_lshlrev_b32 v120, 16, v240
v_and_b32 v121, 0xffff0000, v240
v_add_f32 v16, v16, v120
v_add_f32 v17, v17, v121
v_cvt_pk_bf16_f32 v240, v16, v17
v_lshlrev_b32 v120, 16, v241
v_and_b32 v121, 0xffff0000, v241
v_add_f32 v18, v18, v120
v_add_f32 v19, v19, v121
v_cvt_pk_bf16_f32 v241, v18, v19
v_lshlrev_b32 v120, 16, v242
v_and_b32 v121, 0xffff0000, v242
v_add_f32 v20, v20, v120
v_add_f32 v21, v21, v121
v_cvt_pk_bf16_f32 v242, v20, v21
v_lshlrev_b32 v120, 16, v243
v_and_b32 v121, 0xffff0000, v243
v_add_f32 v22, v22, v120
v_add_f32 v23, v23, v121
v_cvt_pk_bf16_f32 v243, v22, v23
v_lshlrev_b32 v120, 16, v244
v_and_b32 v121, 0xffff0000, v244
v_add_f32 v24, v24, v120
v_add_f32 v25, v25, v121
v_cvt_pk_bf16_f32 v244, v24, v25
v_lshlrev_b32 v120, 16, v245
v_and_b32 v121, 0xffff0000, v245
v_add_f32 v26, v26, v120
v_add_f32 v27, v27, v121
v_cvt_pk_bf16_f32 v245, v26, v27
v_lshlrev_b32 v120, 16, v246
v_and_b32 v121, 0xffff0000, v246
v_add_f32 v28, v28, v120
v_add_f32 v29, v29, v121
v_cvt_pk_bf16_f32 v246, v28, v29
v_lshlrev_b32 v120, 16, v247
v_and_b32 v121, 0xffff0000, v247
v_add_f32 v30, v30, v120
v_add_f32 v31, v31, v121
v_cvt_pk_bf16_f32 v247, v30, v31
v_lshlrev_b32 v120, 16, v248
v_and_b32 v121, 0xffff0000, v248
v_add_f32 v32, v32, v120
v_add_f32 v33, v33, v121
v_cvt_pk_bf16_f32 v248, v32, v33
v_lshlrev_b32 v120, 16, v249
v_and_b32 v121, 0xffff0000, v249
v_add_f32 v34, v34, v120
v_add_f32 v35, v35, v121
v_cvt_pk_bf16_f32 v249, v34, v35
s_add_u32 s43, s40, 19922944
s_add_u32 s44, s41, 19922944
buffer_store_dwordx4 v[240:243], v2, s[8:11], s43 offen sc1
buffer_store_dwordx4 v[244:247], v2, s[8:11], s43 offen offset:1024 sc1
buffer_store_dwordx2 v[248:249], v2, s[8:11], s44 offen sc1
v_mov_b32 v6, 0
v_mov_b32 v7, 0
v_dot2_f32_bf16 v6, v240, s62, v6
v_dot2_f32_bf16 v7, v240, v240, v7
v_dot2_f32_bf16 v6, v241, s62, v6
v_dot2_f32_bf16 v7, v241, v241, v7
v_dot2_f32_bf16 v6, v242, s62, v6
v_dot2_f32_bf16 v7, v242, v242, v7
v_dot2_f32_bf16 v6, v243, s62, v6
v_dot2_f32_bf16 v7, v243, v243, v7
v_dot2_f32_bf16 v6, v244, s62, v6
v_dot2_f32_bf16 v7, v244, v244, v7
v_dot2_f32_bf16 v6, v245, s62, v6
v_dot2_f32_bf16 v7, v245, v245, v7
v_dot2_f32_bf16 v6, v246, s62, v6
v_dot2_f32_bf16 v7, v246, v246, v7
v_dot2_f32_bf16 v6, v247, s62, v6
v_dot2_f32_bf16 v7, v247, v247, v7
v_dot2_f32_bf16 v6, v248, s62, v6
v_dot2_f32_bf16 v7, v248, v248, v7
v_dot2_f32_bf16 v6, v249, s62, v6
v_dot2_f32_bf16 v7, v249, v249, v7
s_nop 2
v_mov_b32 v8, v6
s_nop 1
v_permlane32_swap_b32 v6, v8
s_nop 1
v_add_f32 v6, v6, v8
v_mov_b32 v8, v6
s_nop 1
v_permlane16_swap_b32 v6, v8
s_nop 1
v_add_f32 v6, v6, v8
v_mov_b32 v8, v7
s_nop 1
v_permlane32_swap_b32 v7, v8
s_nop 1
v_add_f32 v7, v7, v8
v_mov_b32 v8, v7
s_nop 1
v_permlane16_swap_b32 v7, v8
s_nop 1
v_add_f32 v7, v7, v8
s_lshl_b32 s35, s36, 10
s_lshl_b32 s42, s30, 7
s_add_u32 s35, s35, s42
s_add_u32 s35, s35, 52559872
v_lshlrev_b32 v8, 3, v3
s_mov_b64 exec, 0xffff
buffer_store_dwordx2 v[6:7], v8, s[8:11], s35 offen sc1
s_mov_b64 exec, -1
s_waitcnt vmcnt(0)
s_barrier
s_cmp_lg_u32 s6, 0
s_cbranch_scc1 L_ar_21
v_mov_b32 v8, 1
v_mov_b32 v9, s20
s_mov_b64 exec, 1
buffer_atomic_add v8, v9, s[8:11], 0 offen sc1
s_mov_b64 exec, -1
L_ar_21:
s_mov_b32 s4, s88
s_mov_b32 s5, s89
s_mov_b32 s20, s90
s_mul_i32 s30, s5, 143360
s_add_u32 s30, s30, 3145728
s_lshl_b32 s31, s2, 10
s_add_u32 s31, s31, 11010048
v_lshlrev_b32 v6, 4, v4
s_add_u32 s49, s31, 512
buffer_load_dwordx4 v[192:195], v6, s[8:11], s49 offen offset:0 sc1
buffer_load_dwordx4 v[196:199], v6, s[8:11], s49 offen offset:64 sc1
buffer_load_dwordx4 v[200:203], v6, s[8:11], s49 offen offset:128 sc1
buffer_load_dwordx4 v[204:207], v6, s[8:11], s49 offen offset:192 sc1
buffer_load_dwordx4 v[208:211], v6, s[8:11], s49 offen offset:256 sc1
buffer_load_dwordx4 v[212:215], v6, s[8:11], s49 offen offset:320 sc1
buffer_load_dwordx4 v[216:219], v6, s[8:11], s49 offen offset:384 sc1
s_cmp_eq_u32 s6, 0
s_cbranch_scc1 L_dm_22
s_mov_b32 s24, 0
s_cmp_eq_u32 s6, 2
s_cselect_b32 s24, 20480, s24
s_cmp_eq_u32 s6, 3
s_cselect_b32 s24, 40960, s24
s_add_u32 s25, s30, s24
s_mov_b32 m0, s24
s_nop 0
buffer_load_dwordx4 v2, s[8:11], s25 offen offset:0 lds
buffer_load_dwordx4 v2, s[8:11], s25 offen offset:1024 lds
buffer_load_dwordx4 v2, s[8:11], s25 offen offset:2048 lds
buffer_load_dwordx4 v2, s[8:11], s25 offen offset:3072 lds
s_add_u32 s24, s24, 4096
s_add_u32 s25, s25, 4096
s_mov_b32 m0, s24
s_nop 0
buffer_load_dwordx4 v2, s[8:11], s25 offen offset:0 lds
buffer_load_dwordx4 v2, s[8:11], s25 offen offset:1024 lds
buffer_load_dwordx4 v2, s[8:11], s25 offen offset:2048 lds
buffer_load_dwordx4 v2, s[8:11], s25 offen offset:3072 lds
s_add_u32 s24, s24, 4096
s_add_u32 s25, s25, 4096
s_mov_b32 m0, s24
s_nop 0
buffer_load_dwordx4 v2, s[8:11], s25 offen offset:0 lds
buffer_load_dwordx4 v2, s[8:11], s25 offen offset:1024 lds
buffer_load_dwordx4 v2, s[8:11], s25 offen offset:2048 lds
buffer_load_dwordx4 v2, s[8:11], s25 offen offset:3072 lds
s_add_u32 s24, s24, 4096
s_add_u32 s25, s25, 4096
s_mov_b32 m0, s24
s_nop 0
buffer_load_dwordx4 v2, s[8:11], s25 offen offset:0 lds
buffer_load_dwordx4 v2, s[8:11], s25 offen offset:1024 lds
buffer_load_dwordx4 v2, s[8:11], s25 offen offset:2048 lds
buffer_load_dwordx4 v2, s[8:11], s25 offen offset:3072 lds
s_add_u32 s24, s24, 4096
s_add_u32 s25, s25, 4096
s_mov_b32 m0, s24
s_nop 0
buffer_load_dwordx4 v2, s[8:11], s25 offen offset:0 lds
buffer_load_dwordx4 v2, s[8:11], s25 offen offset:1024 lds
buffer_load_dwordx4 v2, s[8:11], s25 offen offset:2048 lds
buffer_load_dwordx4 v2, s[8:11], s25 offen offset:3072 lds
s_add_u32 s24, s24, 4096
s_add_u32 s25, s25, 4096
L_dm_22:
s_cmp_lg_u32 s6, 0
s_cbranch_scc1 L_pl_23
v_mov_b32 v9, s20
s_mov_b64 exec, 1
s_mov_b32 s21, 32
s_mov_b32 s22, 0
L_lp_24:
buffer_load_dword v6, v9, s[8:11], 0 offen sc1
s_waitcnt vmcnt(0)
v_cmp_gt_u32 vcc, s21, v6
s_cbranch_vccz L_dn_25
s_add_u32 s22, s22, 1
s_cmp_lt_u32 s22, 40000
s_cbranch_scc1 L_lp_24
L_dn_25:
s_mov_b64 exec, -1
L_pl_23:
s_waitcnt vmcnt(0)
s_barrier
s_lshl_b32 s32, s4, 3
s_lshl_b32 s33, s6, 1
s_add_u32 s32, s32, s33
s_add_u32 s33, s32, 1
s_mul_i32 s24, s32, 20480
v_add_u32 v10, s24, v2
s_mul_i32 s24, s33, 20480
v_add_u32 v11, s24, v2
s_mov_b32 s45, 19922944
buffer_load_dwordx4 a[0:3], v10, s[8:11], s45 offen offset:0 sc1
buffer_load_dwordx4 a[4:7], v11, s[8:11], s45 offen offset:0 sc1
buffer_load_dwordx4 a[8:11], v10, s[8:11], s45 offen offset:1024 sc1
buffer_load_dwordx4 a[12:15], v11, s[8:11], s45 offen offset:1024 sc1
buffer_load_dwordx4 a[16:19], v10, s[8:11], s45 offen offset:2048 sc1
buffer_load_dwordx4 a[20:23], v11, s[8:11], s45 offen offset:2048 sc1
buffer_load_dwordx4 a[24:27], v10, s[8:11], s45 offen offset:3072 sc1
buffer_load_dwordx4 a[28:31], v11, s[8:11], s45 offen offset:3072 sc1
s_add_u32 s45, s45, 4096
buffer_load_dwordx4 a[32:35], v10, s[8:11], s45 offen offset:0 sc1
buffer_load_dwordx4 a[36:39], v11, s[8:11], s45 offen offset:0 sc1
buffer_load_dwordx4 a[40:43], v10, s[8:11], s45 offen offset:1024 sc1
buffer_load_dwordx4 a[44:47], v11, s[8:11], s45 offen offset:1024 sc1
v_lshlrev_b32 v5, 8, v4
v_lshlrev_b32 v6, 3, v3
v_add_u32 v5, v5, v6
s_lshl_b32 s46, s32, 10
s_add_u32 s46, s46, 52559872
s_lshl_b32 s47, s33, 10
s_add_u32 s47, s47, 52559872
s_and_b32 s52, s88, 3
s_and_b32 s53, s89, 1
s_lshl_b32 s53, s53, 2
s_add_u32 s53, s53, s52
s_lshr_b32 s54, s89, 1
v_mov_b32 v13, v2
ds_read_b128 v[88:91], v13 offset:0
ds_read_b128 v[92:95], v13 offset:1024
ds_read_b128 v[96:99], v13 offset:2048
ds_read_b128 v[100:103], v13 offset:3072
ds_read_b128 v[104:107], v13 offset:4096
ds_read_b128 v[108:111], v13 offset:5120
ds_read_b128 v[112:115], v13 offset:6144
s_waitcnt vmcnt(10) lgkmcnt(0)
v_mfma_f32_16x16x32_bf16 v[16:19], v[88:91], a[0:3], 0
ds_read_b128 v[128:131], v13 offset:7168
v_mfma_f32_16x16x32_bf16 v[44:47], v[88:91], a[4:7], 0
ds_read_b128 v[132:135], v13 offset:8192
buffer_load_dwordx4 a[48:51], v10, s[8:11], s45 offen offset:2048 sc1
v_mfma_f32_16x16x32_bf16 v[20:23], v[92:95], a[0:3], 0
ds_read_b128 v[136:139], v13 offset:9216
v_mfma_f32_16x16x32_bf16 v[48:51], v[92:95], a[4:7], 0
ds_read_b128 v[140:143], v13 offset:10240
v_mfma_f32_16x16x32_bf16 v[24:27], v[96:99], a[0:3], 0
ds_read_b128 v[144:147], v13 offset:11264
v_mfma_f32_16x16x32_bf16 v[52:55], v[96:99], a[4:7], 0
ds_read_b128 v[148:151], v13 offset:12288
v_mfma_f32_16x16x32_bf16 v[28:31], v[100:103], a[0:3], 0
ds_read_b128 v[152:155], v13 offset:13312
v_mfma_f32_16x16x32_bf16 v[56:59], v[100:103], a[4:7], 0
v_mfma_f32_16x16x32_bf16 v[32:35], v[104:107], a[0:3], 0
buffer_load_dwordx4 a[52:55], v11, s[8:11], s45 offen offset:2048 sc1
v_mfma_f32_16x16x32_bf16 v[60:63], v[104:107], a[4:7], 0
v_mfma_f32_16x16x32_bf16 v[36:39], v[108:111], a[0:3], 0
v_mfma_f32_16x16x32_bf16 v[64:67], v[108:111], a[4:7], 0
v_mfma_f32_16x16x32_bf16 v[40:43], v[112:115], a[0:3], 0
v_mfma_f32_16x16x32_bf16 v[68:71], v[112:115], a[4:7], 0
s_waitcnt vmcnt(10) lgkmcnt(0)
v_mfma_f32_16x16x32_bf16 v[16:19], v[128:131], a[8:11], v[16:19]
ds_read_b128 v[88:91], v13 offset:14336
v_mfma_f32_16x16x32_bf16 v[44:47], v[128:131], a[12:15], v[44:47]
ds_read_b128 v[92:95], v13 offset:15360
buffer_load_dwordx4 a[56:59], v10, s[8:11], s45 offen offset:3072 sc1
v_mfma_f32_16x16x32_bf16 v[20:23], v[132:135], a[8:11], v[20:23]
ds_read_b128 v[96:99], v13 offset:16384
v_mfma_f32_16x16x32_bf16 v[48:51], v[132:135], a[12:15], v[48:51]
ds_read_b128 v[100:103], v13 offset:17408
v_mfma_f32_16x16x32_bf16 v[24:27], v[136:139], a[8:11], v[24:27]
ds_read_b128 v[104:107], v13 offset:18432
v_mfma_f32_16x16x32_bf16 v[52:55], v[136:139], a[12:15], v[52:55]
ds_read_b128 v[108:111], v13 offset:19456
buffer_load_dwordx4 a[60:63], v11, s[8:11], s45 offen offset:3072 sc1
v_mfma_f32_16x16x32_bf16 v[28:31], v[140:143], a[8:11], v[28:31]
ds_read_b128 v[112:115], v13 offset:20480
v_mfma_f32_16x16x32_bf16 v[56:59], v[140:143], a[12:15], v[56:59]
v_mfma_f32_16x16x32_bf16 v[32:35], v[144:147], a[8:11], v[32:35]
v_mfma_f32_16x16x32_bf16 v[60:63], v[144:147], a[12:15], v[60:63]
v_mfma_f32_16x16x32_bf16 v[36:39], v[148:151], a[8:11], v[36:39]
buffer_load_dwordx2 v[168:169], v5, s[8:11], s46 offen sc1
v_mfma_f32_16x16x32_bf16 v[64:67], v[148:151], a[12:15], v[64:67]
v_mfma_f32_16x16x32_bf16 v[40:43], v[152:155], a[8:11], v[40:43]
v_mfma_f32_16x16x32_bf16 v[68:71], v[152:155], a[12:15], v[68:71]
s_waitcnt vmcnt(11) lgkmcnt(0)
v_mfma_f32_16x16x32_bf16 v[16:19], v[88:91], a[16:19], v[16:19]
ds_read_b128 v[128:131], v13 offset:21504
v_mfma_f32_16x16x32_bf16 v[44:47], v[88:91], a[20:23], v[44:47]
ds_read_b128 v[132:135], v13 offset:22528
s_add_u32 s45, s45, 4096
buffer_load_dwordx4 a[64:67], v10, s[8:11], s45 offen offset:0 sc1
v_mfma_f32_16x16x32_bf16 v[20:23], v[92:95], a[16:19], v[20:23]
ds_read_b128 v[136:139], v13 offset:23552
v_mfma_f32_16x16x32_bf16 v[48:51], v[92:95], a[20:23], v[48:51]
ds_read_b128 v[140:143], v13 offset:24576
v_mfma_f32_16x16x32_bf16 v[24:27], v[96:99], a[16:19], v[24:27]
ds_read_b128 v[144:147], v13 offset:25600
v_mfma_f32_16x16x32_bf16 v[52:55], v[96:99], a[20:23], v[52:55]
ds_read_b128 v[148:151], v13 offset:26624
buffer_load_dwordx4 a[68:71], v11, s[8:11], s45 offen offset:0 sc1
v_mfma_f32_16x16x32_bf16 v[28:31], v[100:103], a[16:19], v[28:31]
ds_read_b128 v[152:155], v13 offset:27648
v_mfma_f32_16x16x32_bf16 v[56:59], v[100:103], a[20:23], v[56:59]
v_mfma_f32_16x16x32_bf16 v[32:35], v[104:107], a[16:19], v[32:35]
v_mfma_f32_16x16x32_bf16 v[60:63], v[104:107], a[20:23], v[60:63]
v_mfma_f32_16x16x32_bf16 v[36:39], v[108:111], a[16:19], v[36:39]
buffer_load_dwordx2 v[170:171], v5, s[8:11], s46 offen offset:128 sc1
v_mfma_f32_16x16x32_bf16 v[64:67], v[108:111], a[20:23], v[64:67]
v_mfma_f32_16x16x32_bf16 v[40:43], v[112:115], a[16:19], v[40:43]
v_mfma_f32_16x16x32_bf16 v[68:71], v[112:115], a[20:23], v[68:71]
s_waitcnt vmcnt(12) lgkmcnt(0)
v_mfma_f32_16x16x32_bf16 v[16:19], v[128:131], a[24:27], v[16:19]
ds_read_b128 v[88:91], v13 offset:28672
v_mfma_f32_16x16x32_bf16 v[44:47], v[128:131], a[28:31], v[44:47]
ds_read_b128 v[92:95], v13 offset:29696
buffer_load_dwordx4 a[72:75], v10, s[8:11], s45 offen offset:1024 sc1
v_mfma_f32_16x16x32_bf16 v[20:23], v[132:135], a[24:27], v[20:23]
ds_read_b128 v[96:99], v13 offset:30720
v_mfma_f32_16x16x32_bf16 v[48:51], v[132:135], a[28:31], v[48:51]
ds_read_b128 v[100:103], v13 offset:31744
v_mfma_f32_16x16x32_bf16 v[24:27], v[136:139], a[24:27], v[24:27]
ds_read_b128 v[104:107], v13 offset:32768
v_mfma_f32_16x16x32_bf16 v[52:55], v[136:139], a[28:31], v[52:55]
ds_read_b128 v[108:111], v13 offset:33792
buffer_load_dwordx4 a[76:79], v11, s[8:11], s45 offen offset:1024 sc1
v_mfma_f32_16x16x32_bf16 v[28:31], v[140:143], a[24:27], v[28:31]
ds_read_b128 v[112:115], v13 offset:34816
v_mfma_f32_16x16x32_bf16 v[56:59], v[140:143], a[28:31], v[56:59]
v_mfma_f32_16x16x32_bf16 v[32:35], v[144:147], a[24:27], v[32:35]
v_mfma_f32_16x16x32_bf16 v[60:63], v[144:147], a[28:31], v[60:63]
v_mfma_f32_16x16x32_bf16 v[36:39], v[148:151], a[24:27], v[36:39]
buffer_load_dwordx2 v[172:173], v5, s[8:11], s47 offen sc1
v_mfma_f32_16x16x32_bf16 v[64:67], v[148:151], a[28:31], v[64:67]
v_mfma_f32_16x16x32_bf16 v[40:43], v[152:155], a[24:27], v[40:43]
v_mfma_f32_16x16x32_bf16 v[68:71], v[152:155], a[28:31], v[68:71]
s_waitcnt vmcnt(13) lgkmcnt(0)
v_mfma_f32_16x16x32_bf16 v[16:19], v[88:91], a[32:35], v[16:19]
ds_read_b128 v[128:131], v13 offset:35840
v_mfma_f32_16x16x32_bf16 v[44:47], v[88:91], a[36:39], v[44:47]
ds_read_b128 v[132:135], v13 offset:36864
buffer_load_dwordx4 a[80:83], v10, s[8:11], s45 offen offset:2048 sc1
v_mfma_f32_16x16x32_bf16 v[20:23], v[92:95], a[32:35], v[20:23]
ds_read_b128 v[136:139], v13 offset:37888
v_mfma_f32_16x16x32_bf16 v[48:51], v[92:95], a[36:39], v[48:51]
ds_read_b128 v[140:143], v13 offset:38912
v_mfma_f32_16x16x32_bf16 v[24:27], v[96:99], a[32:35], v[24:27]
ds_read_b128 v[144:147], v13 offset:39936
v_mfma_f32_16x16x32_bf16 v[52:55], v[96:99], a[36:39], v[52:55]
ds_read_b128 v[148:151], v13 offset:40960
buffer_load_dwordx4 a[84:87], v11, s[8:11], s45 offen offset:2048 sc1
v_mfma_f32_16x16x32_bf16 v[28:31], v[100:103], a[32:35], v[28:31]
ds_read_b128 v[152:155], v13 offset:41984
v_mfma_f32_16x16x32_bf16 v[56:59], v[100:103], a[36:39], v[56:59]
v_mfma_f32_16x16x32_bf16 v[32:35], v[104:107], a[32:35], v[32:35]
v_mfma_f32_16x16x32_bf16 v[60:63], v[104:107], a[36:39], v[60:63]
v_mfma_f32_16x16x32_bf16 v[36:39], v[108:111], a[32:35], v[36:39]
buffer_load_dwordx2 v[174:175], v5, s[8:11], s47 offen offset:128 sc1
v_mfma_f32_16x16x32_bf16 v[64:67], v[108:111], a[36:39], v[64:67]
v_mfma_f32_16x16x32_bf16 v[40:43], v[112:115], a[32:35], v[40:43]
v_mfma_f32_16x16x32_bf16 v[68:71], v[112:115], a[36:39], v[68:71]
s_waitcnt vmcnt(14) lgkmcnt(0)
v_mfma_f32_16x16x32_bf16 v[16:19], v[128:131], a[40:43], v[16:19]
ds_read_b128 v[88:91], v13 offset:43008
v_mfma_f32_16x16x32_bf16 v[44:47], v[128:131], a[44:47], v[44:47]
ds_read_b128 v[92:95], v13 offset:44032
buffer_load_dwordx4 a[88:91], v10, s[8:11], s45 offen offset:3072 sc1
v_mfma_f32_16x16x32_bf16 v[20:23], v[132:135], a[40:43], v[20:23]
ds_read_b128 v[96:99], v13 offset:45056
v_mfma_f32_16x16x32_bf16 v[48:51], v[132:135], a[44:47], v[48:51]
ds_read_b128 v[100:103], v13 offset:46080
v_mfma_f32_16x16x32_bf16 v[24:27], v[136:139], a[40:43], v[24:27]
ds_read_b128 v[104:107], v13 offset:47104
v_mfma_f32_16x16x32_bf16 v[52:55], v[136:139], a[44:47], v[52:55]
ds_read_b128 v[108:111], v13 offset:48128
v_mfma_f32_16x16x32_bf16 v[28:31], v[140:143], a[40:43], v[28:31]
ds_read_b128 v[112:115], v13 offset:49152
v_mfma_f32_16x16x32_bf16 v[56:59], v[140:143], a[44:47], v[56:59]
v_mfma_f32_16x16x32_bf16 v[32:35], v[144:147], a[40:43], v[32:35]
buffer_load_dwordx4 a[92:95], v11, s[8:11], s45 offen offset:3072 sc1
v_mfma_f32_16x16x32_bf16 v[60:63], v[144:147], a[44:47], v[60:63]
v_mfma_f32_16x16x32_bf16 v[36:39], v[148:151], a[40:43], v[36:39]
v_mfma_f32_16x16x32_bf16 v[64:67], v[148:151], a[44:47], v[64:67]
v_mfma_f32_16x16x32_bf16 v[40:43], v[152:155], a[40:43], v[40:43]
v_mfma_f32_16x16x32_bf16 v[68:71], v[152:155], a[44:47], v[68:71]
s_waitcnt vmcnt(14) lgkmcnt(0)
v_mfma_f32_16x16x32_bf16 v[16:19], v[88:91], a[48:51], v[16:19]
ds_read_b128 v[128:131], v13 offset:50176
v_mfma_f32_16x16x32_bf16 v[44:47], v[88:91], a[52:55], v[44:47]
ds_read_b128 v[132:135], v13 offset:51200
s_add_u32 s45, s45, 4096
buffer_load_dwordx4 a[96:99], v10, s[8:11], s45 offen offset:0 sc1
v_mfma_f32_16x16x32_bf16 v[20:23], v[92:95], a[48:51], v[20:23]
ds_read_b128 v[136:139], v13 offset:52224
v_mfma_f32_16x16x32_bf16 v[48:51], v[92:95], a[52:55], v[48:51]
ds_read_b128 v[140:143], v13 offset:53248
v_mfma_f32_16x16x32_bf16 v[24:27], v[96:99], a[48:51], v[24:27]
ds_read_b128 v[144:147], v13 offset:54272
v_mfma_f32_16x16x32_bf16 v[52:55], v[96:99], a[52:55], v[52:55]
ds_read_b128 v[148:151], v13 offset:55296
v_mfma_f32_16x16x32_bf16 v[28:31], v[100:103], a[48:51], v[28:31]
ds_read_b128 v[152:155], v13 offset:56320
v_mfma_f32_16x16x32_bf16 v[56:59], v[100:103], a[52:55], v[56:59]
v_mfma_f32_16x16x32_bf16 v[32:35], v[104:107], a[48:51], v[32:35]
buffer_load_dwordx4 a[100:103], v11, s[8:11], s45 offen offset:0 sc1
v_mfma_f32_16x16x32_bf16 v[60:63], v[104:107], a[52:55], v[60:63]
v_mfma_f32_16x16x32_bf16 v[36:39], v[108:111], a[48:51], v[36:39]
v_mfma_f32_16x16x32_bf16 v[64:67], v[108:111], a[52:55], v[64:67]
v_mfma_f32_16x16x32_bf16 v[40:43], v[112:115], a[48:51], v[40:43]
v_mfma_f32_16x16x32_bf16 v[68:71], v[112:115], a[52:55], v[68:71]
s_waitcnt vmcnt(14) lgkmcnt(0)
v_mfma_f32_16x16x32_bf16 v[16:19], v[128:131], a[56:59], v[16:19]
ds_read_b128 v[88:91], v13 offset:57344
v_mfma_f32_16x16x32_bf16 v[44:47], v[128:131], a[60:63], v[44:47]
ds_read_b128 v[92:95], v13 offset:58368
buffer_load_dwordx4 a[104:107], v10, s[8:11], s45 offen offset:1024 sc1
v_mfma_f32_16x16x32_bf16 v[20:23], v[132:135], a[56:59], v[20:23]
ds_read_b128 v[96:99], v13 offset:59392
v_mfma_f32_16x16x32_bf16 v[48:51], v[132:135], a[60:63], v[48:51]
ds_read_b128 v[100:103], v13 offset:60416
v_mfma_f32_16x16x32_bf16 v[24:27], v[136:139], a[56:59], v[24:27]
ds_read_b128 v[104:107], v13 offset:61440
v_mfma_f32_16x16x32_bf16 v[52:55], v[136:139], a[60:63], v[52:55]
ds_read_b128 v[108:111], v13 offset:62464
v_mfma_f32_16x16x32_bf16 v[28:31], v[140:143], a[56:59], v[28:31]
ds_read_b128 v[112:115], v13 offset:63488
v_mfma_f32_16x16x32_bf16 v[56:59], v[140:143], a[60:63], v[56:59]
v_mfma_f32_16x16x32_bf16 v[32:35], v[144:147], a[56:59], v[32:35]
buffer_load_dwordx4 a[108:111], v11, s[8:11], s45 offen offset:1024 sc1
v_mfma_f32_16x16x32_bf16 v[60:63], v[144:147], a[60:63], v[60:63]
v_mfma_f32_16x16x32_bf16 v[36:39], v[148:151], a[56:59], v[36:39]
v_mfma_f32_16x16x32_bf16 v[64:67], v[148:151], a[60:63], v[64:67]
v_mfma_f32_16x16x32_bf16 v[40:43], v[152:155], a[56:59], v[40:43]
v_mfma_f32_16x16x32_bf16 v[68:71], v[152:155], a[60:63], v[68:71]
s_waitcnt vmcnt(13) lgkmcnt(0)
v_add_u32 v13, 64512, v13
v_mfma_f32_16x16x32_bf16 v[16:19], v[88:91], a[64:67], v[16:19]
ds_read_b128 v[128:131], v13 offset:0
v_mfma_f32_16x16x32_bf16 v[44:47], v[88:91], a[68:71], v[44:47]
ds_read_b128 v[132:135], v13 offset:1024
buffer_load_dwordx4 a[112:115], v10, s[8:11], s45 offen offset:2048 sc1
v_mfma_f32_16x16x32_bf16 v[20:23], v[92:95], a[64:67], v[20:23]
ds_read_b128 v[136:139], v13 offset:2048
v_mfma_f32_16x16x32_bf16 v[48:51], v[92:95], a[68:71], v[48:51]
ds_read_b128 v[140:143], v13 offset:3072
v_mfma_f32_16x16x32_bf16 v[24:27], v[96:99], a[64:67], v[24:27]
ds_read_b128 v[144:147], v13 offset:4096
v_mfma_f32_16x16x32_bf16 v[52:55], v[96:99], a[68:71], v[52:55]
ds_read_b128 v[148:151], v13 offset:5120
v_mfma_f32_16x16x32_bf16 v[28:31], v[100:103], a[64:67], v[28:31]
ds_read_b128 v[152:155], v13 offset:6144
v_mfma_f32_16x16x32_bf16 v[56:59], v[100:103], a[68:71], v[56:59]
v_mfma_f32_16x16x32_bf16 v[32:35], v[104:107], a[64:67], v[32:35]
buffer_load_dwordx4 a[116:119], v11, s[8:11], s45 offen offset:2048 sc1
v_mfma_f32_16x16x32_bf16 v[60:63], v[104:107], a[68:71], v[60:63]
v_mfma_f32_16x16x32_bf16 v[36:39], v[108:111], a[64:67], v[36:39]
v_mfma_f32_16x16x32_bf16 v[64:67], v[108:111], a[68:71], v[64:67]
v_mfma_f32_16x16x32_bf16 v[40:43], v[112:115], a[64:67], v[40:43]
v_mfma_f32_16x16x32_bf16 v[68:71], v[112:115], a[68:71], v[68:71]
s_waitcnt vmcnt(12) lgkmcnt(0)
v_mfma_f32_16x16x32_bf16 v[16:19], v[128:131], a[72:75], v[16:19]
ds_read_b128 v[88:91], v13 offset:7168
v_mfma_f32_16x16x32_bf16 v[44:47], v[128:131], a[76:79], v[44:47]
ds_read_b128 v[92:95], v13 offset:8192
buffer_load_dwordx4 a[120:123], v10, s[8:11], s45 offen offset:3072 sc1
v_mfma_f32_16x16x32_bf16 v[20:23], v[132:135], a[72:75], v[20:23]
ds_read_b128 v[96:99], v13 offset:9216
v_mfma_f32_16x16x32_bf16 v[48:51], v[132:135], a[76:79], v[48:51]
ds_read_b128 v[100:103], v13 offset:10240
v_mfma_f32_16x16x32_bf16 v[24:27], v[136:139], a[72:75], v[24:27]
ds_read_b128 v[104:107], v13 offset:11264
v_mfma_f32_16x16x32_bf16 v[52:55], v[136:139], a[76:79], v[52:55]
ds_read_b128 v[108:111], v13 offset:12288
v_mfma_f32_16x16x32_bf16 v[28:31], v[140:143], a[72:75], v[28:31]
ds_read_b128 v[112:115], v13 offset:13312
v_mfma_f32_16x16x32_bf16 v[56:59], v[140:143], a[76:79], v[56:59]
v_mfma_f32_16x16x32_bf16 v[32:35], v[144:147], a[72:75], v[32:35]
buffer_load_dwordx4 a[124:127], v11, s[8:11], s45 offen offset:3072 sc1
v_mfma_f32_16x16x32_bf16 v[60:63], v[144:147], a[76:79], v[60:63]
v_mfma_f32_16x16x32_bf16 v[36:39], v[148:151], a[72:75], v[36:39]
v_mfma_f32_16x16x32_bf16 v[64:67], v[148:151], a[76:79], v[64:67]
v_mfma_f32_16x16x32_bf16 v[40:43], v[152:155], a[72:75], v[40:43]
v_mfma_f32_16x16x32_bf16 v[68:71], v[152:155], a[76:79], v[68:71]
s_waitcnt vmcnt(11) lgkmcnt(0)
v_mfma_f32_16x16x32_bf16 v[16:19], v[88:91], a[80:83], v[16:19]
ds_read_b128 v[128:131], v13 offset:14336
v_mfma_f32_16x16x32_bf16 v[44:47], v[88:91], a[84:87], v[44:47]
ds_read_b128 v[132:135], v13 offset:15360
s_add_u32 s45, s45, 4096
buffer_load_dwordx4 a[128:131], v10, s[8:11], s45 offen offset:0 sc1
v_mfma_f32_16x16x32_bf16 v[20:23], v[92:95], a[80:83], v[20:23]
ds_read_b128 v[136:139], v13 offset:16384
v_mfma_f32_16x16x32_bf16 v[48:51], v[92:95], a[84:87], v[48:51]
ds_read_b128 v[140:143], v13 offset:17408
v_mfma_f32_16x16x32_bf16 v[24:27], v[96:99], a[80:83], v[24:27]
ds_read_b128 v[144:147], v13 offset:18432
v_mfma_f32_16x16x32_bf16 v[52:55], v[96:99], a[84:87], v[52:55]
ds_read_b128 v[148:151], v13 offset:19456
v_mfma_f32_16x16x32_bf16 v[28:31], v[100:103], a[80:83], v[28:31]
ds_read_b128 v[152:155], v13 offset:20480
v_mfma_f32_16x16x32_bf16 v[56:59], v[100:103], a[84:87], v[56:59]
v_mfma_f32_16x16x32_bf16 v[32:35], v[104:107], a[80:83], v[32:35]
buffer_load_dwordx4 a[132:135], v11, s[8:11], s45 offen offset:0 sc1
v_mfma_f32_16x16x32_bf16 v[60:63], v[104:107], a[84:87], v[60:63]
v_mfma_f32_16x16x32_bf16 v[36:39], v[108:111], a[80:83], v[36:39]
v_mfma_f32_16x16x32_bf16 v[64:67], v[108:111], a[84:87], v[64:67]
v_mfma_f32_16x16x32_bf16 v[40:43], v[112:115], a[80:83], v[40:43]
v_mfma_f32_16x16x32_bf16 v[68:71], v[112:115], a[84:87], v[68:71]
s_waitcnt vmcnt(10) lgkmcnt(0)
v_mfma_f32_16x16x32_bf16 v[16:19], v[128:131], a[88:91], v[16:19]
ds_read_b128 v[88:91], v13 offset:21504
v_mfma_f32_16x16x32_bf16 v[44:47], v[128:131], a[92:95], v[44:47]
ds_read_b128 v[92:95], v13 offset:22528
buffer_load_dwordx4 a[136:139], v10, s[8:11], s45 offen offset:1024 sc1
v_mfma_f32_16x16x32_bf16 v[20:23], v[132:135], a[88:91], v[20:23]
ds_read_b128 v[96:99], v13 offset:23552
v_mfma_f32_16x16x32_bf16 v[48:51], v[132:135], a[92:95], v[48:51]
ds_read_b128 v[100:103], v13 offset:24576
v_mfma_f32_16x16x32_bf16 v[24:27], v[136:139], a[88:91], v[24:27]
ds_read_b128 v[104:107], v13 offset:25600
v_mfma_f32_16x16x32_bf16 v[52:55], v[136:139], a[92:95], v[52:55]
ds_read_b128 v[108:111], v13 offset:26624
v_mfma_f32_16x16x32_bf16 v[28:31], v[140:143], a[88:91], v[28:31]
ds_read_b128 v[112:115], v13 offset:27648
v_mfma_f32_16x16x32_bf16 v[56:59], v[140:143], a[92:95], v[56:59]
v_add_f32 v168, v168, v170
v_add_f32 v169, v169, v171
v_mfma_f32_16x16x32_bf16 v[32:35], v[144:147], a[88:91], v[32:35]
buffer_load_dwordx4 a[140:143], v11, s[8:11], s45 offen offset:1024 sc1
v_mov_b32 v9, v168
s_nop 1
v_mfma_f32_16x16x32_bf16 v[60:63], v[144:147], a[92:95], v[60:63]
v_permlane32_swap_b32 v168, v9
s_nop 1
v_mfma_f32_16x16x32_bf16 v[36:39], v[148:151], a[88:91], v[36:39]
v_add_f32 v168, v168, v9
v_mov_b32 v9, v168
v_mfma_f32_16x16x32_bf16 v[64:67], v[148:151], a[92:95], v[64:67]
s_nop 1
v_permlane16_swap_b32 v168, v9
v_mfma_f32_16x16x32_bf16 v[40:43], v[152:155], a[88:91], v[40:43]
s_nop 1
v_add_f32 v168, v168, v9
v_mfma_f32_16x16x32_bf16 v[68:71], v[152:155], a[92:95], v[68:71]
v_mov_b32 v9, v169
s_nop 1
s_waitcnt vmcnt(10) lgkmcnt(0)
v_mfma_f32_16x16x32_bf16 v[16:19], v[88:91], a[96:99], v[16:19]
ds_read_b128 v[128:131], v13 offset:28672
v_mfma_f32_16x16x32_bf16 v[44:47], v[88:91], a[100:103], v[44:47]
ds_read_b128 v[132:135], v13 offset:29696
buffer_load_dwordx4 a[144:147], v10, s[8:11], s45 offen offset:2048 sc1
v_mfma_f32_16x16x32_bf16 v[20:23], v[92:95], a[96:99], v[20:23]
ds_read_b128 v[136:139], v13 offset:30720
v_mfma_f32_16x16x32_bf16 v[48:51], v[92:95], a[100:103], v[48:51]
ds_read_b128 v[140:143], v13 offset:31744
v_mfma_f32_16x16x32_bf16 v[24:27], v[96:99], a[96:99], v[24:27]
ds_read_b128 v[144:147], v13 offset:32768
v_mfma_f32_16x16x32_bf16 v[52:55], v[96:99], a[100:103], v[52:55]
ds_read_b128 v[148:151], v13 offset:33792
v_mfma_f32_16x16x32_bf16 v[28:31], v[100:103], a[96:99], v[28:31]
ds_read_b128 v[152:155], v13 offset:34816
v_mfma_f32_16x16x32_bf16 v[56:59], v[100:103], a[100:103], v[56:59]
v_permlane32_swap_b32 v169, v9
s_nop 1
v_mfma_f32_16x16x32_bf16 v[32:35], v[104:107], a[96:99], v[32:35]
buffer_load_dwordx4 a[148:151], v11, s[8:11], s45 offen offset:2048 sc1
v_add_f32 v169, v169, v9
v_mov_b32 v9, v169
v_mfma_f32_16x16x32_bf16 v[60:63], v[104:107], a[100:103], v[60:63]
s_nop 1
v_permlane16_swap_b32 v169, v9
v_mfma_f32_16x16x32_bf16 v[36:39], v[108:111], a[96:99], v[36:39]
s_nop 1
v_add_f32 v169, v169, v9
v_mfma_f32_16x16x32_bf16 v[64:67], v[108:111], a[100:103], v[64:67]
v_mul_f32 v168, 0x3acccccd, v168
v_mul_f32 v169, 0x3acccccd, v169
v_mfma_f32_16x16x32_bf16 v[40:43], v[112:115], a[96:99], v[40:43]
v_fma_f32 v169, -v168, v168, v169
v_max_f32 v169, 0, v169
v_mfma_f32_16x16x32_bf16 v[68:71], v[112:115], a[100:103], v[68:71]
v_add_f32 v169, 0x3727c5ac, v169
v_rsq_f32 v180, v169
s_waitcnt vmcnt(10) lgkmcnt(0)
v_mfma_f32_16x16x32_bf16 v[16:19], v[128:131], a[104:107], v[16:19]
ds_read_b128 v[88:91], v13 offset:35840
v_mfma_f32_16x16x32_bf16 v[44:47], v[128:131], a[108:111], v[44:47]
ds_read_b128 v[92:95], v13 offset:36864
buffer_load_dwordx4 a[152:155], v10, s[8:11], s45 offen offset:3072 sc1
v_mfma_f32_16x16x32_bf16 v[20:23], v[132:135], a[104:107], v[20:23]
ds_read_b128 v[96:99], v13 offset:37888
v_mfma_f32_16x16x32_bf16 v[48:51], v[132:135], a[108:111], v[48:51]
ds_read_b128 v[100:103], v13 offset:38912
v_mfma_f32_16x16x32_bf16 v[24:27], v[136:139], a[104:107], v[24:27]
ds_read_b128 v[104:107], v13 offset:39936
v_mfma_f32_16x16x32_bf16 v[52:55], v[136:139], a[108:111], v[52:55]
ds_read_b128 v[108:111], v13 offset:40960
v_mfma_f32_16x16x32_bf16 v[28:31], v[140:143], a[104:107], v[28:31]
ds_read_b128 v[112:115], v13 offset:41984
v_mfma_f32_16x16x32_bf16 v[56:59], v[140:143], a[108:111], v[56:59]
s_nop 1
v_mul_f32 v186, v168, v180
v_mfma_f32_16x16x32_bf16 v[32:35], v[144:147], a[104:107], v[32:35]
buffer_load_dwordx4 a[156:159], v11, s[8:11], s45 offen offset:3072 sc1
v_sub_f32 v186, 0, v186
v_add_f32 v172, v172, v174
v_mfma_f32_16x16x32_bf16 v[60:63], v[144:147], a[108:111], v[60:63]
v_add_f32 v173, v173, v175
v_mov_b32 v9, v172
v_mfma_f32_16x16x32_bf16 v[36:39], v[148:151], a[104:107], v[36:39]
s_nop 1
v_permlane32_swap_b32 v172, v9
v_mfma_f32_16x16x32_bf16 v[64:67], v[148:151], a[108:111], v[64:67]
s_nop 1
v_add_f32 v172, v172, v9
v_mfma_f32_16x16x32_bf16 v[40:43], v[152:155], a[104:107], v[40:43]
v_mov_b32 v9, v172
s_nop 1
v_mfma_f32_16x16x32_bf16 v[68:71], v[152:155], a[108:111], v[68:71]
v_permlane16_swap_b32 v172, v9
s_nop 1
s_waitcnt vmcnt(10) lgkmcnt(0)
v_mfma_f32_16x16x32_bf16 v[16:19], v[88:91], a[112:115], v[16:19]
ds_read_b128 v[128:131], v13 offset:43008
v_mfma_f32_16x16x32_bf16 v[44:47], v[88:91], a[116:119], v[44:47]
ds_read_b128 v[132:135], v13 offset:44032
v_mfma_f32_16x16x32_bf16 v[20:23], v[92:95], a[112:115], v[20:23]
ds_read_b128 v[136:139], v13 offset:45056
v_mfma_f32_16x16x32_bf16 v[48:51], v[92:95], a[116:119], v[48:51]
ds_read_b128 v[140:143], v13 offset:46080
v_mfma_f32_16x16x32_bf16 v[24:27], v[96:99], a[112:115], v[24:27]
ds_read_b128 v[144:147], v13 offset:47104
v_mfma_f32_16x16x32_bf16 v[52:55], v[96:99], a[116:119], v[52:55]
ds_read_b128 v[148:151], v13 offset:48128
v_mfma_f32_16x16x32_bf16 v[28:31], v[100:103], a[112:115], v[28:31]
ds_read_b128 v[152:155], v13 offset:49152
v_mfma_f32_16x16x32_bf16 v[56:59], v[100:103], a[116:119], v[56:59]
v_add_f32 v172, v172, v9
v_mov_b32 v9, v173
v_mfma_f32_16x16x32_bf16 v[32:35], v[104:107], a[112:115], v[32:35]
s_nop 1
v_permlane32_swap_b32 v173, v9
v_mfma_f32_16x16x32_bf16 v[60:63], v[104:107], a[116:119], v[60:63]
s_nop 1
v_add_f32 v173, v173, v9
v_mfma_f32_16x16x32_bf16 v[36:39], v[108:111], a[112:115], v[36:39]
v_mov_b32 v9, v173
s_nop 1
v_mfma_f32_16x16x32_bf16 v[64:67], v[108:111], a[116:119], v[64:67]
v_permlane16_swap_b32 v173, v9
s_nop 1
v_mfma_f32_16x16x32_bf16 v[40:43], v[112:115], a[112:115], v[40:43]
v_add_f32 v173, v173, v9
v_mul_f32 v172, 0x3acccccd, v172
v_mfma_f32_16x16x32_bf16 v[68:71], v[112:115], a[116:119], v[68:71]
v_mul_f32 v173, 0x3acccccd, v173
v_fma_f32 v173, -v172, v172, v173
s_waitcnt vmcnt(8) lgkmcnt(0)
v_mfma_f32_16x16x32_bf16 v[16:19], v[128:131], a[120:123], v[16:19]
ds_read_b128 v[88:91], v13 offset:50176
v_mfma_f32_16x16x32_bf16 v[44:47], v[128:131], a[124:127], v[44:47]
ds_read_b128 v[92:95], v13 offset:51200
v_mfma_f32_16x16x32_bf16 v[20:23], v[132:135], a[120:123], v[20:23]
ds_read_b128 v[96:99], v13 offset:52224
v_mfma_f32_16x16x32_bf16 v[48:51], v[132:135], a[124:127], v[48:51]
ds_read_b128 v[100:103], v13 offset:53248
v_mfma_f32_16x16x32_bf16 v[24:27], v[136:139], a[120:123], v[24:27]
ds_read_b128 v[104:107], v13 offset:54272
v_mfma_f32_16x16x32_bf16 v[52:55], v[136:139], a[124:127], v[52:55]
ds_read_b128 v[108:111], v13 offset:55296
v_mfma_f32_16x16x32_bf16 v[28:31], v[140:143], a[120:123], v[28:31]
ds_read_b128 v[112:115], v13 offset:56320
v_mfma_f32_16x16x32_bf16 v[56:59], v[140:143], a[124:127], v[56:59]
v_max_f32 v173, 0, v173
v_add_f32 v173, 0x3727c5ac, v173
v_mfma_f32_16x16x32_bf16 v[32:35], v[144:147], a[120:123], v[32:35]
v_rsq_f32 v182, v173
s_nop 1
v_mfma_f32_16x16x32_bf16 v[60:63], v[144:147], a[124:127], v[60:63]
v_mul_f32 v188, v172, v182
v_sub_f32 v188, 0, v188
v_mfma_f32_16x16x32_bf16 v[36:39], v[148:151], a[120:123], v[36:39]
v_mfma_f32_16x16x32_bf16 v[64:67], v[148:151], a[124:127], v[64:67]
v_mfma_f32_16x16x32_bf16 v[40:43], v[152:155], a[120:123], v[40:43]
v_mfma_f32_16x16x32_bf16 v[68:71], v[152:155], a[124:127], v[68:71]
s_waitcnt vmcnt(6) lgkmcnt(0)
v_mfma_f32_16x16x32_bf16 v[16:19], v[88:91], a[128:131], v[16:19]
ds_read_b128 v[128:131], v13 offset:57344
v_mfma_f32_16x16x32_bf16 v[44:47], v[88:91], a[132:135], v[44:47]
ds_read_b128 v[132:135], v13 offset:58368
v_mfma_f32_16x16x32_bf16 v[20:23], v[92:95], a[128:131], v[20:23]
ds_read_b128 v[136:139], v13 offset:59392
v_mfma_f32_16x16x32_bf16 v[48:51], v[92:95], a[132:135], v[48:51]
ds_read_b128 v[140:143], v13 offset:60416
v_mfma_f32_16x16x32_bf16 v[24:27], v[96:99], a[128:131], v[24:27]
ds_read_b128 v[144:147], v13 offset:61440
v_mfma_f32_16x16x32_bf16 v[52:55], v[96:99], a[132:135], v[52:55]
ds_read_b128 v[148:151], v13 offset:62464
v_mfma_f32_16x16x32_bf16 v[28:31], v[100:103], a[128:131], v[28:31]
ds_read_b128 v[152:155], v13 offset:63488
v_mfma_f32_16x16x32_bf16 v[56:59], v[100:103], a[132:135], v[56:59]
v_mfma_f32_16x16x32_bf16 v[32:35], v[104:107], a[128:131], v[32:35]
v_mfma_f32_16x16x32_bf16 v[60:63], v[104:107], a[132:135], v[60:63]
v_mfma_f32_16x16x32_bf16 v[36:39], v[108:111], a[128:131], v[36:39]
v_mfma_f32_16x16x32_bf16 v[64:67], v[108:111], a[132:135], v[64:67]
v_mfma_f32_16x16x32_bf16 v[40:43], v[112:115], a[128:131], v[40:43]
v_mfma_f32_16x16x32_bf16 v[68:71], v[112:115], a[132:135], v[68:71]
s_waitcnt vmcnt(4) lgkmcnt(0)
v_add_u32 v13, 64512, v13
v_mfma_f32_16x16x32_bf16 v[16:19], v[128:131], a[136:139], v[16:19]
ds_read_b128 v[88:91], v13 offset:0
v_mfma_f32_16x16x32_bf16 v[44:47], v[128:131], a[140:143], v[44:47]
ds_read_b128 v[92:95], v13 offset:1024
v_mfma_f32_16x16x32_bf16 v[20:23], v[132:135], a[136:139], v[20:23]
ds_read_b128 v[96:99], v13 offset:2048
v_mfma_f32_16x16x32_bf16 v[48:51], v[132:135], a[140:143], v[48:51]
ds_read_b128 v[100:103], v13 offset:3072
v_mfma_f32_16x16x32_bf16 v[24:27], v[136:139], a[136:139], v[24:27]
ds_read_b128 v[104:107], v13 offset:4096
v_mfma_f32_16x16x32_bf16 v[52:55], v[136:139], a[140:143], v[52:55]
ds_read_b128 v[108:111], v13 offset:5120
v_mfma_f32_16x16x32_bf16 v[28:31], v[140:143], a[136:139], v[28:31]
ds_read_b128 v[112:115], v13 offset:6144
v_mfma_f32_16x16x32_bf16 v[56:59], v[140:143], a[140:143], v[56:59]
v_mfma_f32_16x16x32_bf16 v[32:35], v[144:147], a[136:139], v[32:35]
v_mfma_f32_16x16x32_bf16 v[60:63], v[144:147], a[140:143], v[60:63]
v_mfma_f32_16x16x32_bf16 v[36:39], v[148:151], a[136:139], v[36:39]
v_mfma_f32_16x16x32_bf16 v[64:67], v[148:151], a[140:143], v[64:67]
v_mfma_f32_16x16x32_bf16 v[40:43], v[152:155], a[136:139], v[40:43]
v_mfma_f32_16x16x32_bf16 v[68:71], v[152:155], a[140:143], v[68:71]
s_waitcnt vmcnt(2) lgkmcnt(0)
v_mfma_f32_16x16x32_bf16 v[16:19], v[88:91], a[144:147], v[16:19]
ds_read_b128 v[128:131], v13 offset:7168
v_mfma_f32_16x16x32_bf16 v[44:47], v[88:91], a[148:151], v[44:47]
ds_read_b128 v[132:135], v13 offset:8192
v_mfma_f32_16x16x32_bf16 v[20:23], v[92:95], a[144:147], v[20:23]
ds_read_b128 v[136:139], v13 offset:9216
v_mfma_f32_16x16x32_bf16 v[48:51], v[92:95], a[148:151], v[48:51]
ds_read_b128 v[140:143], v13 offset:10240
v_mfma_f32_16x16x32_bf16 v[24:27], v[96:99], a[144:147], v[24:27]
ds_read_b128 v[144:147], v13 offset:11264
v_mfma_f32_16x16x32_bf16 v[52:55], v[96:99], a[148:151], v[52:55]
ds_read_b128 v[148:151], v13 offset:12288
v_mfma_f32_16x16x32_bf16 v[28:31], v[100:103], a[144:147], v[28:31]
ds_read_b128 v[152:155], v13 offset:13312
v_mfma_f32_16x16x32_bf16 v[56:59], v[100:103], a[148:151], v[56:59]
v_mfma_f32_16x16x32_bf16 v[32:35], v[104:107], a[144:147], v[32:35]
v_mfma_f32_16x16x32_bf16 v[60:63], v[104:107], a[148:151], v[60:63]
v_mfma_f32_16x16x32_bf16 v[36:39], v[108:111], a[144:147], v[36:39]
v_mfma_f32_16x16x32_bf16 v[64:67], v[108:111], a[148:151], v[64:67]
v_mfma_f32_16x16x32_bf16 v[40:43], v[112:115], a[144:147], v[40:43]
v_mfma_f32_16x16x32_bf16 v[68:71], v[112:115], a[148:151], v[68:71]
s_waitcnt vmcnt(0) lgkmcnt(0)
v_mfma_f32_16x16x32_bf16 v[16:19], v[128:131], a[152:155], v[16:19]
v_mfma_f32_16x16x32_bf16 v[44:47], v[128:131], a[156:159], v[44:47]
v_mfma_f32_16x16x32_bf16 v[20:23], v[132:135], a[152:155], v[20:23]
v_mfma_f32_16x16x32_bf16 v[48:51], v[132:135], a[156:159], v[48:51]
v_mfma_f32_16x16x32_bf16 v[24:27], v[136:139], a[152:155], v[24:27]
v_mfma_f32_16x16x32_bf16 v[52:55], v[136:139], a[156:159], v[52:55]
v_mfma_f32_16x16x32_bf16 v[28:31], v[140:143], a[152:155], v[28:31]
v_mfma_f32_16x16x32_bf16 v[56:59], v[140:143], a[156:159], v[56:59]
v_mfma_f32_16x16x32_bf16 v[32:35], v[144:147], a[152:155], v[32:35]
v_mfma_f32_16x16x32_bf16 v[60:63], v[144:147], a[156:159], v[60:63]
v_mfma_f32_16x16x32_bf16 v[36:39], v[148:151], a[152:155], v[36:39]
v_mfma_f32_16x16x32_bf16 v[64:67], v[148:151], a[156:159], v[64:67]
v_mfma_f32_16x16x32_bf16 v[40:43], v[152:155], a[152:155], v[40:43]
v_mfma_f32_16x16x32_bf16 v[68:71], v[152:155], a[156:159], v[68:71]
s_waitcnt vmcnt(0)
s_nop 7
v_pk_mul_f32 v[16:17], v[16:17], v[180:181] op_sel_hi:[1,0]
v_pk_mul_f32 v[18:19], v[18:19], v[180:181] op_sel_hi:[1,0]
v_pk_fma_f32 v[16:17], v[192:193], v[186:187], v[16:17] op_sel_hi:[1,0,1]
v_pk_fma_f32 v[18:19], v[194:195], v[186:187], v[18:19] op_sel_hi:[1,0,1]
v_pk_mul_f32 v[20:21], v[20:21], v[180:181] op_sel_hi:[1,0]
v_pk_mul_f32 v[22:23], v[22:23], v[180:181] op_sel_hi:[1,0]
v_pk_fma_f32 v[20:21], v[196:197], v[186:187], v[20:21] op_sel_hi:[1,0,1]
v_pk_fma_f32 v[22:23], v[198:199], v[186:187], v[22:23] op_sel_hi:[1,0,1]
v_pk_mul_f32 v[24:25], v[24:25], v[180:181] op_sel_hi:[1,0]
v_pk_mul_f32 v[26:27], v[26:27], v[180:181] op_sel_hi:[1,0]
v_pk_fma_f32 v[24:25], v[200:201], v[186:187], v[24:25] op_sel_hi:[1,0,1]
v_pk_fma_f32 v[26:27], v[202:203], v[186:187], v[26:27] op_sel_hi:[1,0,1]
v_pk_mul_f32 v[28:29], v[28:29], v[180:181] op_sel_hi:[1,0]
v_pk_mul_f32 v[30:31], v[30:31], v[180:181] op_sel_hi:[1,0]
v_pk_fma_f32 v[28:29], v[204:205], v[186:187], v[28:29] op_sel_hi:[1,0,1]
v_pk_fma_f32 v[30:31], v[206:207], v[186:187], v[30:31] op_sel_hi:[1,0,1]
v_pk_mul_f32 v[32:33], v[32:33], v[180:181] op_sel_hi:[1,0]
v_pk_mul_f32 v[34:35], v[34:35], v[180:181] op_sel_hi:[1,0]
v_pk_fma_f32 v[32:33], v[208:209], v[186:187], v[32:33] op_sel_hi:[1,0,1]
v_pk_fma_f32 v[34:35], v[210:211], v[186:187], v[34:35] op_sel_hi:[1,0,1]
v_pk_mul_f32 v[36:37], v[36:37], v[180:181] op_sel_hi:[1,0]
v_pk_mul_f32 v[38:39], v[38:39], v[180:181] op_sel_hi:[1,0]
v_pk_fma_f32 v[36:37], v[212:213], v[186:187], v[36:37] op_sel_hi:[1,0,1]
v_pk_fma_f32 v[38:39], v[214:215], v[186:187], v[38:39] op_sel_hi:[1,0,1]
v_pk_mul_f32 v[40:41], v[40:41], v[180:181] op_sel_hi:[1,0]
v_pk_mul_f32 v[42:43], v[42:43], v[180:181] op_sel_hi:[1,0]
v_pk_fma_f32 v[40:41], v[216:217], v[186:187], v[40:41] op_sel_hi:[1,0,1]
v_pk_fma_f32 v[42:43], v[218:219], v[186:187], v[42:43] op_sel_hi:[1,0,1]
v_pk_mul_f32 v[44:45], v[44:45], v[182:183] op_sel_hi:[1,0]
v_pk_mul_f32 v[46:47], v[46:47], v[182:183] op_sel_hi:[1,0]
v_pk_fma_f32 v[44:45], v[192:193], v[188:189], v[44:45] op_sel_hi:[1,0,1]
v_pk_fma_f32 v[46:47], v[194:195], v[188:189], v[46:47] op_sel_hi:[1,0,1]
v_pk_mul_f32 v[48:49], v[48:49], v[182:183] op_sel_hi:[1,0]
v_pk_mul_f32 v[50:51], v[50:51], v[182:183] op_sel_hi:[1,0]
v_pk_fma_f32 v[48:49], v[196:197], v[188:189], v[48:49] op_sel_hi:[1,0,1]
v_pk_fma_f32 v[50:51], v[198:199], v[188:189], v[50:51] op_sel_hi:[1,0,1]
v_pk_mul_f32 v[52:53], v[52:53], v[182:183] op_sel_hi:[1,0]
v_pk_mul_f32 v[54:55], v[54:55], v[182:183] op_sel_hi:[1,0]
v_pk_fma_f32 v[52:53], v[200:201], v[188:189], v[52:53] op_sel_hi:[1,0,1]
v_pk_fma_f32 v[54:55], v[202:203], v[188:189], v[54:55] op_sel_hi:[1,0,1]
v_pk_mul_f32 v[56:57], v[56:57], v[182:183] op_sel_hi:[1,0]
v_pk_mul_f32 v[58:59], v[58:59], v[182:183] op_sel_hi:[1,0]
v_pk_fma_f32 v[56:57], v[204:205], v[188:189], v[56:57] op_sel_hi:[1,0,1]
v_pk_fma_f32 v[58:59], v[206:207], v[188:189], v[58:59] op_sel_hi:[1,0,1]
v_pk_mul_f32 v[60:61], v[60:61], v[182:183] op_sel_hi:[1,0]
v_pk_mul_f32 v[62:63], v[62:63], v[182:183] op_sel_hi:[1,0]
v_pk_fma_f32 v[60:61], v[208:209], v[188:189], v[60:61] op_sel_hi:[1,0,1]
v_pk_fma_f32 v[62:63], v[210:211], v[188:189], v[62:63] op_sel_hi:[1,0,1]
v_pk_mul_f32 v[64:65], v[64:65], v[182:183] op_sel_hi:[1,0]
v_pk_mul_f32 v[66:67], v[66:67], v[182:183] op_sel_hi:[1,0]
v_pk_fma_f32 v[64:65], v[212:213], v[188:189], v[64:65] op_sel_hi:[1,0,1]
v_pk_fma_f32 v[66:67], v[214:215], v[188:189], v[66:67] op_sel_hi:[1,0,1]
v_pk_mul_f32 v[68:69], v[68:69], v[182:183] op_sel_hi:[1,0]
v_pk_mul_f32 v[70:71], v[70:71], v[182:183] op_sel_hi:[1,0]
v_pk_fma_f32 v[68:69], v[216:217], v[188:189], v[68:69] op_sel_hi:[1,0,1]
v_pk_fma_f32 v[70:71], v[218:219], v[188:189], v[70:71] op_sel_hi:[1,0,1]
s_and_b32 s24, s5, 1
s_mul_i32 s25, s5, 7
s_add_u32 s26, s25, s24
s_lshr_b32 s26, s26, 1
s_xor_b32 s27, s24, 1
s_mul_i32 s27, s27, 6
s_add_u32 s27, s27, s25
s_lshr_b32 s27, s27, 1
s_lshl_b32 s26, s26, 10
s_lshl_b32 s27, s27, 10
s_lshl_b32 s24, s24, 3
s_add_u32 s27, s27, s24
s_mul_i32 s28, s32, 57344
s_add_u32 s28, s28, 35651584
s_add_u32 s29, s28, s27
s_add_u32 s28, s28, s26
v_max_f32 v16, 0, v16
v_max_f32 v17, 0, v17
v_max_f32 v18, 0, v18
v_max_f32 v19, 0, v19
v_max_f32 v20, 0, v20
v_max_f32 v21, 0, v21
v_max_f32 v22, 0, v22
v_max_f32 v23, 0, v23
v_max_f32 v24, 0, v24
v_max_f32 v25, 0, v25
v_max_f32 v26, 0, v26
v_max_f32 v27, 0, v27
v_max_f32 v28, 0, v28
v_max_f32 v29, 0, v29
v_max_f32 v30, 0, v30
v_max_f32 v31, 0, v31
v_max_f32 v32, 0, v32
v_max_f32 v33, 0, v33
v_max_f32 v34, 0, v34
v_max_f32 v35, 0, v35
v_max_f32 v36, 0, v36
v_max_f32 v37, 0, v37
v_max_f32 v38, 0, v38
v_max_f32 v39, 0, v39
v_max_f32 v40, 0, v40
v_max_f32 v41, 0, v41
v_max_f32 v42, 0, v42
v_max_f32 v43, 0, v43
v_cvt_pk_bf16_f32 v88, v16, v17
v_cvt_pk_bf16_f32 v89, v18, v19
v_cvt_pk_bf16_f32 v90, v20, v21
v_cvt_pk_bf16_f32 v91, v22, v23
v_cvt_pk_bf16_f32 v92, v24, v25
v_cvt_pk_bf16_f32 v93, v26, v27
v_cvt_pk_bf16_f32 v94, v28, v29
v_cvt_pk_bf16_f32 v95, v30, v31
v_cvt_pk_bf16_f32 v96, v32, v33
v_cvt_pk_bf16_f32 v97, v34, v35
v_cvt_pk_bf16_f32 v98, v36, v37
v_cvt_pk_bf16_f32 v99, v38, v39
v_cvt_pk_bf16_f32 v100, v40, v41
v_cvt_pk_bf16_f32 v101, v42, v43
buffer_store_dwordx4 v[88:91], v2, s[8:11], s28 offen offset:0 sc1
buffer_store_dwordx4 v[92:95], v2, s[8:11], s28 offen offset:1024 sc1
buffer_store_dwordx4 v[96:99], v2, s[8:11], s28 offen offset:2048 sc1
buffer_store_dwordx2 v[100:101], v2, s[8:11], s29 offen sc1
s_mul_i32 s28, s33, 57344
s_add_u32 s28, s28, 35651584
s_add_u32 s29, s28, s27
s_add_u32 s28, s28, s26
v_max_f32 v44, 0, v44
v_max_f32 v45, 0, v45
v_max_f32 v46, 0, v46
v_max_f32 v47, 0, v47
v_max_f32 v48, 0, v48
v_max_f32 v49, 0, v49
v_max_f32 v50, 0, v50
v_max_f32 v51, 0, v51
v_max_f32 v52, 0, v52
v_max_f32 v53, 0, v53
v_max_f32 v54, 0, v54
v_max_f32 v55, 0, v55
v_max_f32 v56, 0, v56
v_max_f32 v57, 0, v57
v_max_f32 v58, 0, v58
v_max_f32 v59, 0, v59
v_max_f32 v60, 0, v60
v_max_f32 v61, 0, v61
v_max_f32 v62, 0, v62
v_max_f32 v63, 0, v63
v_max_f32 v64, 0, v64
v_max_f32 v65, 0, v65
v_max_f32 v66, 0, v66
v_max_f32 v67, 0, v67
v_max_f32 v68, 0, v68
v_max_f32 v69, 0, v69
v_max_f32 v70, 0, v70
v_max_f32 v71, 0, v71
v_cvt_pk_bf16_f32 v104, v44, v45
v_cvt_pk_bf16_f32 v105, v46, v47
v_cvt_pk_bf16_f32 v106, v48, v49
v_cvt_pk_bf16_f32 v107, v50, v51
v_cvt_pk_bf16_f32 v108, v52, v53
v_cvt_pk_bf16_f32 v109, v54, v55
v_cvt_pk_bf16_f32 v110, v56, v57
v_cvt_pk_bf16_f32 v111, v58, v59
v_cvt_pk_bf16_f32 v112, v60, v61
v_cvt_pk_bf16_f32 v113, v62, v63
v_cvt_pk_bf16_f32 v114, v64, v65
v_cvt_pk_bf16_f32 v115, v66, v67
v_cvt_pk_bf16_f32 v116, v68, v69
v_cvt_pk_bf16_f32 v117, v70, v71
buffer_store_dwordx4 v[104:107], v2, s[8:11], s28 offen offset:0 sc1
buffer_store_dwordx4 v[108:111], v2, s[8:11], s28 offen offset:1024 sc1
buffer_store_dwordx4 v[112:115], v2, s[8:11], s28 offen offset:2048 sc1
buffer_store_dwordx2 v[116:117], v2, s[8:11], s29 offen sc1
s_lshr_b32 s30, s89, 1
s_mul_i32 s32, s30, 286720
s_mul_i32 s33, s6, 71680
s_add_u32 s32, s32, s33
s_add_u32 s32, s32, 7340032
s_add_u32 s33, s32, 0
buffer_load_dwordx4 a[0:3], v2, s[8:11], s33 offen offset:0
s_add_u32 s33, s32, 0
buffer_load_dwordx4 a[4:7], v2, s[8:11], s33 offen offset:1024
s_add_u32 s33, s32, 0
buffer_load_dwordx4 a[8:11], v2, s[8:11], s33 offen offset:2048
s_add_u32 s33, s32, 0
buffer_load_dwordx4 a[12:15], v2, s[8:11], s33 offen offset:3072
s_add_u32 s33, s32, 4096
buffer_load_dwordx4 a[16:19], v2, s[8:11], s33 offen offset:0
s_add_u32 s33, s32, 4096
buffer_load_dwordx4 a[20:23], v2, s[8:11], s33 offen offset:1024
s_add_u32 s33, s32, 4096
buffer_load_dwordx4 a[24:27], v2, s[8:11], s33 offen offset:2048
s_add_u32 s33, s32, 4096
buffer_load_dwordx4 a[28:31], v2, s[8:11], s33 offen offset:3072
s_add_u32 s33, s32, 8192
buffer_load_dwordx4 a[32:35], v2, s[8:11], s33 offen offset:0
s_add_u32 s33, s32, 8192
buffer_load_dwordx4 a[36:39], v2, s[8:11], s33 offen offset:1024
s_add_u32 s33, s32, 8192
buffer_load_dwordx4 a[40:43], v2, s[8:11], s33 offen offset:2048
s_add_u32 s33, s32, 8192
buffer_load_dwordx4 a[44:47], v2, s[8:11], s33 offen offset:3072
s_add_u32 s33, s32, 12288
buffer_load_dwordx4 a[48:51], v2, s[8:11], s33 offen offset:0
s_add_u32 s33, s32, 12288
buffer_load_dwordx4 a[52:55], v2, s[8:11], s33 offen offset:1024
s_add_u32 s33, s32, 12288
buffer_load_dwordx4 a[56:59], v2, s[8:11], s33 offen offset:2048
s_add_u32 s33, s32, 12288
buffer_load_dwordx4 a[60:63], v2, s[8:11], s33 offen offset:3072
s_add_u32 s33, s32, 16384
buffer_load_dwordx4 a[64:67], v2, s[8:11], s33 offen offset:0
s_add_u32 s33, s32, 16384
buffer_load_dwordx4 a[68:71], v2, s[8:11], s33 offen offset:1024
s_add_u32 s33, s32, 16384
buffer_load_dwordx4 a[72:75], v2, s[8:11], s33 offen offset:2048
s_add_u32 s33, s32, 16384
buffer_load_dwordx4 a[76:79], v2, s[8:11], s33 offen offset:3072
s_waitcnt vmcnt(20)
s_barrier
s_cmp_lg_u32 s6, 0
s_cbranch_scc1 L_ar_26
v_mov_b32 v8, 1
v_mov_b32 v9, s20
s_mov_b64 exec, 1
buffer_atomic_add v8, v9, s[8:11], 0 offen sc1
s_mov_b64 exec, -1
L_ar_26:
s_mov_b32 s4, s88
s_mov_b32 s5, s89
s_mov_b32 s20, s90
s_lshr_b32 s30, s5, 1
s_and_b32 s31, s5, 1
s_add_u32 s33, s32, 20480
buffer_load_dwordx4 a[80:83], v2, s[8:11], s33 offen offset:0
s_add_u32 s33, s32, 20480
buffer_load_dwordx4 a[84:87], v2, s[8:11], s33 offen offset:1024
s_add_u32 s33, s32, 20480
buffer_load_dwordx4 a[88:91], v2, s[8:11], s33 offen offset:2048
s_add_u32 s33, s32, 20480
buffer_load_dwordx4 a[92:95], v2, s[8:11], s33 offen offset:3072
s_add_u32 s33, s32, 24576
buffer_load_dwordx4 a[96:99], v2, s[8:11], s33 offen offset:0
s_add_u32 s33, s32, 24576
buffer_load_dwordx4 a[100:103], v2, s[8:11], s33 offen offset:1024
s_add_u32 s33, s32, 24576
buffer_load_dwordx4 a[104:107], v2, s[8:11], s33 offen offset:2048
s_add_u32 s33, s32, 24576
buffer_load_dwordx4 a[108:111], v2, s[8:11], s33 offen offset:3072
s_add_u32 s33, s32, 28672
buffer_load_dwordx4 a[112:115], v2, s[8:11], s33 offen offset:0
s_add_u32 s33, s32, 28672
buffer_load_dwordx4 a[116:119], v2, s[8:11], s33 offen offset:1024
s_add_u32 s33, s32, 28672
buffer_load_dwordx4 a[120:123], v2, s[8:11], s33 offen offset:2048
s_add_u32 s33, s32, 28672
buffer_load_dwordx4 a[124:127], v2, s[8:11], s33 offen offset:3072
s_add_u32 s33, s32, 32768
buffer_load_dwordx4 a[128:131], v2, s[8:11], s33 offen offset:0
s_add_u32 s33, s32, 32768
buffer_load_dwordx4 a[132:135], v2, s[8:11], s33 offen offset:1024
s_add_u32 s33, s32, 32768
buffer_load_dwordx4 a[136:139], v2, s[8:11], s33 offen offset:2048
s_add_u32 s33, s32, 32768
buffer_load_dwordx4 a[140:143], v2, s[8:11], s33 offen offset:3072
s_add_u32 s33, s32, 36864
buffer_load_dwordx4 a[144:147], v2, s[8:11], s33 offen offset:0
s_add_u32 s33, s32, 36864
buffer_load_dwordx4 a[148:151], v2, s[8:11], s33 offen offset:1024
s_add_u32 s33, s32, 36864
buffer_load_dwordx4 a[152:155], v2, s[8:11], s33 offen offset:2048
s_add_u32 s33, s32, 36864
buffer_load_dwordx4 a[156:159], v2, s[8:11], s33 offen offset:3072
s_add_u32 s33, s32, 40960
buffer_load_dwordx4 a[160:163], v2, s[8:11], s33 offen offset:0
s_add_u32 s33, s32, 40960
buffer_load_dwordx4 a[164:167], v2, s[8:11], s33 offen offset:1024
s_add_u32 s33, s32, 40960
buffer_load_dwordx4 a[168:171], v2, s[8:11], s33 offen offset:2048
s_add_u32 s33, s32, 40960
buffer_load_dwordx4 a[172:175], v2, s[8:11], s33 offen offset:3072
s_add_u32 s33, s32, 45056
buffer_load_dwordx4 a[176:179], v2, s[8:11], s33 offen offset:0
s_add_u32 s33, s32, 45056
buffer_load_dwordx4 a[180:183], v2, s[8:11], s33 offen offset:1024
s_add_u32 s33, s32, 45056
buffer_load_dwordx4 a[184:187], v2, s[8:11], s33 offen offset:2048
s_add_u32 s33, s32, 45056
buffer_load_dwordx4 a[188:191], v2, s[8:11], s33 offen offset:3072
s_add_u32 s33, s32, 49152
buffer_load_dwordx4 a[192:195], v2, s[8:11], s33 offen offset:0
s_add_u32 s33, s32, 49152
buffer_load_dwordx4 a[196:199], v2, s[8:11], s33 offen offset:1024
s_add_u32 s33, s32, 49152
buffer_load_dwordx4 a[200:203], v2, s[8:11], s33 offen offset:2048
s_add_u32 s33, s32, 49152
buffer_load_dwordx4 a[204:207], v2, s[8:11], s33 offen offset:3072
s_add_u32 s33, s32, 53248
buffer_load_dwordx4 a[208:211], v2, s[8:11], s33 offen offset:0
s_add_u32 s33, s32, 53248
buffer_load_dwordx4 a[212:215], v2, s[8:11], s33 offen offset:1024
s_add_u32 s33, s32, 53248
buffer_load_dwordx4 a[216:219], v2, s[8:11], s33 offen offset:2048
s_add_u32 s33, s32, 53248
buffer_load_dwordx4 a[220:223], v2, s[8:11], s33 offen offset:3072
s_add_u32 s33, s32, 57344
buffer_load_dwordx4 a[224:227], v2, s[8:11], s33 offen offset:0
s_add_u32 s33, s32, 57344
buffer_load_dwordx4 a[228:231], v2, s[8:11], s33 offen offset:1024
s_add_u32 s33, s32, 57344
buffer_load_dwordx4 a[232:235], v2, s[8:11], s33 offen offset:2048
s_add_u32 s33, s32, 57344
buffer_load_dwordx4 a[236:239], v2, s[8:11], s33 offen offset:3072
s_add_u32 s33, s32, 61440
buffer_load_dwordx4 a[240:243], v2, s[8:11], s33 offen offset:0
s_add_u32 s33, s32, 61440
buffer_load_dwordx4 a[244:247], v2, s[8:11], s33 offen offset:1024
s_add_u32 s33, s32, 61440
buffer_load_dwordx4 a[248:251], v2, s[8:11], s33 offen offset:2048
s_add_u32 s33, s32, 61440
buffer_load_dwordx4 a[252:255], v2, s[8:11], s33 offen offset:3072
s_add_u32 s33, s32, 65536
buffer_load_dwordx4 v[96:99], v2, s[8:11], s33 offen offset:0
s_cmp_lg_u32 s6, 0
s_cbranch_scc1 L_pl_27
v_mov_b32 v9, s20
s_mov_b64 exec, 1
s_mov_b32 s21, 48
s_mov_b32 s22, 0
L_lp_28:
buffer_load_dword v6, v9, s[8:11], 0 offen sc1
s_waitcnt vmcnt(0)
v_cmp_gt_u32 vcc, s21, v6
s_cbranch_vccz L_dn_29
s_add_u32 s22, s22, 1
s_cmp_lt_u32 s22, 40000
s_cbranch_scc1 L_lp_28
L_dn_29:
s_mov_b64 exec, -1
L_pl_27:
s_barrier
s_lshl_b32 s34, s4, 3
s_lshl_b32 s35, s31, 2
s_add_u32 s34, s34, s35
s_add_u32 s35, s6, 0
s_and_b32 s35, s35, 3
s_add_u32 s35, s35, s34
s_mov_b32 s36, s35
s_mul_i32 s35, s35, 57344
v_add_u32 v232, s35, v2
s_add_u32 s35, s6, 1
s_and_b32 s35, s35, 3
s_add_u32 s35, s35, s34
s_mul_i32 s35, s35, 57344
v_add_u32 v233, s35, v2
s_add_u32 s35, s6, 2
s_and_b32 s35, s35, 3
s_add_u32 s35, s35, s34
s_mul_i32 s35, s35, 57344
v_add_u32 v234, s35, v2
s_add_u32 s35, s6, 3
s_and_b32 s35, s35, 3
s_add_u32 s35, s35, s34
s_mul_i32 s35, s35, 57344
v_add_u32 v235, s35, v2
s_mul_i32 s37, s6, 14336
s_add_u32 s37, s37, 35651584
buffer_load_dwordx4 v[120:123], v232, s[8:11], s37 offen offset:0 sc1
buffer_load_dwordx4 v[124:127], v233, s[8:11], s37 offen offset:0 sc1
buffer_load_dwordx4 v[128:131], v234, s[8:11], s37 offen offset:0 sc1
buffer_load_dwordx4 v[132:135], v235, s[8:11], s37 offen offset:0 sc1
buffer_load_dwordx4 v[136:139], v232, s[8:11], s37 offen offset:1024 sc1
buffer_load_dwordx4 v[140:143], v233, s[8:11], s37 offen offset:1024 sc1
buffer_load_dwordx4 v[144:147], v234, s[8:11], s37 offen offset:1024 sc1
buffer_load_dwordx4 v[148:151], v235, s[8:11], s37 offen offset:1024 sc1
buffer_load_dwordx4 v[152:155], v232, s[8:11], s37 offen offset:2048 sc1
buffer_load_dwordx4 v[156:159], v233, s[8:11], s37 offen offset:2048 sc1
buffer_load_dwordx4 v[160:163], v234, s[8:11], s37 offen offset:2048 sc1
buffer_load_dwordx4 v[164:167], v235, s[8:11], s37 offen offset:2048 sc1
buffer_load_dwordx4 v[168:171], v232, s[8:11], s37 offen offset:3072 sc1
buffer_load_dwordx4 v[172:175], v233, s[8:11], s37 offen offset:3072 sc1
buffer_load_dwordx4 v[176:179], v234, s[8:11], s37 offen offset:3072 sc1
buffer_load_dwordx4 v[180:183], v235, s[8:11], s37 offen offset:3072 sc1
s_add_u32 s37, s37, 4096
buffer_load_dwordx4 v[184:187], v232, s[8:11], s37 offen offset:0 sc1
buffer_load_dwordx4 v[188:191], v233, s[8:11], s37 offen offset:0 sc1
buffer_load_dwordx4 v[192:195], v234, s[8:11], s37 offen offset:0 sc1
buffer_load_dwordx4 v[196:199], v235, s[8:11], s37 offen offset:0 sc1
buffer_load_dwordx4 v[200:203], v232, s[8:11], s37 offen offset:1024 sc1
buffer_load_dwordx4 v[204:207], v233, s[8:11], s37 offen offset:1024 sc1
buffer_load_dwordx4 v[208:211], v234, s[8:11], s37 offen offset:1024 sc1
buffer_load_dwordx4 v[212:215], v235, s[8:11], s37 offen offset:1024 sc1
buffer_load_dwordx4 v[216:219], v232, s[8:11], s37 offen offset:2048 sc1
buffer_load_dwordx4 v[220:223], v233, s[8:11], s37 offen offset:2048 sc1
buffer_load_dwordx4 v[224:227], v234, s[8:11], s37 offen offset:2048 sc1
buffer_load_dwordx4 v[228:231], v235, s[8:11], s37 offen offset:2048 sc1
s_and_b32 s38, s30, 1
s_mul_i32 s39, s30, 5
s_add_u32 s40, s39, s38
s_lshr_b32 s40, s40, 1
s_xor_b32 s41, s38, 1
s_lshl_b32 s41, s41, 2
s_add_u32 s41, s41, s39
s_lshr_b32 s41, s41, 1
s_lshl_b32 s40, s40, 10
s_lshl_b32 s41, s41, 10
s_lshl_b32 s42, s38, 3
s_add_u32 s41, s41, s42
s_mul_i32 s42, s36, 20480
s_add_u32 s40, s40, s42
s_add_u32 s41, s41, s42
s_add_u32 s43, s40, 19922944
s_add_u32 s44, s41, 19922944
s_and_b32 s52, s88, 3
s_and_b32 s53, s89, 1
s_lshl_b32 s53, s53, 2
s_add_u32 s53, s53, s52
s_lshr_b32 s54, s89, 1
s_mul_i32 s56, s89, 163840
s_mul_i32 s60, s52, 40960
s_add_u32 s56, s56, s60
s_mul_i32 s60, s6, 10240
s_add_u32 s56, s56, s60
s_add_u32 s56, s56, 0
s_waitcnt vmcnt(24)
v_mfma_f32_16x16x32_bf16 v[16:19], a[0:3], v[120:123], 0
v_mfma_f32_16x16x32_bf16 v[20:23], a[4:7], v[120:123], 0
s_add_u32 s45, s32, 65536
buffer_load_dwordx4 v[100:103], v2, s[8:11], s45 offen offset:1024
v_mfma_f32_16x16x32_bf16 v[24:27], a[8:11], v[120:123], 0
v_mfma_f32_16x16x32_bf16 v[28:31], a[12:15], v[120:123], 0
v_mfma_f32_16x16x32_bf16 v[32:35], a[16:19], v[120:123], 0
v_mfma_f32_16x16x32_bf16 v[36:39], a[0:3], v[124:127], 0
buffer_load_dwordx4 v[104:107], v2, s[8:11], s45 offen offset:2048
v_mfma_f32_16x16x32_bf16 v[40:43], a[4:7], v[124:127], 0
v_mfma_f32_16x16x32_bf16 v[44:47], a[8:11], v[124:127], 0
v_mfma_f32_16x16x32_bf16 v[48:51], a[12:15], v[124:127], 0
v_mfma_f32_16x16x32_bf16 v[52:55], a[16:19], v[124:127], 0
buffer_load_dwordx4 v[108:111], v2, s[8:11], s45 offen offset:3072
v_mfma_f32_16x16x32_bf16 v[56:59], a[0:3], v[128:131], 0
v_mfma_f32_16x16x32_bf16 v[60:63], a[4:7], v[128:131], 0
v_mfma_f32_16x16x32_bf16 v[64:67], a[8:11], v[128:131], 0
v_mfma_f32_16x16x32_bf16 v[68:71], a[12:15], v[128:131], 0
s_add_u32 s45, s32, 69632
buffer_load_dwordx4 v[112:115], v2, s[8:11], s45 offen offset:0
v_mfma_f32_16x16x32_bf16 v[72:75], a[16:19], v[128:131], 0
v_mfma_f32_16x16x32_bf16 v[76:79], a[0:3], v[132:135], 0
v_mfma_f32_16x16x32_bf16 v[80:83], a[4:7], v[132:135], 0
v_mfma_f32_16x16x32_bf16 v[84:87], a[8:11], v[132:135], 0
buffer_load_dwordx4 v[116:119], v2, s[8:11], s45 offen offset:1024
v_mfma_f32_16x16x32_bf16 v[88:91], a[12:15], v[132:135], 0
v_mfma_f32_16x16x32_bf16 v[92:95], a[16:19], v[132:135], 0
s_waitcnt vmcnt(25)
v_mfma_f32_16x16x32_bf16 v[16:19], a[20:23], v[136:139], v[16:19]
v_mfma_f32_16x16x32_bf16 v[20:23], a[24:27], v[136:139], v[20:23]
buffer_load_dwordx4 v[120:123], v232, s[8:11], s37 offen offset:3072 sc1
v_mfma_f32_16x16x32_bf16 v[24:27], a[28:31], v[136:139], v[24:27]
v_mfma_f32_16x16x32_bf16 v[28:31], a[32:35], v[136:139], v[28:31]
v_mfma_f32_16x16x32_bf16 v[32:35], a[36:39], v[136:139], v[32:35]
v_mfma_f32_16x16x32_bf16 v[36:39], a[20:23], v[140:143], v[36:39]
v_mfma_f32_16x16x32_bf16 v[40:43], a[24:27], v[140:143], v[40:43]
buffer_load_dwordx4 v[124:127], v233, s[8:11], s37 offen offset:3072 sc1
v_mfma_f32_16x16x32_bf16 v[44:47], a[28:31], v[140:143], v[44:47]
v_mfma_f32_16x16x32_bf16 v[48:51], a[32:35], v[140:143], v[48:51]
v_mfma_f32_16x16x32_bf16 v[52:55], a[36:39], v[140:143], v[52:55]
v_mfma_f32_16x16x32_bf16 v[56:59], a[20:23], v[144:147], v[56:59]
v_mfma_f32_16x16x32_bf16 v[60:63], a[24:27], v[144:147], v[60:63]
buffer_load_dwordx4 v[128:131], v234, s[8:11], s37 offen offset:3072 sc1
v_mfma_f32_16x16x32_bf16 v[64:67], a[28:31], v[144:147], v[64:67]
v_mfma_f32_16x16x32_bf16 v[68:71], a[32:35], v[144:147], v[68:71]
v_mfma_f32_16x16x32_bf16 v[72:75], a[36:39], v[144:147], v[72:75]
v_mfma_f32_16x16x32_bf16 v[76:79], a[20:23], v[148:151], v[76:79]
v_mfma_f32_16x16x32_bf16 v[80:83], a[24:27], v[148:151], v[80:83]
buffer_load_dwordx4 v[132:135], v235, s[8:11], s37 offen offset:3072 sc1
v_mfma_f32_16x16x32_bf16 v[84:87], a[28:31], v[148:151], v[84:87]
v_mfma_f32_16x16x32_bf16 v[88:91], a[32:35], v[148:151], v[88:91]
v_mfma_f32_16x16x32_bf16 v[92:95], a[36:39], v[148:151], v[92:95]
s_waitcnt vmcnt(25)
v_mfma_f32_16x16x32_bf16 v[16:19], a[40:43], v[152:155], v[16:19]
v_mfma_f32_16x16x32_bf16 v[20:23], a[44:47], v[152:155], v[20:23]
s_add_u32 s37, s37, 4096
buffer_load_dwordx4 v[136:139], v232, s[8:11], s37 offen offset:0 sc1
v_mfma_f32_16x16x32_bf16 v[24:27], a[48:51], v[152:155], v[24:27]
v_mfma_f32_16x16x32_bf16 v[28:31], a[52:55], v[152:155], v[28:31]
v_mfma_f32_16x16x32_bf16 v[32:35], a[56:59], v[152:155], v[32:35]
v_mfma_f32_16x16x32_bf16 v[36:39], a[40:43], v[156:159], v[36:39]
v_mfma_f32_16x16x32_bf16 v[40:43], a[44:47], v[156:159], v[40:43]
buffer_load_dwordx4 v[140:143], v233, s[8:11], s37 offen offset:0 sc1
v_mfma_f32_16x16x32_bf16 v[44:47], a[48:51], v[156:159], v[44:47]
v_mfma_f32_16x16x32_bf16 v[48:51], a[52:55], v[156:159], v[48:51]
v_mfma_f32_16x16x32_bf16 v[52:55], a[56:59], v[156:159], v[52:55]
v_mfma_f32_16x16x32_bf16 v[56:59], a[40:43], v[160:163], v[56:59]
v_mfma_f32_16x16x32_bf16 v[60:63], a[44:47], v[160:163], v[60:63]
buffer_load_dwordx4 v[144:147], v234, s[8:11], s37 offen offset:0 sc1
v_mfma_f32_16x16x32_bf16 v[64:67], a[48:51], v[160:163], v[64:67]
v_mfma_f32_16x16x32_bf16 v[68:71], a[52:55], v[160:163], v[68:71]
v_mfma_f32_16x16x32_bf16 v[72:75], a[56:59], v[160:163], v[72:75]
v_mfma_f32_16x16x32_bf16 v[76:79], a[40:43], v[164:167], v[76:79]
v_mfma_f32_16x16x32_bf16 v[80:83], a[44:47], v[164:167], v[80:83]
buffer_load_dwordx4 v[148:151], v235, s[8:11], s37 offen offset:0 sc1
v_mfma_f32_16x16x32_bf16 v[84:87], a[48:51], v[164:167], v[84:87]
v_mfma_f32_16x16x32_bf16 v[88:91], a[52:55], v[164:167], v[88:91]
v_mfma_f32_16x16x32_bf16 v[92:95], a[56:59], v[164:167], v[92:95]
s_waitcnt vmcnt(25)
v_mfma_f32_16x16x32_bf16 v[16:19], a[60:63], v[168:171], v[16:19]
v_mfma_f32_16x16x32_bf16 v[20:23], a[64:67], v[168:171], v[20:23]
buffer_load_dwordx4 v[152:155], v232, s[8:11], s37 offen offset:1024 sc1
v_mfma_f32_16x16x32_bf16 v[24:27], a[68:71], v[168:171], v[24:27]
v_mfma_f32_16x16x32_bf16 v[28:31], a[72:75], v[168:171], v[28:31]
v_mfma_f32_16x16x32_bf16 v[32:35], a[76:79], v[168:171], v[32:35]
v_mfma_f32_16x16x32_bf16 v[36:39], a[60:63], v[172:175], v[36:39]
v_mfma_f32_16x16x32_bf16 v[40:43], a[64:67], v[172:175], v[40:43]
buffer_load_dwordx4 v[156:159], v233, s[8:11], s37 offen offset:1024 sc1
v_mfma_f32_16x16x32_bf16 v[44:47], a[68:71], v[172:175], v[44:47]
v_mfma_f32_16x16x32_bf16 v[48:51], a[72:75], v[172:175], v[48:51]
v_mfma_f32_16x16x32_bf16 v[52:55], a[76:79], v[172:175], v[52:55]
v_mfma_f32_16x16x32_bf16 v[56:59], a[60:63], v[176:179], v[56:59]
v_mfma_f32_16x16x32_bf16 v[60:63], a[64:67], v[176:179], v[60:63]
buffer_load_dwordx4 v[160:163], v234, s[8:11], s37 offen offset:1024 sc1
v_mfma_f32_16x16x32_bf16 v[64:67], a[68:71], v[176:179], v[64:67]
v_mfma_f32_16x16x32_bf16 v[68:71], a[72:75], v[176:179], v[68:71]
v_mfma_f32_16x16x32_bf16 v[72:75], a[76:79], v[176:179], v[72:75]
v_mfma_f32_16x16x32_bf16 v[76:79], a[60:63], v[180:183], v[76:79]
v_mfma_f32_16x16x32_bf16 v[80:83], a[64:67], v[180:183], v[80:83]
buffer_load_dwordx4 v[164:167], v235, s[8:11], s37 offen offset:1024 sc1
v_mfma_f32_16x16x32_bf16 v[84:87], a[68:71], v[180:183], v[84:87]
v_mfma_f32_16x16x32_bf16 v[88:91], a[72:75], v[180:183], v[88:91]
v_mfma_f32_16x16x32_bf16 v[92:95], a[76:79], v[180:183], v[92:95]
s_waitcnt vmcnt(25)
v_mfma_f32_16x16x32_bf16 v[16:19], a[80:83], v[184:187], v[16:19]
v_mfma_f32_16x16x32_bf16 v[20:23], a[84:87], v[184:187], v[20:23]
buffer_load_dwordx4 v[168:171], v232, s[8:11], s37 offen offset:2048 sc1
v_mfma_f32_16x16x32_bf16 v[24:27], a[88:91], v[184:187], v[24:27]
v_mfma_f32_16x16x32_bf16 v[28:31], a[92:95], v[184:187], v[28:31]
v_mfma_f32_16x16x32_bf16 v[32:35], a[96:99], v[184:187], v[32:35]
v_mfma_f32_16x16x32_bf16 v[36:39], a[80:83], v[188:191], v[36:39]
v_mfma_f32_16x16x32_bf16 v[40:43], a[84:87], v[188:191], v[40:43]
buffer_load_dwordx4 v[172:175], v233, s[8:11], s37 offen offset:2048 sc1
v_mfma_f32_16x16x32_bf16 v[44:47], a[88:91], v[188:191], v[44:47]
v_mfma_f32_16x16x32_bf16 v[48:51], a[92:95], v[188:191], v[48:51]
v_mfma_f32_16x16x32_bf16 v[52:55], a[96:99], v[188:191], v[52:55]
v_mfma_f32_16x16x32_bf16 v[56:59], a[80:83], v[192:195], v[56:59]
v_mfma_f32_16x16x32_bf16 v[60:63], a[84:87], v[192:195], v[60:63]
buffer_load_dwordx4 v[176:179], v234, s[8:11], s37 offen offset:2048 sc1
v_mfma_f32_16x16x32_bf16 v[64:67], a[88:91], v[192:195], v[64:67]
v_mfma_f32_16x16x32_bf16 v[68:71], a[92:95], v[192:195], v[68:71]
v_mfma_f32_16x16x32_bf16 v[72:75], a[96:99], v[192:195], v[72:75]
v_mfma_f32_16x16x32_bf16 v[76:79], a[80:83], v[196:199], v[76:79]
v_mfma_f32_16x16x32_bf16 v[80:83], a[84:87], v[196:199], v[80:83]
buffer_load_dwordx4 v[180:183], v235, s[8:11], s37 offen offset:2048 sc1
v_mfma_f32_16x16x32_bf16 v[84:87], a[88:91], v[196:199], v[84:87]
v_mfma_f32_16x16x32_bf16 v[88:91], a[92:95], v[196:199], v[88:91]
v_mfma_f32_16x16x32_bf16 v[92:95], a[96:99], v[196:199], v[92:95]
s_waitcnt vmcnt(25)
v_mfma_f32_16x16x32_bf16 v[16:19], a[100:103], v[200:203], v[16:19]
v_mfma_f32_16x16x32_bf16 v[20:23], a[104:107], v[200:203], v[20:23]
buffer_load_dwordx4 v[184:187], v232, s[8:11], s37 offen offset:3072 sc1
v_mfma_f32_16x16x32_bf16 v[24:27], a[108:111], v[200:203], v[24:27]
v_mfma_f32_16x16x32_bf16 v[28:31], a[112:115], v[200:203], v[28:31]
v_mfma_f32_16x16x32_bf16 v[32:35], a[116:119], v[200:203], v[32:35]
v_mfma_f32_16x16x32_bf16 v[36:39], a[100:103], v[204:207], v[36:39]
v_mfma_f32_16x16x32_bf16 v[40:43], a[104:107], v[204:207], v[40:43]
buffer_load_dwordx4 v[188:191], v233, s[8:11], s37 offen offset:3072 sc1
v_mfma_f32_16x16x32_bf16 v[44:47], a[108:111], v[204:207], v[44:47]
v_mfma_f32_16x16x32_bf16 v[48:51], a[112:115], v[204:207], v[48:51]
v_mfma_f32_16x16x32_bf16 v[52:55], a[116:119], v[204:207], v[52:55]
v_mfma_f32_16x16x32_bf16 v[56:59], a[100:103], v[208:211], v[56:59]
v_mfma_f32_16x16x32_bf16 v[60:63], a[104:107], v[208:211], v[60:63]
buffer_load_dwordx4 v[192:195], v234, s[8:11], s37 offen offset:3072 sc1
v_mfma_f32_16x16x32_bf16 v[64:67], a[108:111], v[208:211], v[64:67]
v_mfma_f32_16x16x32_bf16 v[68:71], a[112:115], v[208:211], v[68:71]
v_mfma_f32_16x16x32_bf16 v[72:75], a[116:119], v[208:211], v[72:75]
v_mfma_f32_16x16x32_bf16 v[76:79], a[100:103], v[212:215], v[76:79]
v_mfma_f32_16x16x32_bf16 v[80:83], a[104:107], v[212:215], v[80:83]
buffer_load_dwordx4 v[196:199], v235, s[8:11], s37 offen offset:3072 sc1
v_mfma_f32_16x16x32_bf16 v[84:87], a[108:111], v[212:215], v[84:87]
v_mfma_f32_16x16x32_bf16 v[88:91], a[112:115], v[212:215], v[88:91]
v_mfma_f32_16x16x32_bf16 v[92:95], a[116:119], v[212:215], v[92:95]
s_waitcnt vmcnt(25)
v_mfma_f32_16x16x32_bf16 v[16:19], a[120:123], v[216:219], v[16:19]
v_mfma_f32_16x16x32_bf16 v[20:23], a[124:127], v[216:219], v[20:23]
s_add_u32 s37, s37, 4096
buffer_load_dwordx4 v[200:203], v232, s[8:11], s37 offen offset:0 sc1
v_mfma_f32_16x16x32_bf16 v[24:27], a[128:131], v[216:219], v[24:27]
v_mfma_f32_16x16x32_bf16 v[28:31], a[132:135], v[216:219], v[28:31]
v_mfma_f32_16x16x32_bf16 v[32:35], a[136:139], v[216:219], v[32:35]
v_mfma_f32_16x16x32_bf16 v[36:39], a[120:123], v[220:223], v[36:39]
v_mfma_f32_16x16x32_bf16 v[40:43], a[124:127], v[220:223], v[40:43]
buffer_load_dwordx4 v[204:207], v233, s[8:11], s37 offen offset:0 sc1
v_mfma_f32_16x16x32_bf16 v[44:47], a[128:131], v[220:223], v[44:47]
v_mfma_f32_16x16x32_bf16 v[48:51], a[132:135], v[220:223], v[48:51]
v_mfma_f32_16x16x32_bf16 v[52:55], a[136:139], v[220:223], v[52:55]
v_mfma_f32_16x16x32_bf16 v[56:59], a[120:123], v[224:227], v[56:59]
v_mfma_f32_16x16x32_bf16 v[60:63], a[124:127], v[224:227], v[60:63]
buffer_load_dwordx4 v[208:211], v234, s[8:11], s37 offen offset:0 sc1
v_mfma_f32_16x16x32_bf16 v[64:67], a[128:131], v[224:227], v[64:67]
v_mfma_f32_16x16x32_bf16 v[68:71], a[132:135], v[224:227], v[68:71]
v_mfma_f32_16x16x32_bf16 v[72:75], a[136:139], v[224:227], v[72:75]
v_mfma_f32_16x16x32_bf16 v[76:79], a[120:123], v[228:231], v[76:79]
v_mfma_f32_16x16x32_bf16 v[80:83], a[124:127], v[228:231], v[80:83]
buffer_load_dwordx4 v[212:215], v235, s[8:11], s37 offen offset:0 sc1
v_mfma_f32_16x16x32_bf16 v[84:87], a[128:131], v[228:231], v[84:87]
v_mfma_f32_16x16x32_bf16 v[88:91], a[132:135], v[228:231], v[88:91]
v_mfma_f32_16x16x32_bf16 v[92:95], a[136:139], v[228:231], v[92:95]
s_waitcnt vmcnt(20)
v_mfma_f32_16x16x32_bf16 v[16:19], a[140:143], v[120:123], v[16:19]
v_mfma_f32_16x16x32_bf16 v[20:23], a[144:147], v[120:123], v[20:23]
buffer_load_dwordx4 v[216:219], v232, s[8:11], s37 offen offset:1024 sc1
v_mfma_f32_16x16x32_bf16 v[24:27], a[148:151], v[120:123], v[24:27]
v_mfma_f32_16x16x32_bf16 v[28:31], a[152:155], v[120:123], v[28:31]
v_mfma_f32_16x16x32_bf16 v[32:35], a[156:159], v[120:123], v[32:35]
v_mfma_f32_16x16x32_bf16 v[36:39], a[140:143], v[124:127], v[36:39]
v_mfma_f32_16x16x32_bf16 v[40:43], a[144:147], v[124:127], v[40:43]
buffer_load_dwordx4 v[220:223], v233, s[8:11], s37 offen offset:1024 sc1
v_mfma_f32_16x16x32_bf16 v[44:47], a[148:151], v[124:127], v[44:47]
v_mfma_f32_16x16x32_bf16 v[48:51], a[152:155], v[124:127], v[48:51]
v_mfma_f32_16x16x32_bf16 v[52:55], a[156:159], v[124:127], v[52:55]
v_mfma_f32_16x16x32_bf16 v[56:59], a[140:143], v[128:131], v[56:59]
v_mfma_f32_16x16x32_bf16 v[60:63], a[144:147], v[128:131], v[60:63]
buffer_load_dwordx4 v[224:227], v234, s[8:11], s37 offen offset:1024 sc1
v_mfma_f32_16x16x32_bf16 v[64:67], a[148:151], v[128:131], v[64:67]
v_mfma_f32_16x16x32_bf16 v[68:71], a[152:155], v[128:131], v[68:71]
v_mfma_f32_16x16x32_bf16 v[72:75], a[156:159], v[128:131], v[72:75]
v_mfma_f32_16x16x32_bf16 v[76:79], a[140:143], v[132:135], v[76:79]
v_mfma_f32_16x16x32_bf16 v[80:83], a[144:147], v[132:135], v[80:83]
buffer_load_dwordx4 v[228:231], v235, s[8:11], s37 offen offset:1024 sc1
v_mfma_f32_16x16x32_bf16 v[84:87], a[148:151], v[132:135], v[84:87]
v_mfma_f32_16x16x32_bf16 v[88:91], a[152:155], v[132:135], v[88:91]
v_mfma_f32_16x16x32_bf16 v[92:95], a[156:159], v[132:135], v[92:95]
s_waitcnt vmcnt(20)
v_mfma_f32_16x16x32_bf16 v[16:19], a[160:163], v[136:139], v[16:19]
v_mfma_f32_16x16x32_bf16 v[20:23], a[164:167], v[136:139], v[20:23]
buffer_load_dwordx4 v[240:243], v2, s[8:11], s43 offen sc1
v_mfma_f32_16x16x32_bf16 v[24:27], a[168:171], v[136:139], v[24:27]
v_mfma_f32_16x16x32_bf16 v[28:31], a[172:175], v[136:139], v[28:31]
v_mfma_f32_16x16x32_bf16 v[32:35], a[176:179], v[136:139], v[32:35]
v_mfma_f32_16x16x32_bf16 v[36:39], a[160:163], v[140:143], v[36:39]
v_mfma_f32_16x16x32_bf16 v[40:43], a[164:167], v[140:143], v[40:43]
buffer_load_dwordx4 v[244:247], v2, s[8:11], s43 offen offset:1024 sc1
v_mfma_f32_16x16x32_bf16 v[44:47], a[168:171], v[140:143], v[44:47]
v_mfma_f32_16x16x32_bf16 v[48:51], a[172:175], v[140:143], v[48:51]
v_mfma_f32_16x16x32_bf16 v[52:55], a[176:179], v[140:143], v[52:55]
v_mfma_f32_16x16x32_bf16 v[56:59], a[160:163], v[144:147], v[56:59]
v_mfma_f32_16x16x32_bf16 v[60:63], a[164:167], v[144:147], v[60:63]
buffer_load_dwordx2 v[248:249], v2, s[8:11], s44 offen sc1
v_mfma_f32_16x16x32_bf16 v[64:67], a[168:171], v[144:147], v[64:67]
v_mfma_f32_16x16x32_bf16 v[68:71], a[172:175], v[144:147], v[68:71]
v_mfma_f32_16x16x32_bf16 v[72:75], a[176:179], v[144:147], v[72:75]
v_mfma_f32_16x16x32_bf16 v[76:79], a[160:163], v[148:151], v[76:79]
v_mfma_f32_16x16x32_bf16 v[80:83], a[164:167], v[148:151], v[80:83]
buffer_load_dword v254, v253, s[8:11], s56 offen
v_mfma_f32_16x16x32_bf16 v[84:87], a[168:171], v[148:151], v[84:87]
v_mfma_f32_16x16x32_bf16 v[88:91], a[172:175], v[148:151], v[88:91]
v_mfma_f32_16x16x32_bf16 v[92:95], a[176:179], v[148:151], v[92:95]
s_waitcnt vmcnt(20)
v_mfma_f32_16x16x32_bf16 v[16:19], a[180:183], v[152:155], v[16:19]
v_mfma_f32_16x16x32_bf16 v[20:23], a[184:187], v[152:155], v[20:23]
v_mfma_f32_16x16x32_bf16 v[24:27], a[188:191], v[152:155], v[24:27]
v_mfma_f32_16x16x32_bf16 v[28:31], a[192:195], v[152:155], v[28:31]
v_mfma_f32_16x16x32_bf16 v[32:35], a[196:199], v[152:155], v[32:35]
v_mfma_f32_16x16x32_bf16 v[36:39], a[180:183], v[156:159], v[36:39]
v_mfma_f32_16x16x32_bf16 v[40:43], a[184:187], v[156:159], v[40:43]
v_mfma_f32_16x16x32_bf16 v[44:47], a[188:191], v[156:159], v[44:47]
v_mfma_f32_16x16x32_bf16 v[48:51], a[192:195], v[156:159], v[48:51]
v_mfma_f32_16x16x32_bf16 v[52:55], a[196:199], v[156:159], v[52:55]
v_mfma_f32_16x16x32_bf16 v[56:59], a[180:183], v[160:163], v[56:59]
v_mfma_f32_16x16x32_bf16 v[60:63], a[184:187], v[160:163], v[60:63]
v_mfma_f32_16x16x32_bf16 v[64:67], a[188:191], v[160:163], v[64:67]
v_mfma_f32_16x16x32_bf16 v[68:71], a[192:195], v[160:163], v[68:71]
v_mfma_f32_16x16x32_bf16 v[72:75], a[196:199], v[160:163], v[72:75]
v_mfma_f32_16x16x32_bf16 v[76:79], a[180:183], v[164:167], v[76:79]
v_mfma_f32_16x16x32_bf16 v[80:83], a[184:187], v[164:167], v[80:83]
v_mfma_f32_16x16x32_bf16 v[84:87], a[188:191], v[164:167], v[84:87]
v_mfma_f32_16x16x32_bf16 v[88:91], a[192:195], v[164:167], v[88:91]
v_mfma_f32_16x16x32_bf16 v[92:95], a[196:199], v[164:167], v[92:95]
s_waitcnt vmcnt(16)
v_mfma_f32_16x16x32_bf16 v[16:19], a[200:203], v[168:171], v[16:19]
v_mfma_f32_16x16x32_bf16 v[20:23], a[204:207], v[168:171], v[20:23]
v_mfma_f32_16x16x32_bf16 v[24:27], a[208:211], v[168:171], v[24:27]
v_mfma_f32_16x16x32_bf16 v[28:31], a[212:215], v[168:171], v[28:31]
v_mfma_f32_16x16x32_bf16 v[32:35], a[216:219], v[168:171], v[32:35]
v_mfma_f32_16x16x32_bf16 v[36:39], a[200:203], v[172:175], v[36:39]
v_mfma_f32_16x16x32_bf16 v[40:43], a[204:207], v[172:175], v[40:43]
v_mfma_f32_16x16x32_bf16 v[44:47], a[208:211], v[172:175], v[44:47]
v_mfma_f32_16x16x32_bf16 v[48:51], a[212:215], v[172:175], v[48:51]
v_mfma_f32_16x16x32_bf16 v[52:55], a[216:219], v[172:175], v[52:55]
v_mfma_f32_16x16x32_bf16 v[56:59], a[200:203], v[176:179], v[56:59]
v_mfma_f32_16x16x32_bf16 v[60:63], a[204:207], v[176:179], v[60:63]
v_mfma_f32_16x16x32_bf16 v[64:67], a[208:211], v[176:179], v[64:67]
v_mfma_f32_16x16x32_bf16 v[68:71], a[212:215], v[176:179], v[68:71]
v_mfma_f32_16x16x32_bf16 v[72:75], a[216:219], v[176:179], v[72:75]
v_mfma_f32_16x16x32_bf16 v[76:79], a[200:203], v[180:183], v[76:79]
v_mfma_f32_16x16x32_bf16 v[80:83], a[204:207], v[180:183], v[80:83]
v_mfma_f32_16x16x32_bf16 v[84:87], a[208:211], v[180:183], v[84:87]
v_mfma_f32_16x16x32_bf16 v[88:91], a[212:215], v[180:183], v[88:91]
v_mfma_f32_16x16x32_bf16 v[92:95], a[216:219], v[180:183], v[92:95]
s_waitcnt vmcnt(12)
v_mfma_f32_16x16x32_bf16 v[16:19], a[220:223], v[184:187], v[16:19]
v_mfma_f32_16x16x32_bf16 v[20:23], a[224:227], v[184:187], v[20:23]
v_mfma_f32_16x16x32_bf16 v[24:27], a[228:231], v[184:187], v[24:27]
v_mfma_f32_16x16x32_bf16 v[28:31], a[232:235], v[184:187], v[28:31]
v_mfma_f32_16x16x32_bf16 v[32:35], a[236:239], v[184:187], v[32:35]
v_mfma_f32_16x16x32_bf16 v[36:39], a[220:223], v[188:191], v[36:39]
v_mfma_f32_16x16x32_bf16 v[40:43], a[224:227], v[188:191], v[40:43]
v_mfma_f32_16x16x32_bf16 v[44:47], a[228:231], v[188:191], v[44:47]
v_mfma_f32_16x16x32_bf16 v[48:51], a[232:235], v[188:191], v[48:51]
v_mfma_f32_16x16x32_bf16 v[52:55], a[236:239], v[188:191], v[52:55]
v_mfma_f32_16x16x32_bf16 v[56:59], a[220:223], v[192:195], v[56:59]
v_mfma_f32_16x16x32_bf16 v[60:63], a[224:227], v[192:195], v[60:63]
v_mfma_f32_16x16x32_bf16 v[64:67], a[228:231], v[192:195], v[64:67]
v_mfma_f32_16x16x32_bf16 v[68:71], a[232:235], v[192:195], v[68:71]
v_mfma_f32_16x16x32_bf16 v[72:75], a[236:239], v[192:195], v[72:75]
v_mfma_f32_16x16x32_bf16 v[76:79], a[220:223], v[196:199], v[76:79]
v_mfma_f32_16x16x32_bf16 v[80:83], a[224:227], v[196:199], v[80:83]
v_mfma_f32_16x16x32_bf16 v[84:87], a[228:231], v[196:199], v[84:87]
v_mfma_f32_16x16x32_bf16 v[88:91], a[232:235], v[196:199], v[88:91]
v_mfma_f32_16x16x32_bf16 v[92:95], a[236:239], v[196:199], v[92:95]
s_waitcnt vmcnt(8)
v_mfma_f32_16x16x32_bf16 v[16:19], a[240:243], v[200:203], v[16:19]
v_mfma_f32_16x16x32_bf16 v[20:23], a[244:247], v[200:203], v[20:23]
v_mfma_f32_16x16x32_bf16 v[24:27], a[248:251], v[200:203], v[24:27]
v_mfma_f32_16x16x32_bf16 v[28:31], a[252:255], v[200:203], v[28:31]
v_mfma_f32_16x16x32_bf16 v[32:35], v[96:99], v[200:203], v[32:35]
v_mfma_f32_16x16x32_bf16 v[36:39], a[240:243], v[204:207], v[36:39]
v_mfma_f32_16x16x32_bf16 v[40:43], a[244:247], v[204:207], v[40:43]
v_mfma_f32_16x16x32_bf16 v[44:47], a[248:251], v[204:207], v[44:47]
v_mfma_f32_16x16x32_bf16 v[48:51], a[252:255], v[204:207], v[48:51]
v_mfma_f32_16x16x32_bf16 v[52:55], v[96:99], v[204:207], v[52:55]
v_mfma_f32_16x16x32_bf16 v[56:59], a[240:243], v[208:211], v[56:59]
v_mfma_f32_16x16x32_bf16 v[60:63], a[244:247], v[208:211], v[60:63]
v_mfma_f32_16x16x32_bf16 v[64:67], a[248:251], v[208:211], v[64:67]
v_mfma_f32_16x16x32_bf16 v[68:71], a[252:255], v[208:211], v[68:71]
v_mfma_f32_16x16x32_bf16 v[72:75], v[96:99], v[208:211], v[72:75]
v_mfma_f32_16x16x32_bf16 v[76:79], a[240:243], v[212:215], v[76:79]
v_mfma_f32_16x16x32_bf16 v[80:83], a[244:247], v[212:215], v[80:83]
v_mfma_f32_16x16x32_bf16 v[84:87], a[248:251], v[212:215], v[84:87]
v_mfma_f32_16x16x32_bf16 v[88:91], a[252:255], v[212:215], v[88:91]
v_mfma_f32_16x16x32_bf16 v[92:95], v[96:99], v[212:215], v[92:95]
s_waitcnt vmcnt(4)
v_mfma_f32_16x16x32_bf16 v[16:19], v[100:103], v[216:219], v[16:19]
v_mfma_f32_16x16x32_bf16 v[20:23], v[104:107], v[216:219], v[20:23]
v_mfma_f32_16x16x32_bf16 v[24:27], v[108:111], v[216:219], v[24:27]
v_mfma_f32_16x16x32_bf16 v[28:31], v[112:115], v[216:219], v[28:31]
v_mfma_f32_16x16x32_bf16 v[32:35], v[116:119], v[216:219], v[32:35]
v_mfma_f32_16x16x32_bf16 v[36:39], v[100:103], v[220:223], v[36:39]
v_mfma_f32_16x16x32_bf16 v[40:43], v[104:107], v[220:223], v[40:43]
v_mfma_f32_16x16x32_bf16 v[44:47], v[108:111], v[220:223], v[44:47]
v_mfma_f32_16x16x32_bf16 v[48:51], v[112:115], v[220:223], v[48:51]
v_mfma_f32_16x16x32_bf16 v[52:55], v[116:119], v[220:223], v[52:55]
v_mfma_f32_16x16x32_bf16 v[56:59], v[100:103], v[224:227], v[56:59]
v_mfma_f32_16x16x32_bf16 v[60:63], v[104:107], v[224:227], v[60:63]
v_mfma_f32_16x16x32_bf16 v[64:67], v[108:111], v[224:227], v[64:67]
v_mfma_f32_16x16x32_bf16 v[68:71], v[112:115], v[224:227], v[68:71]
v_mfma_f32_16x16x32_bf16 v[72:75], v[116:119], v[224:227], v[72:75]
v_mfma_f32_16x16x32_bf16 v[76:79], v[100:103], v[228:231], v[76:79]
v_mfma_f32_16x16x32_bf16 v[80:83], v[104:107], v[228:231], v[80:83]
v_mfma_f32_16x16x32_bf16 v[84:87], v[108:111], v[228:231], v[84:87]
v_mfma_f32_16x16x32_bf16 v[88:91], v[112:115], v[228:231], v[88:91]
v_mfma_f32_16x16x32_bf16 v[92:95], v[116:119], v[228:231], v[92:95]
s_nop 7
s_add_u32 s35, s6, 1
s_and_b32 s35, s35, 3
s_mul_i32 s35, s35, 15360
s_add_u32 s35, s35, 0
v_add_u32 v233, s35, v2
ds_write_b128 v233, v[36:39] offset:0
ds_write_b128 v233, v[40:43] offset:1024
ds_write_b128 v233, v[44:47] offset:2048
ds_write_b128 v233, v[48:51] offset:3072
ds_write_b128 v233, v[52:55] offset:4096
s_add_u32 s35, s6, 2
s_and_b32 s35, s35, 3
s_mul_i32 s35, s35, 15360
s_add_u32 s35, s35, 5120
v_add_u32 v234, s35, v2
ds_write_b128 v234, v[56:59] offset:0
ds_write_b128 v234, v[60:63] offset:1024
ds_write_b128 v234, v[64:67] offset:2048
ds_write_b128 v234, v[68:71] offset:3072
ds_write_b128 v234, v[72:75] offset:4096
s_add_u32 s35, s6, 3
s_and_b32 s35, s35, 3
s_mul_i32 s35, s35, 15360
s_add_u32 s35, s35, 10240
v_add_u32 v235, s35, v2
ds_write_b128 v235, v[76:79] offset:0
ds_write_b128 v235, v[80:83] offset:1024
ds_write_b128 v235, v[84:87] offset:2048
ds_write_b128 v235, v[88:91] offset:3072
ds_write_b128 v235, v[92:95] offset:4096
s_waitcnt lgkmcnt(0)
s_barrier
s_mul_i32 s35, s6, 15360
v_add_u32 v232, s35, v2
ds_read_b128 v[120:123], v232 offset:0
ds_read_b128 v[124:127], v232 offset:1024
ds_read_b128 v[128:131], v232 offset:2048
ds_read_b128 v[132:135], v232 offset:3072
ds_read_b128 v[136:139], v232 offset:4096
ds_read_b128 v[140:143], v232 offset:5120
ds_read_b128 v[144:147], v232 offset:6144
ds_read_b128 v[148:151], v232 offset:7168
ds_read_b128 v[152:155], v232 offset:8192
ds_read_b128 v[156:159], v232 offset:9216
ds_read_b128 v[160:163], v232 offset:10240
ds_read_b128 v[164:167], v232 offset:11264
ds_read_b128 v[168:171], v232 offset:12288
ds_read_b128 v[172:175], v232 offset:13312
ds_read_b128 v[176:179], v232 offset:14336
s_waitcnt lgkmcnt(10)
v_pk_add_f32 v[16:17], v[16:17], v[120:121]
v_pk_add_f32 v[18:19], v[18:19], v[122:123]
v_pk_add_f32 v[20:21], v[20:21], v[124:125]
v_pk_add_f32 v[22:23], v[22:23], v[126:127]
v_pk_add_f32 v[24:25], v[24:25], v[128:129]
v_pk_add_f32 v[26:27], v[26:27], v[130:131]
v_pk_add_f32 v[28:29], v[28:29], v[132:133]
v_pk_add_f32 v[30:31], v[30:31], v[134:135]
v_pk_add_f32 v[32:33], v[32:33], v[136:137]
v_pk_add_f32 v[34:35], v[34:35], v[138:139]
s_waitcnt lgkmcnt(5)
v_pk_add_f32 v[16:17], v[16:17], v[140:141]
v_pk_add_f32 v[18:19], v[18:19], v[142:143]
v_pk_add_f32 v[20:21], v[20:21], v[144:145]
v_pk_add_f32 v[22:23], v[22:23], v[146:147]
v_pk_add_f32 v[24:25], v[24:25], v[148:149]
v_pk_add_f32 v[26:27], v[26:27], v[150:151]
v_pk_add_f32 v[28:29], v[28:29], v[152:153]
v_pk_add_f32 v[30:31], v[30:31], v[154:155]
v_pk_add_f32 v[32:33], v[32:33], v[156:157]
v_pk_add_f32 v[34:35], v[34:35], v[158:159]
s_waitcnt vmcnt(1) lgkmcnt(0)
v_pk_add_f32 v[16:17], v[16:17], v[160:161]
v_pk_add_f32 v[18:19], v[18:19], v[162:163]
v_pk_add_f32 v[20:21], v[20:21], v[164:165]
v_pk_add_f32 v[22:23], v[22:23], v[166:167]
v_pk_add_f32 v[24:25], v[24:25], v[168:169]
v_pk_add_f32 v[26:27], v[26:27], v[170:171]
v_pk_add_f32 v[28:29], v[28:29], v[172:173]
v_pk_add_f32 v[30:31], v[30:31], v[174:175]
v_pk_add_f32 v[32:33], v[32:33], v[176:177]
v_pk_add_f32 v[34:35], v[34:35], v[178:179]
v_lshlrev_b32 v120, 16, v240
v_and_b32 v121, 0xffff0000, v240
v_add_f32 v16, v16, v120
v_add_f32 v17, v17, v121
v_cvt_pk_bf16_f32 v240, v16, v17
v_lshlrev_b32 v120, 16, v241
v_and_b32 v121, 0xffff0000, v241
v_add_f32 v18, v18, v120
v_add_f32 v19, v19, v121
v_cvt_pk_bf16_f32 v241, v18, v19
v_lshlrev_b32 v120, 16, v242
v_and_b32 v121, 0xffff0000, v242
v_add_f32 v20, v20, v120
v_add_f32 v21, v21, v121
v_cvt_pk_bf16_f32 v242, v20, v21
v_lshlrev_b32 v120, 16, v243
v_and_b32 v121, 0xffff0000, v243
v_add_f32 v22, v22, v120
v_add_f32 v23, v23, v121
v_cvt_pk_bf16_f32 v243, v22, v23
v_lshlrev_b32 v120, 16, v244
v_and_b32 v121, 0xffff0000, v244
v_add_f32 v24, v24, v120
v_add_f32 v25, v25, v121
v_cvt_pk_bf16_f32 v244, v24, v25
v_lshlrev_b32 v120, 16, v245
v_and_b32 v121, 0xffff0000, v245
v_add_f32 v26, v26, v120
v_add_f32 v27, v27, v121
v_cvt_pk_bf16_f32 v245, v26, v27
v_lshlrev_b32 v120, 16, v246
v_and_b32 v121, 0xffff0000, v246
v_add_f32 v28, v28, v120
v_add_f32 v29, v29, v121
v_cvt_pk_bf16_f32 v246, v28, v29
v_lshlrev_b32 v120, 16, v247
v_and_b32 v121, 0xffff0000, v247
v_add_f32 v30, v30, v120
v_add_f32 v31, v31, v121
v_cvt_pk_bf16_f32 v247, v30, v31
v_lshlrev_b32 v120, 16, v248
v_and_b32 v121, 0xffff0000, v248
v_add_f32 v32, v32, v120
v_add_f32 v33, v33, v121
v_cvt_pk_bf16_f32 v248, v32, v33
v_lshlrev_b32 v120, 16, v249
v_and_b32 v121, 0xffff0000, v249
v_add_f32 v34, v34, v120
v_add_f32 v35, v35, v121
v_cvt_pk_bf16_f32 v249, v34, v35
s_add_u32 s43, s40, 23068672
s_add_u32 s44, s41, 23068672
buffer_store_dwordx4 v[240:243], v2, s[8:11], s43 offen sc1
buffer_store_dwordx4 v[244:247], v2, s[8:11], s43 offen offset:1024 sc1
buffer_store_dwordx2 v[248:249], v2, s[8:11], s44 offen sc1
v_mov_b32 v6, 0
v_mov_b32 v7, 0
v_dot2_f32_bf16 v6, v240, s62, v6
v_dot2_f32_bf16 v7, v240, v240, v7
v_dot2_f32_bf16 v6, v241, s62, v6
v_dot2_f32_bf16 v7, v241, v241, v7
v_dot2_f32_bf16 v6, v242, s62, v6
v_dot2_f32_bf16 v7, v242, v242, v7
v_dot2_f32_bf16 v6, v243, s62, v6
v_dot2_f32_bf16 v7, v243, v243, v7
v_dot2_f32_bf16 v6, v244, s62, v6
v_dot2_f32_bf16 v7, v244, v244, v7
v_dot2_f32_bf16 v6, v245, s62, v6
v_dot2_f32_bf16 v7, v245, v245, v7
v_dot2_f32_bf16 v6, v246, s62, v6
v_dot2_f32_bf16 v7, v246, v246, v7
v_dot2_f32_bf16 v6, v247, s62, v6
v_dot2_f32_bf16 v7, v247, v247, v7
v_dot2_f32_bf16 v6, v248, s62, v6
v_dot2_f32_bf16 v7, v248, v248, v7
v_dot2_f32_bf16 v6, v249, s62, v6
v_dot2_f32_bf16 v7, v249, v249, v7
s_nop 2
v_mov_b32 v8, v6
s_nop 1
v_permlane32_swap_b32 v6, v8
s_nop 1
v_add_f32 v6, v6, v8
v_mov_b32 v8, v6
s_nop 1
v_permlane16_swap_b32 v6, v8
s_nop 1
v_add_f32 v6, v6, v8
v_mov_b32 v8, v7
s_nop 1
v_permlane32_swap_b32 v7, v8
s_nop 1
v_add_f32 v7, v7, v8
v_mov_b32 v8, v7
s_nop 1
v_permlane16_swap_b32 v7, v8
s_nop 1
v_add_f32 v7, v7, v8
s_lshl_b32 s35, s36, 10
s_lshl_b32 s42, s30, 7
s_add_u32 s35, s35, s42
s_add_u32 s35, s35, 52690944
v_lshlrev_b32 v8, 3, v3
s_mov_b64 exec, 0xffff
buffer_store_dwordx2 v[6:7], v8, s[8:11], s35 offen sc1
s_mov_b64 exec, -1
s_mul_i32 s58, s6, 24576
s_add_u32 s58, s58, 65536
s_mul_i32 s59, s89, 163840
s_add_u32 s59, s59, s58
s_add_u32 s59, s59, 0
s_mov_b32 m0, s58
s_nop 0
buffer_load_dwordx4 v2, s[8:11], s59 offen offset:0 lds
buffer_load_dwordx4 v2, s[8:11], s59 offen offset:1024 lds
buffer_load_dwordx4 v2, s[8:11], s59 offen offset:2048 lds
buffer_load_dwordx4 v2, s[8:11], s59 offen offset:3072 lds
s_add_u32 s58, s58, 4096
s_add_u32 s59, s59, 4096
s_mov_b32 m0, s58
s_nop 0
buffer_load_dwordx4 v2, s[8:11], s59 offen offset:0 lds
buffer_load_dwordx4 v2, s[8:11], s59 offen offset:1024 lds
buffer_load_dwordx4 v2, s[8:11], s59 offen offset:2048 lds
buffer_load_dwordx4 v2, s[8:11], s59 offen offset:3072 lds
s_add_u32 s58, s58, 4096
s_add_u32 s59, s59, 4096
s_mov_b32 m0, s58
s_nop 0
buffer_load_dwordx4 v2, s[8:11], s59 offen offset:0 lds
buffer_load_dwordx4 v2, s[8:11], s59 offen offset:1024 lds
buffer_load_dwordx4 v2, s[8:11], s59 offen offset:2048 lds
buffer_load_dwordx4 v2, s[8:11], s59 offen offset:3072 lds
s_add_u32 s58, s58, 4096
s_add_u32 s59, s59, 4096
s_mov_b32 m0, s58
s_nop 0
buffer_load_dwordx4 v2, s[8:11], s59 offen offset:0 lds
buffer_load_dwordx4 v2, s[8:11], s59 offen offset:1024 lds
buffer_load_dwordx4 v2, s[8:11], s59 offen offset:2048 lds
buffer_load_dwordx4 v2, s[8:11], s59 offen offset:3072 lds
s_add_u32 s58, s58, 4096
s_add_u32 s59, s59, 4096
s_mov_b32 m0, s58
s_nop 0
buffer_load_dwordx4 v2, s[8:11], s59 offen offset:0 lds
buffer_load_dwordx4 v2, s[8:11], s59 offen offset:1024 lds
buffer_load_dwordx4 v2, s[8:11], s59 offen offset:2048 lds
buffer_load_dwordx4 v2, s[8:11], s59 offen offset:3072 lds
s_add_u32 s58, s58, 4096
s_add_u32 s59, s59, 4096
s_mov_b32 m0, s58
s_nop 0
buffer_load_dwordx4 v2, s[8:11], s59 offen offset:0 lds
buffer_load_dwordx4 v2, s[8:11], s59 offen offset:1024 lds
buffer_load_dwordx4 v2, s[8:11], s59 offen offset:2048 lds
buffer_load_dwordx4 v2, s[8:11], s59 offen offset:3072 lds
s_add_u32 s58, s58, 4096
s_add_u32 s59, s59, 4096
s_waitcnt vmcnt(24)
s_barrier
s_cmp_lg_u32 s6, 0
s_cbranch_scc1 L_ar_30
v_mov_b32 v8, 1
v_mov_b32 v9, s20
s_mov_b64 exec, 1
buffer_atomic_add v8, v9, s[8:11], 0 offen sc1
s_mov_b64 exec, -1
L_ar_30:
s_mov_b32 s4, s88
s_mov_b32 s5, s89
s_mov_b32 s20, s90
s_mul_i32 s30, s5, 163840
s_add_u32 s30, s30, 0
s_lshl_b32 s31, s2, 10
s_add_u32 s31, s31, 11010048
s_lshl_b32 s35, s6, 1
s_min_u32 s35, s35, 4
s_lshl_b32 s36, s6, 1
s_add_u32 s36, s36, 1
s_min_u32 s36, s36, 4
v_lshlrev_b32 v6, 4, v4
s_add_u32 s49, s31, 0
s_lshl_b32 s50, s35, 6
s_add_u32 s50, s50, s49
s_lshl_b32 s51, s36, 6
s_add_u32 s51, s51, s49
buffer_load_dwordx4 v[192:195], v6, s[8:11], s49 offen offset:0 sc1
buffer_load_dwordx4 v[196:199], v6, s[8:11], s49 offen offset:64 sc1
buffer_load_dwordx4 v[200:203], v6, s[8:11], s49 offen offset:128 sc1
buffer_load_dwordx4 v[204:207], v6, s[8:11], s49 offen offset:192 sc1
buffer_load_dwordx4 v[208:211], v6, s[8:11], s49 offen offset:256 sc1
buffer_load_dwordx4 v[212:215], v6, s[8:11], s49 offen offset:320 sc1
buffer_load_dwordx4 v[216:219], v6, s[8:11], s49 offen offset:384 sc1
buffer_load_dwordx4 v[220:223], v6, s[8:11], s49 offen offset:448 sc1
buffer_load_dwordx4 v[224:227], v6, s[8:11], s50 offen sc1
buffer_load_dwordx4 v[228:231], v6, s[8:11], s51 offen sc1
s_cmp_eq_u32 s6, 0
s_cbranch_scc1 L_dm_31
s_mov_b32 s24, 0
s_cmp_eq_u32 s6, 2
s_cselect_b32 s24, 24576, s24
s_cmp_eq_u32 s6, 3
s_cselect_b32 s24, 45056, s24
s_add_u32 s25, s30, s24
s_mov_b32 m0, s24
s_nop 0
buffer_load_dwordx4 v2, s[8:11], s25 offen offset:0 lds
buffer_load_dwordx4 v2, s[8:11], s25 offen offset:1024 lds
buffer_load_dwordx4 v2, s[8:11], s25 offen offset:2048 lds
buffer_load_dwordx4 v2, s[8:11], s25 offen offset:3072 lds
s_add_u32 s24, s24, 4096
s_add_u32 s25, s25, 4096
s_mov_b32 m0, s24
s_nop 0
buffer_load_dwordx4 v2, s[8:11], s25 offen offset:0 lds
buffer_load_dwordx4 v2, s[8:11], s25 offen offset:1024 lds
buffer_load_dwordx4 v2, s[8:11], s25 offen offset:2048 lds
buffer_load_dwordx4 v2, s[8:11], s25 offen offset:3072 lds
s_add_u32 s24, s24, 4096
s_add_u32 s25, s25, 4096
s_mov_b32 m0, s24
s_nop 0
buffer_load_dwordx4 v2, s[8:11], s25 offen offset:0 lds
buffer_load_dwordx4 v2, s[8:11], s25 offen offset:1024 lds
buffer_load_dwordx4 v2, s[8:11], s25 offen offset:2048 lds
buffer_load_dwordx4 v2, s[8:11], s25 offen offset:3072 lds
s_add_u32 s24, s24, 4096
s_add_u32 s25, s25, 4096
s_mov_b32 m0, s24
s_nop 0
buffer_load_dwordx4 v2, s[8:11], s25 offen offset:0 lds
buffer_load_dwordx4 v2, s[8:11], s25 offen offset:1024 lds
buffer_load_dwordx4 v2, s[8:11], s25 offen offset:2048 lds
buffer_load_dwordx4 v2, s[8:11], s25 offen offset:3072 lds
s_add_u32 s24, s24, 4096
s_add_u32 s25, s25, 4096
s_mov_b32 m0, s24
s_nop 0
buffer_load_dwordx4 v2, s[8:11], s25 offen offset:0 lds
buffer_load_dwordx4 v2, s[8:11], s25 offen offset:1024 lds
buffer_load_dwordx4 v2, s[8:11], s25 offen offset:2048 lds
buffer_load_dwordx4 v2, s[8:11], s25 offen offset:3072 lds
s_add_u32 s24, s24, 4096
s_add_u32 s25, s25, 4096
s_cmp_gt_u32 s6, 1
s_cbranch_scc1 L_dx_32
s_mov_b32 m0, s24
s_nop 0
buffer_load_dwordx4 v2, s[8:11], s25 offen offset:0 lds
buffer_load_dwordx4 v2, s[8:11], s25 offen offset:1024 lds
buffer_load_dwordx4 v2, s[8:11], s25 offen offset:2048 lds
buffer_load_dwordx4 v2, s[8:11], s25 offen offset:3072 lds
s_add_u32 s24, s24, 4096
s_add_u32 s25, s25, 4096
L_dx_32:
L_dm_31:
s_cmp_lg_u32 s6, 0
s_cbranch_scc1 L_pl_33
v_mov_b32 v9, s20
s_add_u32 s22, s20, 0xffffff00
s_cmp_eq_u32 s4, 0
s_cselect_b32 s22, s20, s22
v_mov_b32 v8, s22
v_cmp_eq_u32 vcc, 1, v1
s_nop 1
v_cndmask_b32 v9, v9, v8, vcc
s_mov_b64 exec, 3
s_mov_b32 s21, 64
s_mov_b32 s22, 0
L_lp_34:
buffer_load_dword v6, v9, s[8:11], 0 offen sc1
s_waitcnt vmcnt(0)
v_cmp_gt_u32 vcc, s21, v6
s_cbranch_vccz L_dn_35
s_add_u32 s22, s22, 1
s_cmp_lt_u32 s22, 40000
s_cbranch_scc1 L_lp_34
L_dn_35:
s_mov_b64 exec, -1
L_pl_33:
s_waitcnt vmcnt(0)
s_barrier
s_lshl_b32 s32, s4, 3
s_lshl_b32 s33, s6, 1
s_add_u32 s32, s32, s33
s_add_u32 s33, s32, 1
s_lshl_b32 s34, s4, 3
s_max_u32 s34, s34, 1
s_sub_u32 s34, s34, 1
s_mul_i32 s24, s32, 20480
v_add_u32 v10, s24, v2
s_mul_i32 s24, s33, 20480
v_add_u32 v11, s24, v2
s_mul_i32 s24, s34, 20480
v_add_u32 v12, s24, v2
s_mov_b32 s45, 23068672
buffer_load_dwordx4 a[0:3], v10, s[8:11], s45 offen offset:0 sc1
buffer_load_dwordx4 a[4:7], v11, s[8:11], s45 offen offset:0 sc1
buffer_load_dwordx4 a[8:11], v12, s[8:11], s45 offen offset:0 sc1
buffer_load_dwordx4 a[12:15], v10, s[8:11], s45 offen offset:1024 sc1
buffer_load_dwordx4 a[16:19], v11, s[8:11], s45 offen offset:1024 sc1
buffer_load_dwordx4 a[20:23], v12, s[8:11], s45 offen offset:1024 sc1
buffer_load_dwordx4 a[24:27], v10, s[8:11], s45 offen offset:2048 sc1
buffer_load_dwordx4 a[28:31], v11, s[8:11], s45 offen offset:2048 sc1
buffer_load_dwordx4 a[32:35], v12, s[8:11], s45 offen offset:2048 sc1
buffer_load_dwordx4 a[36:39], v10, s[8:11], s45 offen offset:3072 sc1
buffer_load_dwordx4 a[40:43], v11, s[8:11], s45 offen offset:3072 sc1
buffer_load_dwordx4 a[44:47], v12, s[8:11], s45 offen offset:3072 sc1
s_add_u32 s45, s45, 4096
buffer_load_dwordx4 a[48:51], v10, s[8:11], s45 offen offset:0 sc1
buffer_load_dwordx4 a[52:55], v11, s[8:11], s45 offen offset:0 sc1
buffer_load_dwordx4 a[56:59], v12, s[8:11], s45 offen offset:0 sc1
v_lshlrev_b32 v5, 8, v4
v_lshlrev_b32 v6, 3, v3
v_add_u32 v5, v5, v6
s_lshl_b32 s46, s32, 10
s_add_u32 s46, s46, 52690944
s_lshl_b32 s47, s33, 10
s_add_u32 s47, s47, 52690944
s_lshl_b32 s48, s34, 10
s_add_u32 s48, s48, 52690944
s_and_b32 s52, s88, 3
s_and_b32 s53, s89, 1
s_lshl_b32 s53, s53, 2
s_add_u32 s53, s53, s52
s_lshr_b32 s54, s89, 1
s_mul_i32 s56, s54, 102400
s_mul_i32 s60, s53, 12800
s_add_u32 s56, s56, s60
s_mul_i32 s60, s6, 3200
s_add_u32 s56, s56, s60
s_add_u32 s56, s56, 6291456
s_mul_i32 s57, s89, 143360
s_mul_i32 s60, s52, 35840
s_add_u32 s57, s57, s60
s_mul_i32 s60, s6, 8960
s_add_u32 s57, s57, s60
s_add_u32 s57, s57, 3145728
v_mov_b32 v13, v2
s_lshl_b32 s25, s35, 10
v_add_u32 v14, s25, v2
s_lshl_b32 s25, s36, 10
v_add_u32 v15, s25, v2
ds_read_b128 v[88:91], v13 offset:0
ds_read_b128 v[92:95], v13 offset:1024
ds_read_b128 v[96:99], v13 offset:2048
ds_read_b128 v[100:103], v13 offset:3072
ds_read_b128 v[104:107], v13 offset:4096
ds_read_b128 v[108:111], v13 offset:5120
ds_read_b128 v[112:115], v13 offset:6144
ds_read_b128 v[116:119], v13 offset:7168
ds_read_b128 v[120:123], v14 offset:0
ds_read_b128 v[124:127], v15 offset:0
s_waitcnt vmcnt(12) lgkmcnt(0)
v_mfma_f32_16x16x32_bf16 v[16:19], v[88:91], a[0:3], 0
ds_read_b128 v[128:131], v13 offset:8192
v_mfma_f32_16x16x32_bf16 v[48:51], v[88:91], a[4:7], 0
ds_read_b128 v[132:135], v13 offset:9216
buffer_load_dwordx4 a[60:63], v10, s[8:11], s45 offen offset:1024 sc1
v_mfma_f32_16x16x32_bf16 v[20:23], v[92:95], a[0:3], 0
ds_read_b128 v[136:139], v13 offset:10240
v_mfma_f32_16x16x32_bf16 v[52:55], v[92:95], a[4:7], 0
ds_read_b128 v[140:143], v13 offset:11264
v_mfma_f32_16x16x32_bf16 v[24:27], v[96:99], a[0:3], 0
ds_read_b128 v[144:147], v13 offset:12288
v_mfma_f32_16x16x32_bf16 v[56:59], v[96:99], a[4:7], 0
ds_read_b128 v[148:151], v13 offset:13312
v_mfma_f32_16x16x32_bf16 v[28:31], v[100:103], a[0:3], 0
ds_read_b128 v[152:155], v13 offset:14336
v_mfma_f32_16x16x32_bf16 v[60:63], v[100:103], a[4:7], 0
ds_read_b128 v[156:159], v13 offset:15360
buffer_load_dwordx4 a[64:67], v11, s[8:11], s45 offen offset:1024 sc1
v_mfma_f32_16x16x32_bf16 v[32:35], v[104:107], a[0:3], 0
ds_read_b128 v[160:163], v14 offset:8192
v_mfma_f32_16x16x32_bf16 v[64:67], v[104:107], a[4:7], 0
ds_read_b128 v[164:167], v15 offset:8192
v_mfma_f32_16x16x32_bf16 v[36:39], v[108:111], a[0:3], 0
v_mfma_f32_16x16x32_bf16 v[68:71], v[108:111], a[4:7], 0
v_mfma_f32_16x16x32_bf16 v[40:43], v[112:115], a[0:3], 0
v_mfma_f32_16x16x32_bf16 v[72:75], v[112:115], a[4:7], 0
buffer_load_dwordx4 a[68:71], v12, s[8:11], s45 offen offset:1024 sc1
v_mfma_f32_16x16x32_bf16 v[44:47], v[116:119], a[0:3], 0
v_mfma_f32_16x16x32_bf16 v[76:79], v[116:119], a[4:7], 0
v_mfma_f32_16x16x32_bf16 v[80:83], v[120:123], a[8:11], 0
v_mfma_f32_16x16x32_bf16 v[84:87], v[124:127], a[8:11], 0
s_waitcnt vmcnt(12) lgkmcnt(0)
v_mfma_f32_16x16x32_bf16 v[16:19], v[128:131], a[12:15], v[16:19]
ds_read_b128 v[88:91], v13 offset:16384
v_mfma_f32_16x16x32_bf16 v[48:51], v[128:131], a[16:19], v[48:51]
ds_read_b128 v[92:95], v13 offset:17408
buffer_load_dwordx4 a[72:75], v10, s[8:11], s45 offen offset:2048 sc1
v_mfma_f32_16x16x32_bf16 v[20:23], v[132:135], a[12:15], v[20:23]
ds_read_b128 v[96:99], v13 offset:18432
v_mfma_f32_16x16x32_bf16 v[52:55], v[132:135], a[16:19], v[52:55]
ds_read_b128 v[100:103], v13 offset:19456
v_mfma_f32_16x16x32_bf16 v[24:27], v[136:139], a[12:15], v[24:27]
ds_read_b128 v[104:107], v13 offset:20480
buffer_load_dwordx4 a[76:79], v11, s[8:11], s45 offen offset:2048 sc1
v_mfma_f32_16x16x32_bf16 v[56:59], v[136:139], a[16:19], v[56:59]
ds_read_b128 v[108:111], v13 offset:21504
v_mfma_f32_16x16x32_bf16 v[28:31], v[140:143], a[12:15], v[28:31]
ds_read_b128 v[112:115], v13 offset:22528
v_mfma_f32_16x16x32_bf16 v[60:63], v[140:143], a[16:19], v[60:63]
ds_read_b128 v[116:119], v13 offset:23552
v_mfma_f32_16x16x32_bf16 v[32:35], v[144:147], a[12:15], v[32:35]
ds_read_b128 v[120:123], v14 offset:16384
buffer_load_dwordx4 a[80:83], v12, s[8:11], s45 offen offset:2048 sc1
v_mfma_f32_16x16x32_bf16 v[64:67], v[144:147], a[16:19], v[64:67]
ds_read_b128 v[124:127], v15 offset:16384
v_mfma_f32_16x16x32_bf16 v[36:39], v[148:151], a[12:15], v[36:39]
v_mfma_f32_16x16x32_bf16 v[68:71], v[148:151], a[16:19], v[68:71]
buffer_load_dwordx2 v[168:169], v5, s[8:11], s46 offen sc1
v_mfma_f32_16x16x32_bf16 v[40:43], v[152:155], a[12:15], v[40:43]
v_mfma_f32_16x16x32_bf16 v[72:75], v[152:155], a[16:19], v[72:75]
v_mfma_f32_16x16x32_bf16 v[44:47], v[156:159], a[12:15], v[44:47]
v_mfma_f32_16x16x32_bf16 v[76:79], v[156:159], a[16:19], v[76:79]
buffer_load_dwordx2 v[170:171], v5, s[8:11], s46 offen offset:128 sc1
v_mfma_f32_16x16x32_bf16 v[80:83], v[160:163], a[20:23], v[80:83]
v_mfma_f32_16x16x32_bf16 v[84:87], v[164:167], a[20:23], v[84:87]
s_waitcnt vmcnt(14) lgkmcnt(0)
v_mfma_f32_16x16x32_bf16 v[16:19], v[88:91], a[24:27], v[16:19]
ds_read_b128 v[128:131], v13 offset:24576
v_mfma_f32_16x16x32_bf16 v[48:51], v[88:91], a[28:31], v[48:51]
ds_read_b128 v[132:135], v13 offset:25600
buffer_load_dwordx4 a[84:87], v10, s[8:11], s45 offen offset:3072 sc1
v_mfma_f32_16x16x32_bf16 v[20:23], v[92:95], a[24:27], v[20:23]
ds_read_b128 v[136:139], v13 offset:26624
v_mfma_f32_16x16x32_bf16 v[52:55], v[92:95], a[28:31], v[52:55]
ds_read_b128 v[140:143], v13 offset:27648
v_mfma_f32_16x16x32_bf16 v[24:27], v[96:99], a[24:27], v[24:27]
ds_read_b128 v[144:147], v13 offset:28672
buffer_load_dwordx4 a[88:91], v11, s[8:11], s45 offen offset:3072 sc1
v_mfma_f32_16x16x32_bf16 v[56:59], v[96:99], a[28:31], v[56:59]
ds_read_b128 v[148:151], v13 offset:29696
v_mfma_f32_16x16x32_bf16 v[28:31], v[100:103], a[24:27], v[28:31]
ds_read_b128 v[152:155], v13 offset:30720
v_mfma_f32_16x16x32_bf16 v[60:63], v[100:103], a[28:31], v[60:63]
ds_read_b128 v[156:159], v13 offset:31744
v_mfma_f32_16x16x32_bf16 v[32:35], v[104:107], a[24:27], v[32:35]
ds_read_b128 v[160:163], v14 offset:24576
buffer_load_dwordx4 a[92:95], v12, s[8:11], s45 offen offset:3072 sc1
v_mfma_f32_16x16x32_bf16 v[64:67], v[104:107], a[28:31], v[64:67]
ds_read_b128 v[164:167], v15 offset:24576
v_mfma_f32_16x16x32_bf16 v[36:39], v[108:111], a[24:27], v[36:39]
s_lshl_b32 s24, s6, 5
s_add_u32 s24, s24, 16
v_mfma_f32_16x16x32_bf16 v[68:71], v[108:111], a[28:31], v[68:71]
buffer_load_dwordx2 v[172:173], v5, s[8:11], s47 offen sc1
v_add_u32 v245, s24, v3
v_mul_u32_u24 v7, 48, v245
v_mfma_f32_16x16x32_bf16 v[40:43], v[112:115], a[24:27], v[40:43]
v_mul_u32_u24 v8, 80, v245
v_add_u32 v8, 27648, v8
v_mfma_f32_16x16x32_bf16 v[72:75], v[112:115], a[28:31], v[72:75]
v_add_u32 v245, 0, v4
v_mul_u32_u24 v246, 13, v245
v_mfma_f32_16x16x32_bf16 v[44:47], v[116:119], a[24:27], v[44:47]
v_lshrrev_b32 v246, 6, v246
v_mul_u32_u24 v247, 5, v246
v_mfma_f32_16x16x32_bf16 v[76:79], v[116:119], a[28:31], v[76:79]
buffer_load_dwordx2 v[174:175], v5, s[8:11], s47 offen offset:128 sc1
v_sub_u32 v247, v245, v247
v_add_u32 v248, -2, v246
v_mfma_f32_16x16x32_bf16 v[80:83], v[120:123], a[32:35], v[80:83]
v_cmp_le_u32 vcc, 4, v246
s_nop 1
v_mfma_f32_16x16x32_bf16 v[84:87], v[124:127], a[32:35], v[84:87]
v_cndmask_b32 v249, v246, v248, vcc
v_mul_u32_u24 v249, 6912, v249
s_waitcnt vmcnt(16) lgkmcnt(0)
v_mfma_f32_16x16x32_bf16 v[16:19], v[128:131], a[36:39], v[16:19]
ds_read_b128 v[88:91], v13 offset:32768
v_mfma_f32_16x16x32_bf16 v[48:51], v[128:131], a[40:43], v[48:51]
ds_read_b128 v[92:95], v13 offset:33792
s_add_u32 s45, s45, 4096
buffer_load_dwordx4 a[96:99], v10, s[8:11], s45 offen offset:0 sc1
v_mfma_f32_16x16x32_bf16 v[20:23], v[132:135], a[36:39], v[20:23]
ds_read_b128 v[96:99], v13 offset:34816
v_mfma_f32_16x16x32_bf16 v[52:55], v[132:135], a[40:43], v[52:55]
ds_read_b128 v[100:103], v13 offset:35840
v_mfma_f32_16x16x32_bf16 v[24:27], v[136:139], a[36:39], v[24:27]
ds_read_b128 v[104:107], v13 offset:36864
buffer_load_dwordx4 a[100:103], v11, s[8:11], s45 offen offset:0 sc1
v_mfma_f32_16x16x32_bf16 v[56:59], v[136:139], a[40:43], v[56:59]
ds_read_b128 v[108:111], v13 offset:37888
v_mfma_f32_16x16x32_bf16 v[28:31], v[140:143], a[36:39], v[28:31]
ds_read_b128 v[112:115], v13 offset:38912
v_mfma_f32_16x16x32_bf16 v[60:63], v[140:143], a[40:43], v[60:63]
ds_read_b128 v[116:119], v13 offset:39936
v_mfma_f32_16x16x32_bf16 v[32:35], v[144:147], a[36:39], v[32:35]
ds_read_b128 v[120:123], v14 offset:32768
buffer_load_dwordx4 a[104:107], v12, s[8:11], s45 offen offset:0 sc1
v_mfma_f32_16x16x32_bf16 v[64:67], v[144:147], a[40:43], v[64:67]
ds_read_b128 v[124:127], v15 offset:32768
v_mfma_f32_16x16x32_bf16 v[36:39], v[148:151], a[36:39], v[36:39]
v_lshl_add_u32 v232, v247, 3, v249
v_add_u32 v232, v232, v7
v_mfma_f32_16x16x32_bf16 v[68:71], v[148:151], a[40:43], v[68:71]
buffer_load_dwordx2 v[176:177], v5, s[8:11], s48 offen sc1
v_add_u32 v245, 4, v4
v_mul_u32_u24 v246, 13, v245
v_mfma_f32_16x16x32_bf16 v[40:43], v[152:155], a[36:39], v[40:43]
v_lshrrev_b32 v246, 6, v246
v_mul_u32_u24 v247, 5, v246
v_mfma_f32_16x16x32_bf16 v[72:75], v[152:155], a[40:43], v[72:75]
v_sub_u32 v247, v245, v247
v_add_u32 v248, -2, v246
v_mfma_f32_16x16x32_bf16 v[44:47], v[156:159], a[36:39], v[44:47]
v_cmp_le_u32 vcc, 4, v246
s_nop 1
v_mfma_f32_16x16x32_bf16 v[76:79], v[156:159], a[40:43], v[76:79]
buffer_load_dwordx2 v[178:179], v5, s[8:11], s48 offen offset:128 sc1
v_cndmask_b32 v249, v246, v248, vcc
v_mul_u32_u24 v249, 6912, v249
v_mfma_f32_16x16x32_bf16 v[80:83], v[160:163], a[44:47], v[80:83]
v_lshl_add_u32 v233, v247, 3, v249
v_add_u32 v233, v233, v7
v_mfma_f32_16x16x32_bf16 v[84:87], v[164:167], a[44:47], v[84:87]
v_add_u32 v245, 8, v4
v_mul_u32_u24 v246, 13, v245
s_waitcnt vmcnt(18) lgkmcnt(0)
v_mfma_f32_16x16x32_bf16 v[16:19], v[88:91], a[48:51], v[16:19]
ds_read_b128 v[128:131], v13 offset:40960
v_mfma_f32_16x16x32_bf16 v[48:51], v[88:91], a[52:55], v[48:51]
ds_read_b128 v[132:135], v13 offset:41984
buffer_load_dwordx4 a[108:111], v10, s[8:11], s45 offen offset:1024 sc1
v_mfma_f32_16x16x32_bf16 v[20:23], v[92:95], a[48:51], v[20:23]
ds_read_b128 v[136:139], v13 offset:43008
v_mfma_f32_16x16x32_bf16 v[52:55], v[92:95], a[52:55], v[52:55]
ds_read_b128 v[140:143], v13 offset:44032
v_mfma_f32_16x16x32_bf16 v[24:27], v[96:99], a[48:51], v[24:27]
ds_read_b128 v[144:147], v13 offset:45056
v_mfma_f32_16x16x32_bf16 v[56:59], v[96:99], a[52:55], v[56:59]
ds_read_b128 v[148:151], v13 offset:46080
v_mfma_f32_16x16x32_bf16 v[28:31], v[100:103], a[48:51], v[28:31]
ds_read_b128 v[152:155], v13 offset:47104
v_mfma_f32_16x16x32_bf16 v[60:63], v[100:103], a[52:55], v[60:63]
ds_read_b128 v[156:159], v13 offset:48128
buffer_load_dwordx4 a[112:115], v11, s[8:11], s45 offen offset:1024 sc1
v_mfma_f32_16x16x32_bf16 v[32:35], v[104:107], a[48:51], v[32:35]
ds_read_b128 v[160:163], v14 offset:40960
v_mfma_f32_16x16x32_bf16 v[64:67], v[104:107], a[52:55], v[64:67]
ds_read_b128 v[164:167], v15 offset:40960
v_mfma_f32_16x16x32_bf16 v[36:39], v[108:111], a[48:51], v[36:39]
v_lshrrev_b32 v246, 6, v246
v_mul_u32_u24 v247, 5, v246
v_mfma_f32_16x16x32_bf16 v[68:71], v[108:111], a[52:55], v[68:71]
v_sub_u32 v247, v245, v247
v_add_u32 v248, -2, v246
v_mfma_f32_16x16x32_bf16 v[40:43], v[112:115], a[48:51], v[40:43]
v_cmp_le_u32 vcc, 4, v246
s_nop 1
v_mfma_f32_16x16x32_bf16 v[72:75], v[112:115], a[52:55], v[72:75]
buffer_load_dwordx4 a[116:119], v12, s[8:11], s45 offen offset:1024 sc1
v_cndmask_b32 v249, v246, v248, vcc
v_mul_u32_u24 v249, 6912, v249
v_mfma_f32_16x16x32_bf16 v[44:47], v[116:119], a[48:51], v[44:47]
v_lshl_add_u32 v234, v247, 3, v249
v_add_u32 v234, v234, v7
v_mfma_f32_16x16x32_bf16 v[76:79], v[116:119], a[52:55], v[76:79]
v_and_b32 v248, 1, v246
v_mul_u32_u24 v248, 11520, v248
v_mfma_f32_16x16x32_bf16 v[80:83], v[120:123], a[56:59], v[80:83]
v_lshl_add_u32 v238, v247, 4, v248
v_add_u32 v238, v238, v8
v_mfma_f32_16x16x32_bf16 v[84:87], v[124:127], a[56:59], v[84:87]
v_add_u32 v245, 12, v4
v_mul_u32_u24 v246, 13, v245
s_waitcnt vmcnt(18) lgkmcnt(0)
v_mfma_f32_16x16x32_bf16 v[16:19], v[128:131], a[60:63], v[16:19]
ds_read_b128 v[88:91], v13 offset:49152
v_mfma_f32_16x16x32_bf16 v[48:51], v[128:131], a[64:67], v[48:51]
ds_read_b128 v[92:95], v13 offset:50176
buffer_load_dwordx4 a[120:123], v10, s[8:11], s45 offen offset:2048 sc1
v_mfma_f32_16x16x32_bf16 v[20:23], v[132:135], a[60:63], v[20:23]
ds_read_b128 v[96:99], v13 offset:51200
v_mfma_f32_16x16x32_bf16 v[52:55], v[132:135], a[64:67], v[52:55]
ds_read_b128 v[100:103], v13 offset:52224
v_mfma_f32_16x16x32_bf16 v[24:27], v[136:139], a[60:63], v[24:27]
ds_read_b128 v[104:107], v13 offset:53248
v_mfma_f32_16x16x32_bf16 v[56:59], v[136:139], a[64:67], v[56:59]
ds_read_b128 v[108:111], v13 offset:54272
v_mfma_f32_16x16x32_bf16 v[28:31], v[140:143], a[60:63], v[28:31]
ds_read_b128 v[112:115], v13 offset:55296
v_mfma_f32_16x16x32_bf16 v[60:63], v[140:143], a[64:67], v[60:63]
ds_read_b128 v[116:119], v13 offset:56320
buffer_load_dwordx4 a[124:127], v11, s[8:11], s45 offen offset:2048 sc1
v_mfma_f32_16x16x32_bf16 v[32:35], v[144:147], a[60:63], v[32:35]
ds_read_b128 v[120:123], v14 offset:49152
v_mfma_f32_16x16x32_bf16 v[64:67], v[144:147], a[64:67], v[64:67]
ds_read_b128 v[124:127], v15 offset:49152
v_mfma_f32_16x16x32_bf16 v[36:39], v[148:151], a[60:63], v[36:39]
v_lshrrev_b32 v246, 6, v246
v_mul_u32_u24 v247, 5, v246
v_mfma_f32_16x16x32_bf16 v[68:71], v[148:151], a[64:67], v[68:71]
v_sub_u32 v247, v245, v247
v_and_b32 v248, 1, v246
v_mfma_f32_16x16x32_bf16 v[40:43], v[152:155], a[60:63], v[40:43]
v_mul_u32_u24 v248, 11520, v248
v_lshl_add_u32 v239, v247, 4, v248
v_mfma_f32_16x16x32_bf16 v[72:75], v[152:155], a[64:67], v[72:75]
buffer_load_dwordx4 a[128:131], v12, s[8:11], s45 offen offset:2048 sc1
v_add_u32 v239, v239, v8
v_add_u32 v245, 16, v4
v_mfma_f32_16x16x32_bf16 v[44:47], v[156:159], a[60:63], v[44:47]
v_mul_u32_u24 v246, 13, v245
v_lshrrev_b32 v246, 6, v246
v_mfma_f32_16x16x32_bf16 v[76:79], v[156:159], a[64:67], v[76:79]
v_mul_u32_u24 v247, 5, v246
v_sub_u32 v247, v245, v247
v_mfma_f32_16x16x32_bf16 v[80:83], v[160:163], a[68:71], v[80:83]
v_and_b32 v248, 1, v246
v_mul_u32_u24 v248, 11520, v248
v_mfma_f32_16x16x32_bf16 v[84:87], v[164:167], a[68:71], v[84:87]
v_lshl_add_u32 v240, v247, 4, v248
v_add_u32 v240, v240, v8
s_waitcnt vmcnt(18) lgkmcnt(0)
v_mfma_f32_16x16x32_bf16 v[16:19], v[88:91], a[72:75], v[16:19]
ds_read_b128 v[128:131], v13 offset:57344
v_mfma_f32_16x16x32_bf16 v[48:51], v[88:91], a[76:79], v[48:51]
ds_read_b128 v[132:135], v13 offset:58368
buffer_load_dwordx4 a[132:135], v10, s[8:11], s45 offen offset:3072 sc1
v_mfma_f32_16x16x32_bf16 v[20:23], v[92:95], a[72:75], v[20:23]
ds_read_b128 v[136:139], v13 offset:59392
v_mfma_f32_16x16x32_bf16 v[52:55], v[92:95], a[76:79], v[52:55]
ds_read_b128 v[140:143], v13 offset:60416
v_mfma_f32_16x16x32_bf16 v[24:27], v[96:99], a[72:75], v[24:27]
ds_read_b128 v[144:147], v13 offset:61440
v_mfma_f32_16x16x32_bf16 v[56:59], v[96:99], a[76:79], v[56:59]
ds_read_b128 v[148:151], v13 offset:62464
v_mfma_f32_16x16x32_bf16 v[28:31], v[100:103], a[72:75], v[28:31]
ds_read_b128 v[152:155], v13 offset:63488
v_mfma_f32_16x16x32_bf16 v[60:63], v[100:103], a[76:79], v[60:63]
ds_read_b128 v[156:159], v13 offset:64512
buffer_load_dwordx4 a[136:139], v11, s[8:11], s45 offen offset:3072 sc1
v_mfma_f32_16x16x32_bf16 v[32:35], v[104:107], a[72:75], v[32:35]
ds_read_b128 v[160:163], v14 offset:57344
v_mfma_f32_16x16x32_bf16 v[64:67], v[104:107], a[76:79], v[64:67]
ds_read_b128 v[164:167], v15 offset:57344
v_mfma_f32_16x16x32_bf16 v[36:39], v[108:111], a[72:75], v[36:39]
v_add_u32 v245, 20, v4
v_mul_u32_u24 v246, 13, v245
v_mfma_f32_16x16x32_bf16 v[68:71], v[108:111], a[76:79], v[68:71]
v_lshrrev_b32 v246, 6, v246
v_mul_u32_u24 v247, 5, v246
v_mfma_f32_16x16x32_bf16 v[40:43], v[112:115], a[72:75], v[40:43]
v_sub_u32 v247, v245, v247
v_add_u32 v248, -2, v246
v_mfma_f32_16x16x32_bf16 v[72:75], v[112:115], a[76:79], v[72:75]
buffer_load_dwordx4 a[140:143], v12, s[8:11], s45 offen offset:3072 sc1
v_cmp_le_u32 vcc, 4, v246
s_nop 1
v_mfma_f32_16x16x32_bf16 v[44:47], v[116:119], a[72:75], v[44:47]
v_cndmask_b32 v249, v246, v248, vcc
v_mul_u32_u24 v249, 6912, v249
v_mfma_f32_16x16x32_bf16 v[76:79], v[116:119], a[76:79], v[76:79]
v_lshl_add_u32 v235, v247, 3, v249
v_add_u32 v235, v235, v7
v_mfma_f32_16x16x32_bf16 v[80:83], v[120:123], a[80:83], v[80:83]
v_add_u32 v245, 24, v4
v_mul_u32_u24 v246, 13, v245
v_mfma_f32_16x16x32_bf16 v[84:87], v[124:127], a[80:83], v[84:87]
v_lshrrev_b32 v246, 6, v246
v_mul_u32_u24 v247, 5, v246
s_waitcnt vmcnt(16) lgkmcnt(0)
v_add_u32 v13, 65536, v13
v_add_u32 v14, 65536, v14
v_add_u32 v15, 65536, v15
v_mfma_f32_16x16x32_bf16 v[16:19], v[128:131], a[84:87], v[16:19]
ds_read_b128 v[88:91], v13 offset:0
v_mfma_f32_16x16x32_bf16 v[48:51], v[128:131], a[88:91], v[48:51]
ds_read_b128 v[92:95], v13 offset:1024
s_add_u32 s45, s45, 4096
buffer_load_dwordx4 a[144:147], v10, s[8:11], s45 offen offset:0 sc1
v_mfma_f32_16x16x32_bf16 v[20:23], v[132:135], a[84:87], v[20:23]
ds_read_b128 v[96:99], v13 offset:2048
v_mfma_f32_16x16x32_bf16 v[52:55], v[132:135], a[88:91], v[52:55]
ds_read_b128 v[100:103], v13 offset:3072
v_mfma_f32_16x16x32_bf16 v[24:27], v[136:139], a[84:87], v[24:27]
ds_read_b128 v[104:107], v13 offset:4096
v_mfma_f32_16x16x32_bf16 v[56:59], v[136:139], a[88:91], v[56:59]
ds_read_b128 v[108:111], v13 offset:5120
v_mfma_f32_16x16x32_bf16 v[28:31], v[140:143], a[84:87], v[28:31]
ds_read_b128 v[112:115], v13 offset:6144
v_mfma_f32_16x16x32_bf16 v[60:63], v[140:143], a[88:91], v[60:63]
ds_read_b128 v[116:119], v13 offset:7168
buffer_load_dwordx4 a[148:151], v11, s[8:11], s45 offen offset:0 sc1
v_mfma_f32_16x16x32_bf16 v[32:35], v[144:147], a[84:87], v[32:35]
ds_read_b128 v[120:123], v14 offset:0
v_mfma_f32_16x16x32_bf16 v[64:67], v[144:147], a[88:91], v[64:67]
ds_read_b128 v[124:127], v15 offset:0
v_mfma_f32_16x16x32_bf16 v[36:39], v[148:151], a[84:87], v[36:39]
v_sub_u32 v247, v245, v247
v_add_u32 v248, -2, v246
v_mfma_f32_16x16x32_bf16 v[68:71], v[148:151], a[88:91], v[68:71]
v_cmp_le_u32 vcc, 4, v246
s_nop 1
v_mfma_f32_16x16x32_bf16 v[40:43], v[152:155], a[84:87], v[40:43]
v_cndmask_b32 v249, v246, v248, vcc
v_mul_u32_u24 v249, 6912, v249
v_mfma_f32_16x16x32_bf16 v[72:75], v[152:155], a[88:91], v[72:75]
buffer_load_dwordx4 a[152:155], v12, s[8:11], s45 offen offset:0 sc1
v_lshl_add_u32 v236, v247, 3, v249
v_add_u32 v236, v236, v7
v_mfma_f32_16x16x32_bf16 v[44:47], v[156:159], a[84:87], v[44:47]
v_add_u32 v245, 28, v4
v_mul_u32_u24 v246, 13, v245
v_mfma_f32_16x16x32_bf16 v[76:79], v[156:159], a[88:91], v[76:79]
v_lshrrev_b32 v246, 6, v246
v_mul_u32_u24 v247, 5, v246
v_mfma_f32_16x16x32_bf16 v[80:83], v[160:163], a[92:95], v[80:83]
v_sub_u32 v247, v245, v247
v_add_u32 v248, -2, v246
v_mfma_f32_16x16x32_bf16 v[84:87], v[164:167], a[92:95], v[84:87]
v_cmp_le_u32 vcc, 4, v246
s_nop 1
s_waitcnt vmcnt(14) lgkmcnt(0)
v_mfma_f32_16x16x32_bf16 v[16:19], v[88:91], a[96:99], v[16:19]
ds_read_b128 v[128:131], v13 offset:8192
v_mfma_f32_16x16x32_bf16 v[48:51], v[88:91], a[100:103], v[48:51]
ds_read_b128 v[132:135], v13 offset:9216
buffer_load_dwordx4 a[156:159], v10, s[8:11], s45 offen offset:1024 sc1
v_mfma_f32_16x16x32_bf16 v[20:23], v[92:95], a[96:99], v[20:23]
ds_read_b128 v[136:139], v13 offset:10240
v_mfma_f32_16x16x32_bf16 v[52:55], v[92:95], a[100:103], v[52:55]
ds_read_b128 v[140:143], v13 offset:11264
v_mfma_f32_16x16x32_bf16 v[24:27], v[96:99], a[96:99], v[24:27]
ds_read_b128 v[144:147], v13 offset:12288
v_mfma_f32_16x16x32_bf16 v[56:59], v[96:99], a[100:103], v[56:59]
ds_read_b128 v[148:151], v13 offset:13312
v_mfma_f32_16x16x32_bf16 v[28:31], v[100:103], a[96:99], v[28:31]
ds_read_b128 v[152:155], v13 offset:14336
v_mfma_f32_16x16x32_bf16 v[60:63], v[100:103], a[100:103], v[60:63]
ds_read_b128 v[156:159], v13 offset:15360
buffer_load_dwordx4 a[160:163], v11, s[8:11], s45 offen offset:1024 sc1
v_mfma_f32_16x16x32_bf16 v[32:35], v[104:107], a[96:99], v[32:35]
ds_read_b128 v[160:163], v14 offset:8192
v_mfma_f32_16x16x32_bf16 v[64:67], v[104:107], a[100:103], v[64:67]
ds_read_b128 v[164:167], v15 offset:8192
v_mfma_f32_16x16x32_bf16 v[36:39], v[108:111], a[96:99], v[36:39]
v_cndmask_b32 v249, v246, v248, vcc
v_mul_u32_u24 v249, 6912, v249
v_mfma_f32_16x16x32_bf16 v[68:71], v[108:111], a[100:103], v[68:71]
v_lshl_add_u32 v237, v247, 3, v249
v_add_u32 v237, v237, v7
v_mfma_f32_16x16x32_bf16 v[40:43], v[112:115], a[96:99], v[40:43]
v_mul_u32_u24 v7, 48, v3
v_mul_u32_u24 v8, 80, v3
v_mfma_f32_16x16x32_bf16 v[72:75], v[112:115], a[100:103], v[72:75]
buffer_load_dwordx4 a[164:167], v12, s[8:11], s45 offen offset:1024 sc1
v_add_u32 v8, 27648, v8
s_lshl_b32 s24, s35, 2
v_mfma_f32_16x16x32_bf16 v[44:47], v[116:119], a[96:99], v[44:47]
v_add_u32 v245, s24, v4
v_mul_u32_u24 v246, 13, v245
v_mfma_f32_16x16x32_bf16 v[76:79], v[116:119], a[100:103], v[76:79]
v_lshrrev_b32 v246, 6, v246
v_mul_u32_u24 v247, 5, v246
v_mfma_f32_16x16x32_bf16 v[80:83], v[120:123], a[104:107], v[80:83]
v_sub_u32 v247, v245, v247
v_add_u32 v248, -2, v246
v_mfma_f32_16x16x32_bf16 v[84:87], v[124:127], a[104:107], v[84:87]
v_cmp_le_u32 vcc, 4, v246
s_nop 1
s_waitcnt vmcnt(12) lgkmcnt(0)
v_mfma_f32_16x16x32_bf16 v[16:19], v[128:131], a[108:111], v[16:19]
ds_read_b128 v[88:91], v13 offset:16384
v_mfma_f32_16x16x32_bf16 v[48:51], v[128:131], a[112:115], v[48:51]
ds_read_b128 v[92:95], v13 offset:17408
buffer_load_dwordx4 a[168:171], v10, s[8:11], s45 offen offset:2048 sc1
v_mfma_f32_16x16x32_bf16 v[20:23], v[132:135], a[108:111], v[20:23]
ds_read_b128 v[96:99], v13 offset:18432
v_mfma_f32_16x16x32_bf16 v[52:55], v[132:135], a[112:115], v[52:55]
ds_read_b128 v[100:103], v13 offset:19456
v_mfma_f32_16x16x32_bf16 v[24:27], v[136:139], a[108:111], v[24:27]
ds_read_b128 v[104:107], v13 offset:20480
v_mfma_f32_16x16x32_bf16 v[56:59], v[136:139], a[112:115], v[56:59]
ds_read_b128 v[108:111], v13 offset:21504
v_mfma_f32_16x16x32_bf16 v[28:31], v[140:143], a[108:111], v[28:31]
ds_read_b128 v[112:115], v13 offset:22528
v_mfma_f32_16x16x32_bf16 v[60:63], v[140:143], a[112:115], v[60:63]
ds_read_b128 v[116:119], v13 offset:23552
buffer_load_dwordx4 a[172:175], v11, s[8:11], s45 offen offset:2048 sc1
v_mfma_f32_16x16x32_bf16 v[32:35], v[144:147], a[108:111], v[32:35]
ds_read_b128 v[120:123], v14 offset:16384
v_mfma_f32_16x16x32_bf16 v[64:67], v[144:147], a[112:115], v[64:67]
ds_read_b128 v[124:127], v15 offset:16384
v_mfma_f32_16x16x32_bf16 v[36:39], v[148:151], a[108:111], v[36:39]
v_cndmask_b32 v249, v246, v248, vcc
v_mul_u32_u24 v249, 6912, v249
v_mfma_f32_16x16x32_bf16 v[68:71], v[148:151], a[112:115], v[68:71]
v_lshl_add_u32 v241, v247, 3, v249
v_add_u32 v241, v241, v7
v_mfma_f32_16x16x32_bf16 v[40:43], v[152:155], a[108:111], v[40:43]
v_and_b32 v248, 1, v246
v_mul_u32_u24 v248, 11520, v248
v_mfma_f32_16x16x32_bf16 v[72:75], v[152:155], a[112:115], v[72:75]
buffer_load_dwordx4 a[176:179], v12, s[8:11], s45 offen offset:2048 sc1
v_lshl_add_u32 v243, v247, 4, v248
v_add_u32 v243, v243, v8
v_mfma_f32_16x16x32_bf16 v[44:47], v[156:159], a[108:111], v[44:47]
v_cmp_gt_u32 s[38:39], 10, v245
s_lshl_b32 s24, s36, 2
v_mfma_f32_16x16x32_bf16 v[76:79], v[156:159], a[112:115], v[76:79]
v_add_u32 v245, s24, v4
v_mul_u32_u24 v246, 13, v245
v_mfma_f32_16x16x32_bf16 v[80:83], v[160:163], a[116:119], v[80:83]
v_lshrrev_b32 v246, 6, v246
v_mul_u32_u24 v247, 5, v246
v_mfma_f32_16x16x32_bf16 v[84:87], v[164:167], a[116:119], v[84:87]
v_sub_u32 v247, v245, v247
v_add_u32 v248, -2, v246
s_waitcnt vmcnt(12) lgkmcnt(0)
v_mfma_f32_16x16x32_bf16 v[16:19], v[88:91], a[120:123], v[16:19]
ds_read_b128 v[128:131], v13 offset:24576
v_mfma_f32_16x16x32_bf16 v[48:51], v[88:91], a[124:127], v[48:51]
ds_read_b128 v[132:135], v13 offset:25600
buffer_load_dwordx4 a[180:183], v10, s[8:11], s45 offen offset:3072 sc1
v_mfma_f32_16x16x32_bf16 v[20:23], v[92:95], a[120:123], v[20:23]
ds_read_b128 v[136:139], v13 offset:26624
v_mfma_f32_16x16x32_bf16 v[52:55], v[92:95], a[124:127], v[52:55]
ds_read_b128 v[140:143], v13 offset:27648
v_mfma_f32_16x16x32_bf16 v[24:27], v[96:99], a[120:123], v[24:27]
ds_read_b128 v[144:147], v13 offset:28672
v_mfma_f32_16x16x32_bf16 v[56:59], v[96:99], a[124:127], v[56:59]
ds_read_b128 v[148:151], v13 offset:29696
v_mfma_f32_16x16x32_bf16 v[28:31], v[100:103], a[120:123], v[28:31]
ds_read_b128 v[152:155], v13 offset:30720
v_mfma_f32_16x16x32_bf16 v[60:63], v[100:103], a[124:127], v[60:63]
ds_read_b128 v[156:159], v13 offset:31744
buffer_load_dwordx4 a[184:187], v11, s[8:11], s45 offen offset:3072 sc1
v_mfma_f32_16x16x32_bf16 v[32:35], v[104:107], a[120:123], v[32:35]
ds_read_b128 v[160:163], v14 offset:24576
v_mfma_f32_16x16x32_bf16 v[64:67], v[104:107], a[124:127], v[64:67]
ds_read_b128 v[164:167], v15 offset:24576
v_mfma_f32_16x16x32_bf16 v[36:39], v[108:111], a[120:123], v[36:39]
v_cmp_le_u32 vcc, 4, v246
s_nop 1
v_mfma_f32_16x16x32_bf16 v[68:71], v[108:111], a[124:127], v[68:71]
v_cndmask_b32 v249, v246, v248, vcc
v_mul_u32_u24 v249, 6912, v249
v_mfma_f32_16x16x32_bf16 v[40:43], v[112:115], a[120:123], v[40:43]
v_lshl_add_u32 v242, v247, 3, v249
v_add_u32 v242, v242, v7
v_mfma_f32_16x16x32_bf16 v[72:75], v[112:115], a[124:127], v[72:75]
buffer_load_dwordx4 a[188:191], v12, s[8:11], s45 offen offset:3072 sc1
v_and_b32 v248, 1, v246
v_mul_u32_u24 v248, 11520, v248
v_mfma_f32_16x16x32_bf16 v[44:47], v[116:119], a[120:123], v[44:47]
v_lshl_add_u32 v244, v247, 4, v248
v_add_u32 v244, v244, v8
v_mfma_f32_16x16x32_bf16 v[76:79], v[116:119], a[124:127], v[76:79]
v_cmp_gt_u32 s[40:41], 10, v245
v_mfma_f32_16x16x32_bf16 v[80:83], v[120:123], a[128:131], v[80:83]
v_add_f32 v168, v168, v170
v_add_f32 v169, v169, v171
v_mfma_f32_16x16x32_bf16 v[84:87], v[124:127], a[128:131], v[84:87]
v_mov_b32 v9, v168
s_nop 1
s_waitcnt vmcnt(12) lgkmcnt(0)
v_mfma_f32_16x16x32_bf16 v[16:19], v[128:131], a[132:135], v[16:19]
ds_read_b128 v[88:91], v13 offset:32768
v_mfma_f32_16x16x32_bf16 v[48:51], v[128:131], a[136:139], v[48:51]
ds_read_b128 v[92:95], v13 offset:33792
s_add_u32 s45, s45, 4096
buffer_load_dwordx4 a[192:195], v10, s[8:11], s45 offen offset:0 sc1
v_mfma_f32_16x16x32_bf16 v[20:23], v[132:135], a[132:135], v[20:23]
ds_read_b128 v[96:99], v13 offset:34816
v_mfma_f32_16x16x32_bf16 v[52:55], v[132:135], a[136:139], v[52:55]
ds_read_b128 v[100:103], v13 offset:35840
v_mfma_f32_16x16x32_bf16 v[24:27], v[136:139], a[132:135], v[24:27]
ds_read_b128 v[104:107], v13 offset:36864
v_mfma_f32_16x16x32_bf16 v[56:59], v[136:139], a[136:139], v[56:59]
ds_read_b128 v[108:111], v13 offset:37888
v_mfma_f32_16x16x32_bf16 v[28:31], v[140:143], a[132:135], v[28:31]
ds_read_b128 v[112:115], v13 offset:38912
v_mfma_f32_16x16x32_bf16 v[60:63], v[140:143], a[136:139], v[60:63]
ds_read_b128 v[116:119], v13 offset:39936
buffer_load_dwordx4 a[196:199], v11, s[8:11], s45 offen offset:0 sc1
v_mfma_f32_16x16x32_bf16 v[32:35], v[144:147], a[132:135], v[32:35]
ds_read_b128 v[120:123], v14 offset:32768
v_mfma_f32_16x16x32_bf16 v[64:67], v[144:147], a[136:139], v[64:67]
ds_read_b128 v[124:127], v15 offset:32768
v_mfma_f32_16x16x32_bf16 v[36:39], v[148:151], a[132:135], v[36:39]
v_permlane32_swap_b32 v168, v9
s_nop 1
v_mfma_f32_16x16x32_bf16 v[68:71], v[148:151], a[136:139], v[68:71]
v_add_f32 v168, v168, v9
v_mov_b32 v9, v168
v_mfma_f32_16x16x32_bf16 v[40:43], v[152:155], a[132:135], v[40:43]
s_nop 1
v_permlane16_swap_b32 v168, v9
v_mfma_f32_16x16x32_bf16 v[72:75], v[152:155], a[136:139], v[72:75]
buffer_load_dwordx4 a[200:203], v12, s[8:11], s45 offen offset:0 sc1
s_nop 1
v_add_f32 v168, v168, v9
v_mfma_f32_16x16x32_bf16 v[44:47], v[156:159], a[132:135], v[44:47]
v_mov_b32 v9, v169
s_nop 1
v_mfma_f32_16x16x32_bf16 v[76:79], v[156:159], a[136:139], v[76:79]
v_permlane32_swap_b32 v169, v9
s_nop 1
v_mfma_f32_16x16x32_bf16 v[80:83], v[160:163], a[140:143], v[80:83]
v_add_f32 v169, v169, v9
v_mov_b32 v9, v169
v_mfma_f32_16x16x32_bf16 v[84:87], v[164:167], a[140:143], v[84:87]
s_nop 1
v_permlane16_swap_b32 v169, v9
s_waitcnt vmcnt(12) lgkmcnt(0)
v_mfma_f32_16x16x32_bf16 v[16:19], v[88:91], a[144:147], v[16:19]
ds_read_b128 v[128:131], v13 offset:40960
v_mfma_f32_16x16x32_bf16 v[48:51], v[88:91], a[148:151], v[48:51]
ds_read_b128 v[132:135], v13 offset:41984
buffer_load_dwordx4 a[204:207], v10, s[8:11], s45 offen offset:1024 sc1
v_mfma_f32_16x16x32_bf16 v[20:23], v[92:95], a[144:147], v[20:23]
ds_read_b128 v[136:139], v13 offset:43008
v_mfma_f32_16x16x32_bf16 v[52:55], v[92:95], a[148:151], v[52:55]
ds_read_b128 v[140:143], v13 offset:44032
v_mfma_f32_16x16x32_bf16 v[24:27], v[96:99], a[144:147], v[24:27]
ds_read_b128 v[144:147], v13 offset:45056
v_mfma_f32_16x16x32_bf16 v[56:59], v[96:99], a[148:151], v[56:59]
ds_read_b128 v[148:151], v13 offset:46080
v_mfma_f32_16x16x32_bf16 v[28:31], v[100:103], a[144:147], v[28:31]
ds_read_b128 v[152:155], v13 offset:47104
v_mfma_f32_16x16x32_bf16 v[60:63], v[100:103], a[148:151], v[60:63]
ds_read_b128 v[156:159], v13 offset:48128
buffer_load_dwordx4 a[208:211], v11, s[8:11], s45 offen offset:1024 sc1
v_mfma_f32_16x16x32_bf16 v[32:35], v[104:107], a[144:147], v[32:35]
ds_read_b128 v[160:163], v14 offset:40960
v_mfma_f32_16x16x32_bf16 v[64:67], v[104:107], a[148:151], v[64:67]
ds_read_b128 v[164:167], v15 offset:40960
v_mfma_f32_16x16x32_bf16 v[36:39], v[108:111], a[144:147], v[36:39]
s_nop 1
v_add_f32 v169, v169, v9
v_mfma_f32_16x16x32_bf16 v[68:71], v[108:111], a[148:151], v[68:71]
v_mul_f32 v168, 0x3acccccd, v168
v_mul_f32 v169, 0x3acccccd, v169
v_mfma_f32_16x16x32_bf16 v[40:43], v[112:115], a[144:147], v[40:43]
v_fma_f32 v169, -v168, v168, v169
v_max_f32 v169, 0, v169
v_mfma_f32_16x16x32_bf16 v[72:75], v[112:115], a[148:151], v[72:75]
buffer_load_dwordx4 a[212:215], v12, s[8:11], s45 offen offset:1024 sc1
v_add_f32 v169, 0x3727c5ac, v169
v_rsq_f32 v180, v169
v_mfma_f32_16x16x32_bf16 v[44:47], v[116:119], a[144:147], v[44:47]
s_nop 1
v_mul_f32 v186, v168, v180
v_mfma_f32_16x16x32_bf16 v[76:79], v[116:119], a[148:151], v[76:79]
v_sub_f32 v186, 0, v186
v_add_f32 v172, v172, v174
v_mfma_f32_16x16x32_bf16 v[80:83], v[120:123], a[152:155], v[80:83]
v_add_f32 v173, v173, v175
v_mov_b32 v9, v172
v_mfma_f32_16x16x32_bf16 v[84:87], v[124:127], a[152:155], v[84:87]
s_nop 1
v_permlane32_swap_b32 v172, v9
s_waitcnt vmcnt(12) lgkmcnt(0)
v_mfma_f32_16x16x32_bf16 v[16:19], v[128:131], a[156:159], v[16:19]
ds_read_b128 v[88:91], v13 offset:49152
v_mfma_f32_16x16x32_bf16 v[48:51], v[128:131], a[160:163], v[48:51]
ds_read_b128 v[92:95], v13 offset:50176
buffer_load_dwordx4 a[216:219], v10, s[8:11], s45 offen offset:2048 sc1
v_mfma_f32_16x16x32_bf16 v[20:23], v[132:135], a[156:159], v[20:23]
ds_read_b128 v[96:99], v13 offset:51200
v_mfma_f32_16x16x32_bf16 v[52:55], v[132:135], a[160:163], v[52:55]
ds_read_b128 v[100:103], v13 offset:52224
v_mfma_f32_16x16x32_bf16 v[24:27], v[136:139], a[156:159], v[24:27]
ds_read_b128 v[104:107], v13 offset:53248
v_mfma_f32_16x16x32_bf16 v[56:59], v[136:139], a[160:163], v[56:59]
ds_read_b128 v[108:111], v13 offset:54272
v_mfma_f32_16x16x32_bf16 v[28:31], v[140:143], a[156:159], v[28:31]
ds_read_b128 v[112:115], v13 offset:55296
v_mfma_f32_16x16x32_bf16 v[60:63], v[140:143], a[160:163], v[60:63]
ds_read_b128 v[116:119], v13 offset:56320
buffer_load_dwordx4 a[220:223], v11, s[8:11], s45 offen offset:2048 sc1
v_mfma_f32_16x16x32_bf16 v[32:35], v[144:147], a[156:159], v[32:35]
ds_read_b128 v[120:123], v14 offset:49152
v_mfma_f32_16x16x32_bf16 v[64:67], v[144:147], a[160:163], v[64:67]
ds_read_b128 v[124:127], v15 offset:49152
v_mfma_f32_16x16x32_bf16 v[36:39], v[148:151], a[156:159], v[36:39]
s_nop 1
v_add_f32 v172, v172, v9
v_mfma_f32_16x16x32_bf16 v[68:71], v[148:151], a[160:163], v[68:71]
v_mov_b32 v9, v172
s_nop 1
v_mfma_f32_16x16x32_bf16 v[40:43], v[152:155], a[156:159], v[40:43]
v_permlane16_swap_b32 v172, v9
s_nop 1
v_mfma_f32_16x16x32_bf16 v[72:75], v[152:155], a[160:163], v[72:75]
buffer_load_dwordx4 a[224:227], v12, s[8:11], s45 offen offset:2048 sc1
v_add_f32 v172, v172, v9
v_mov_b32 v9, v173
v_mfma_f32_16x16x32_bf16 v[44:47], v[156:159], a[156:159], v[44:47]
s_nop 1
v_permlane32_swap_b32 v173, v9
v_mfma_f32_16x16x32_bf16 v[76:79], v[156:159], a[160:163], v[76:79]
s_nop 1
v_add_f32 v173, v173, v9
v_mfma_f32_16x16x32_bf16 v[80:83], v[160:163], a[164:167], v[80:83]
v_mov_b32 v9, v173
s_nop 1
v_mfma_f32_16x16x32_bf16 v[84:87], v[164:167], a[164:167], v[84:87]
v_permlane16_swap_b32 v173, v9
s_nop 1
s_waitcnt vmcnt(12) lgkmcnt(0)
v_mfma_f32_16x16x32_bf16 v[16:19], v[88:91], a[168:171], v[16:19]
ds_read_b128 v[128:131], v13 offset:57344
v_mfma_f32_16x16x32_bf16 v[48:51], v[88:91], a[172:175], v[48:51]
ds_read_b128 v[132:135], v13 offset:58368
buffer_load_dwordx4 a[228:231], v10, s[8:11], s45 offen offset:3072 sc1
v_mfma_f32_16x16x32_bf16 v[20:23], v[92:95], a[168:171], v[20:23]
ds_read_b128 v[136:139], v13 offset:59392
v_mfma_f32_16x16x32_bf16 v[52:55], v[92:95], a[172:175], v[52:55]
ds_read_b128 v[140:143], v13 offset:60416
v_mfma_f32_16x16x32_bf16 v[24:27], v[96:99], a[168:171], v[24:27]
ds_read_b128 v[144:147], v13 offset:61440
v_mfma_f32_16x16x32_bf16 v[56:59], v[96:99], a[172:175], v[56:59]
ds_read_b128 v[148:151], v13 offset:62464
v_mfma_f32_16x16x32_bf16 v[28:31], v[100:103], a[168:171], v[28:31]
ds_read_b128 v[152:155], v13 offset:63488
v_mfma_f32_16x16x32_bf16 v[60:63], v[100:103], a[172:175], v[60:63]
ds_read_b128 v[156:159], v13 offset:64512
buffer_load_dwordx4 a[232:235], v11, s[8:11], s45 offen offset:3072 sc1
v_mfma_f32_16x16x32_bf16 v[32:35], v[104:107], a[168:171], v[32:35]
ds_read_b128 v[160:163], v14 offset:57344
v_mfma_f32_16x16x32_bf16 v[64:67], v[104:107], a[172:175], v[64:67]
ds_read_b128 v[164:167], v15 offset:57344
v_mfma_f32_16x16x32_bf16 v[36:39], v[108:111], a[168:171], v[36:39]
v_add_f32 v173, v173, v9
v_mul_f32 v172, 0x3acccccd, v172
v_mfma_f32_16x16x32_bf16 v[68:71], v[108:111], a[172:175], v[68:71]
v_mul_f32 v173, 0x3acccccd, v173
v_fma_f32 v173, -v172, v172, v173
v_mfma_f32_16x16x32_bf16 v[40:43], v[112:115], a[168:171], v[40:43]
v_max_f32 v173, 0, v173
v_add_f32 v173, 0x3727c5ac, v173
v_mfma_f32_16x16x32_bf16 v[72:75], v[112:115], a[172:175], v[72:75]
buffer_load_dwordx4 a[236:239], v12, s[8:11], s45 offen offset:3072 sc1
v_rsq_f32 v182, v173
s_nop 1
v_mfma_f32_16x16x32_bf16 v[44:47], v[116:119], a[168:171], v[44:47]
v_mul_f32 v188, v172, v182
v_sub_f32 v188, 0, v188
v_mfma_f32_16x16x32_bf16 v[76:79], v[116:119], a[172:175], v[76:79]
v_add_f32 v176, v176, v178
v_add_f32 v177, v177, v179
v_mfma_f32_16x16x32_bf16 v[80:83], v[120:123], a[176:179], v[80:83]
v_mov_b32 v9, v176
s_nop 1
v_mfma_f32_16x16x32_bf16 v[84:87], v[124:127], a[176:179], v[84:87]
v_permlane32_swap_b32 v176, v9
s_nop 1
s_waitcnt vmcnt(12) lgkmcnt(0)
v_add_u32 v13, 65536, v13
v_add_u32 v14, 65536, v14
v_add_u32 v15, 65536, v15
v_mfma_f32_16x16x32_bf16 v[16:19], v[128:131], a[180:183], v[16:19]
ds_read_b128 v[88:91], v13 offset:0
v_mfma_f32_16x16x32_bf16 v[48:51], v[128:131], a[184:187], v[48:51]
ds_read_b128 v[92:95], v13 offset:1024
buffer_load_dword v254, v253, s[8:11], s56 offen
v_mfma_f32_16x16x32_bf16 v[20:23], v[132:135], a[180:183], v[20:23]
ds_read_b128 v[96:99], v13 offset:2048
v_mfma_f32_16x16x32_bf16 v[52:55], v[132:135], a[184:187], v[52:55]
ds_read_b128 v[100:103], v13 offset:3072
v_mfma_f32_16x16x32_bf16 v[24:27], v[136:139], a[180:183], v[24:27]
ds_read_b128 v[104:107], v13 offset:4096
v_mfma_f32_16x16x32_bf16 v[56:59], v[136:139], a[184:187], v[56:59]
ds_read_b128 v[108:111], v13 offset:5120
v_mfma_f32_16x16x32_bf16 v[28:31], v[140:143], a[180:183], v[28:31]
ds_read_b128 v[112:115], v13 offset:6144
v_mfma_f32_16x16x32_bf16 v[60:63], v[140:143], a[184:187], v[60:63]
ds_read_b128 v[116:119], v13 offset:7168
v_mfma_f32_16x16x32_bf16 v[32:35], v[144:147], a[180:183], v[32:35]
ds_read_b128 v[120:123], v14 offset:0
v_mfma_f32_16x16x32_bf16 v[64:67], v[144:147], a[184:187], v[64:67]
ds_read_b128 v[124:127], v15 offset:0
v_mfma_f32_16x16x32_bf16 v[36:39], v[148:151], a[180:183], v[36:39]
v_add_f32 v176, v176, v9
v_mov_b32 v9, v176
v_mfma_f32_16x16x32_bf16 v[68:71], v[148:151], a[184:187], v[68:71]
s_nop 1
v_permlane16_swap_b32 v176, v9
v_mfma_f32_16x16x32_bf16 v[40:43], v[152:155], a[180:183], v[40:43]
s_nop 1
v_add_f32 v176, v176, v9
v_mfma_f32_16x16x32_bf16 v[72:75], v[152:155], a[184:187], v[72:75]
v_mov_b32 v9, v177
s_nop 1
v_mfma_f32_16x16x32_bf16 v[44:47], v[156:159], a[180:183], v[44:47]
v_permlane32_swap_b32 v177, v9
s_nop 1
v_mfma_f32_16x16x32_bf16 v[76:79], v[156:159], a[184:187], v[76:79]
v_add_f32 v177, v177, v9
v_mov_b32 v9, v177
v_mfma_f32_16x16x32_bf16 v[80:83], v[160:163], a[188:191], v[80:83]
s_nop 1
v_permlane16_swap_b32 v177, v9
v_mfma_f32_16x16x32_bf16 v[84:87], v[164:167], a[188:191], v[84:87]
s_nop 1
v_add_f32 v177, v177, v9
s_waitcnt vmcnt(10) lgkmcnt(0)
v_mfma_f32_16x16x32_bf16 v[16:19], v[88:91], a[192:195], v[16:19]
ds_read_b128 v[128:131], v13 offset:8192
v_mfma_f32_16x16x32_bf16 v[48:51], v[88:91], a[196:199], v[48:51]
ds_read_b128 v[132:135], v13 offset:9216
v_mfma_f32_16x16x32_bf16 v[20:23], v[92:95], a[192:195], v[20:23]
ds_read_b128 v[136:139], v13 offset:10240
v_mfma_f32_16x16x32_bf16 v[52:55], v[92:95], a[196:199], v[52:55]
ds_read_b128 v[140:143], v13 offset:11264
v_mfma_f32_16x16x32_bf16 v[24:27], v[96:99], a[192:195], v[24:27]
ds_read_b128 v[144:147], v13 offset:12288
v_mfma_f32_16x16x32_bf16 v[56:59], v[96:99], a[196:199], v[56:59]
ds_read_b128 v[148:151], v13 offset:13312
v_mfma_f32_16x16x32_bf16 v[28:31], v[100:103], a[192:195], v[28:31]
ds_read_b128 v[152:155], v13 offset:14336
v_mfma_f32_16x16x32_bf16 v[60:63], v[100:103], a[196:199], v[60:63]
ds_read_b128 v[156:159], v13 offset:15360
v_mfma_f32_16x16x32_bf16 v[32:35], v[104:107], a[192:195], v[32:35]
ds_read_b128 v[160:163], v14 offset:8192
v_mfma_f32_16x16x32_bf16 v[64:67], v[104:107], a[196:199], v[64:67]
ds_read_b128 v[164:167], v15 offset:8192
v_mfma_f32_16x16x32_bf16 v[36:39], v[108:111], a[192:195], v[36:39]
v_mul_f32 v176, 0x3acccccd, v176
v_mul_f32 v177, 0x3acccccd, v177
v_mfma_f32_16x16x32_bf16 v[68:71], v[108:111], a[196:199], v[68:71]
v_fma_f32 v177, -v176, v176, v177
v_max_f32 v177, 0, v177
v_mfma_f32_16x16x32_bf16 v[40:43], v[112:115], a[192:195], v[40:43]
v_add_f32 v177, 0x3727c5ac, v177
v_rsq_f32 v184, v177
v_mfma_f32_16x16x32_bf16 v[72:75], v[112:115], a[196:199], v[72:75]
s_nop 1
v_mul_f32 v190, v176, v184
v_mfma_f32_16x16x32_bf16 v[44:47], v[116:119], a[192:195], v[44:47]
v_sub_f32 v190, 0, v190
v_mfma_f32_16x16x32_bf16 v[76:79], v[116:119], a[196:199], v[76:79]
v_mfma_f32_16x16x32_bf16 v[80:83], v[120:123], a[200:203], v[80:83]
v_mfma_f32_16x16x32_bf16 v[84:87], v[124:127], a[200:203], v[84:87]
s_waitcnt vmcnt(7) lgkmcnt(0)
v_mfma_f32_16x16x32_bf16 v[16:19], v[128:131], a[204:207], v[16:19]
ds_read_b128 v[88:91], v13 offset:16384
v_mfma_f32_16x16x32_bf16 v[48:51], v[128:131], a[208:211], v[48:51]
ds_read_b128 v[92:95], v13 offset:17408
buffer_load_dword v254, v253, s[8:11], s57 offen
v_mfma_f32_16x16x32_bf16 v[20:23], v[132:135], a[204:207], v[20:23]
ds_read_b128 v[96:99], v13 offset:18432
v_mfma_f32_16x16x32_bf16 v[52:55], v[132:135], a[208:211], v[52:55]
ds_read_b128 v[100:103], v13 offset:19456
v_mfma_f32_16x16x32_bf16 v[24:27], v[136:139], a[204:207], v[24:27]
ds_read_b128 v[104:107], v13 offset:20480
v_mfma_f32_16x16x32_bf16 v[56:59], v[136:139], a[208:211], v[56:59]
ds_read_b128 v[108:111], v13 offset:21504
v_mfma_f32_16x16x32_bf16 v[28:31], v[140:143], a[204:207], v[28:31]
ds_read_b128 v[112:115], v13 offset:22528
v_mfma_f32_16x16x32_bf16 v[60:63], v[140:143], a[208:211], v[60:63]
ds_read_b128 v[116:119], v13 offset:23552
v_mfma_f32_16x16x32_bf16 v[32:35], v[144:147], a[204:207], v[32:35]
ds_read_b128 v[120:123], v14 offset:16384
v_mfma_f32_16x16x32_bf16 v[64:67], v[144:147], a[208:211], v[64:67]
ds_read_b128 v[124:127], v15 offset:16384
v_mfma_f32_16x16x32_bf16 v[36:39], v[148:151], a[204:207], v[36:39]
v_mfma_f32_16x16x32_bf16 v[68:71], v[148:151], a[208:211], v[68:71]
v_mfma_f32_16x16x32_bf16 v[40:43], v[152:155], a[204:207], v[40:43]
v_mfma_f32_16x16x32_bf16 v[72:75], v[152:155], a[208:211], v[72:75]
v_mfma_f32_16x16x32_bf16 v[44:47], v[156:159], a[204:207], v[44:47]
v_mfma_f32_16x16x32_bf16 v[76:79], v[156:159], a[208:211], v[76:79]
v_mfma_f32_16x16x32_bf16 v[80:83], v[160:163], a[212:215], v[80:83]
v_mfma_f32_16x16x32_bf16 v[84:87], v[164:167], a[212:215], v[84:87]
s_waitcnt vmcnt(5) lgkmcnt(0)
v_mfma_f32_16x16x32_bf16 v[16:19], v[88:91], a[216:219], v[16:19]
ds_read_b128 v[128:131], v13 offset:24576
v_mfma_f32_16x16x32_bf16 v[48:51], v[88:91], a[220:223], v[48:51]
ds_read_b128 v[132:135], v13 offset:25600
v_mfma_f32_16x16x32_bf16 v[20:23], v[92:95], a[216:219], v[20:23]
ds_read_b128 v[136:139], v13 offset:26624
v_mfma_f32_16x16x32_bf16 v[52:55], v[92:95], a[220:223], v[52:55]
ds_read_b128 v[140:143], v13 offset:27648
v_mfma_f32_16x16x32_bf16 v[24:27], v[96:99], a[216:219], v[24:27]
ds_read_b128 v[144:147], v13 offset:28672
v_mfma_f32_16x16x32_bf16 v[56:59], v[96:99], a[220:223], v[56:59]
ds_read_b128 v[148:151], v13 offset:29696
v_mfma_f32_16x16x32_bf16 v[28:31], v[100:103], a[216:219], v[28:31]
ds_read_b128 v[152:155], v13 offset:30720
v_mfma_f32_16x16x32_bf16 v[60:63], v[100:103], a[220:223], v[60:63]
ds_read_b128 v[156:159], v13 offset:31744
v_mfma_f32_16x16x32_bf16 v[32:35], v[104:107], a[216:219], v[32:35]
ds_read_b128 v[160:163], v14 offset:24576
v_mfma_f32_16x16x32_bf16 v[64:67], v[104:107], a[220:223], v[64:67]
ds_read_b128 v[164:167], v15 offset:24576
v_mfma_f32_16x16x32_bf16 v[36:39], v[108:111], a[216:219], v[36:39]
v_mfma_f32_16x16x32_bf16 v[68:71], v[108:111], a[220:223], v[68:71]
v_mfma_f32_16x16x32_bf16 v[40:43], v[112:115], a[216:219], v[40:43]
v_mfma_f32_16x16x32_bf16 v[72:75], v[112:115], a[220:223], v[72:75]
v_mfma_f32_16x16x32_bf16 v[44:47], v[116:119], a[216:219], v[44:47]
v_mfma_f32_16x16x32_bf16 v[76:79], v[116:119], a[220:223], v[76:79]
v_mfma_f32_16x16x32_bf16 v[80:83], v[120:123], a[224:227], v[80:83]
v_mfma_f32_16x16x32_bf16 v[84:87], v[124:127], a[224:227], v[84:87]
s_waitcnt vmcnt(2) lgkmcnt(0)
v_mfma_f32_16x16x32_bf16 v[16:19], v[128:131], a[228:231], v[16:19]
v_mfma_f32_16x16x32_bf16 v[48:51], v[128:131], a[232:235], v[48:51]
v_mfma_f32_16x16x32_bf16 v[20:23], v[132:135], a[228:231], v[20:23]
v_mfma_f32_16x16x32_bf16 v[52:55], v[132:135], a[232:235], v[52:55]
v_mfma_f32_16x16x32_bf16 v[24:27], v[136:139], a[228:231], v[24:27]
v_mfma_f32_16x16x32_bf16 v[56:59], v[136:139], a[232:235], v[56:59]
v_mfma_f32_16x16x32_bf16 v[28:31], v[140:143], a[228:231], v[28:31]
v_mfma_f32_16x16x32_bf16 v[60:63], v[140:143], a[232:235], v[60:63]
v_mfma_f32_16x16x32_bf16 v[32:35], v[144:147], a[228:231], v[32:35]
v_mfma_f32_16x16x32_bf16 v[64:67], v[144:147], a[232:235], v[64:67]
v_mfma_f32_16x16x32_bf16 v[36:39], v[148:151], a[228:231], v[36:39]
v_mfma_f32_16x16x32_bf16 v[68:71], v[148:151], a[232:235], v[68:71]
v_mfma_f32_16x16x32_bf16 v[40:43], v[152:155], a[228:231], v[40:43]
v_mfma_f32_16x16x32_bf16 v[72:75], v[152:155], a[232:235], v[72:75]
v_mfma_f32_16x16x32_bf16 v[44:47], v[156:159], a[228:231], v[44:47]
v_mfma_f32_16x16x32_bf16 v[76:79], v[156:159], a[232:235], v[76:79]
v_mfma_f32_16x16x32_bf16 v[80:83], v[160:163], a[236:239], v[80:83]
v_mfma_f32_16x16x32_bf16 v[84:87], v[164:167], a[236:239], v[84:87]
s_waitcnt vmcnt(2)
s_and_b32 s52, s88, 3
s_and_b32 s53, s89, 1
s_lshl_b32 s53, s53, 2
s_add_u32 s53, s53, s52
s_lshr_b32 s54, s89, 1
s_nop 7
v_pk_mul_f32 v[16:17], v[16:17], v[180:181] op_sel_hi:[1,0]
v_pk_mul_f32 v[18:19], v[18:19], v[180:181] op_sel_hi:[1,0]
v_pk_fma_f32 v[16:17], v[192:193], v[186:187], v[16:17] op_sel_hi:[1,0,1]
v_pk_fma_f32 v[18:19], v[194:195], v[186:187], v[18:19] op_sel_hi:[1,0,1]
v_pk_mul_f32 v[20:21], v[20:21], v[180:181] op_sel_hi:[1,0]
v_pk_mul_f32 v[22:23], v[22:23], v[180:181] op_sel_hi:[1,0]
v_pk_fma_f32 v[20:21], v[196:197], v[186:187], v[20:21] op_sel_hi:[1,0,1]
v_pk_fma_f32 v[22:23], v[198:199], v[186:187], v[22:23] op_sel_hi:[1,0,1]
v_pk_mul_f32 v[24:25], v[24:25], v[180:181] op_sel_hi:[1,0]
v_pk_mul_f32 v[26:27], v[26:27], v[180:181] op_sel_hi:[1,0]
v_pk_fma_f32 v[24:25], v[200:201], v[186:187], v[24:25] op_sel_hi:[1,0,1]
v_pk_fma_f32 v[26:27], v[202:203], v[186:187], v[26:27] op_sel_hi:[1,0,1]
v_pk_mul_f32 v[28:29], v[28:29], v[180:181] op_sel_hi:[1,0]
v_pk_mul_f32 v[30:31], v[30:31], v[180:181] op_sel_hi:[1,0]
v_pk_fma_f32 v[28:29], v[204:205], v[186:187], v[28:29] op_sel_hi:[1,0,1]
v_pk_fma_f32 v[30:31], v[206:207], v[186:187], v[30:31] op_sel_hi:[1,0,1]
v_pk_mul_f32 v[32:33], v[32:33], v[180:181] op_sel_hi:[1,0]
v_pk_mul_f32 v[34:35], v[34:35], v[180:181] op_sel_hi:[1,0]
v_pk_fma_f32 v[32:33], v[208:209], v[186:187], v[32:33] op_sel_hi:[1,0,1]
v_pk_fma_f32 v[34:35], v[210:211], v[186:187], v[34:35] op_sel_hi:[1,0,1]
v_pk_mul_f32 v[36:37], v[36:37], v[180:181] op_sel_hi:[1,0]
v_pk_mul_f32 v[38:39], v[38:39], v[180:181] op_sel_hi:[1,0]
v_pk_fma_f32 v[36:37], v[212:213], v[186:187], v[36:37] op_sel_hi:[1,0,1]
v_pk_fma_f32 v[38:39], v[214:215], v[186:187], v[38:39] op_sel_hi:[1,0,1]
v_pk_mul_f32 v[40:41], v[40:41], v[180:181] op_sel_hi:[1,0]
v_pk_mul_f32 v[42:43], v[42:43], v[180:181] op_sel_hi:[1,0]
v_pk_fma_f32 v[40:41], v[216:217], v[186:187], v[40:41] op_sel_hi:[1,0,1]
v_pk_fma_f32 v[42:43], v[218:219], v[186:187], v[42:43] op_sel_hi:[1,0,1]
v_pk_mul_f32 v[44:45], v[44:45], v[180:181] op_sel_hi:[1,0]
v_pk_mul_f32 v[46:47], v[46:47], v[180:181] op_sel_hi:[1,0]
v_pk_fma_f32 v[44:45], v[220:221], v[186:187], v[44:45] op_sel_hi:[1,0,1]
v_pk_fma_f32 v[46:47], v[222:223], v[186:187], v[46:47] op_sel_hi:[1,0,1]
v_pk_mul_f32 v[48:49], v[48:49], v[182:183] op_sel_hi:[1,0]
v_pk_mul_f32 v[50:51], v[50:51], v[182:183] op_sel_hi:[1,0]
v_pk_fma_f32 v[48:49], v[192:193], v[188:189], v[48:49] op_sel_hi:[1,0,1]
v_pk_fma_f32 v[50:51], v[194:195], v[188:189], v[50:51] op_sel_hi:[1,0,1]
v_pk_mul_f32 v[52:53], v[52:53], v[182:183] op_sel_hi:[1,0]
v_pk_mul_f32 v[54:55], v[54:55], v[182:183] op_sel_hi:[1,0]
v_pk_fma_f32 v[52:53], v[196:197], v[188:189], v[52:53] op_sel_hi:[1,0,1]
v_pk_fma_f32 v[54:55], v[198:199], v[188:189], v[54:55] op_sel_hi:[1,0,1]
v_pk_mul_f32 v[56:57], v[56:57], v[182:183] op_sel_hi:[1,0]
v_pk_mul_f32 v[58:59], v[58:59], v[182:183] op_sel_hi:[1,0]
v_pk_fma_f32 v[56:57], v[200:201], v[188:189], v[56:57] op_sel_hi:[1,0,1]
v_pk_fma_f32 v[58:59], v[202:203], v[188:189], v[58:59] op_sel_hi:[1,0,1]
v_pk_mul_f32 v[60:61], v[60:61], v[182:183] op_sel_hi:[1,0]
v_pk_mul_f32 v[62:63], v[62:63], v[182:183] op_sel_hi:[1,0]
v_pk_fma_f32 v[60:61], v[204:205], v[188:189], v[60:61] op_sel_hi:[1,0,1]
v_pk_fma_f32 v[62:63], v[206:207], v[188:189], v[62:63] op_sel_hi:[1,0,1]
v_pk_mul_f32 v[64:65], v[64:65], v[182:183] op_sel_hi:[1,0]
v_pk_mul_f32 v[66:67], v[66:67], v[182:183] op_sel_hi:[1,0]
v_pk_fma_f32 v[64:65], v[208:209], v[188:189], v[64:65] op_sel_hi:[1,0,1]
v_pk_fma_f32 v[66:67], v[210:211], v[188:189], v[66:67] op_sel_hi:[1,0,1]
v_pk_mul_f32 v[68:69], v[68:69], v[182:183] op_sel_hi:[1,0]
v_pk_mul_f32 v[70:71], v[70:71], v[182:183] op_sel_hi:[1,0]
v_pk_fma_f32 v[68:69], v[212:213], v[188:189], v[68:69] op_sel_hi:[1,0,1]
v_pk_fma_f32 v[70:71], v[214:215], v[188:189], v[70:71] op_sel_hi:[1,0,1]
v_pk_mul_f32 v[72:73], v[72:73], v[182:183] op_sel_hi:[1,0]
v_pk_mul_f32 v[74:75], v[74:75], v[182:183] op_sel_hi:[1,0]
v_pk_fma_f32 v[72:73], v[216:217], v[188:189], v[72:73] op_sel_hi:[1,0,1]
v_pk_fma_f32 v[74:75], v[218:219], v[188:189], v[74:75] op_sel_hi:[1,0,1]
v_pk_mul_f32 v[76:77], v[76:77], v[182:183] op_sel_hi:[1,0]
v_pk_mul_f32 v[78:79], v[78:79], v[182:183] op_sel_hi:[1,0]
v_pk_fma_f32 v[76:77], v[220:221], v[188:189], v[76:77] op_sel_hi:[1,0,1]
v_pk_fma_f32 v[78:79], v[222:223], v[188:189], v[78:79] op_sel_hi:[1,0,1]
v_pk_mul_f32 v[80:81], v[80:81], v[184:185] op_sel_hi:[1,0]
v_pk_mul_f32 v[82:83], v[82:83], v[184:185] op_sel_hi:[1,0]
v_pk_fma_f32 v[80:81], v[224:225], v[190:191], v[80:81] op_sel_hi:[1,0,1]
v_pk_fma_f32 v[82:83], v[226:227], v[190:191], v[82:83] op_sel_hi:[1,0,1]
v_pk_mul_f32 v[84:85], v[84:85], v[184:185] op_sel_hi:[1,0]
v_pk_mul_f32 v[86:87], v[86:87], v[184:185] op_sel_hi:[1,0]
v_pk_fma_f32 v[84:85], v[228:229], v[190:191], v[84:85] op_sel_hi:[1,0,1]
v_pk_fma_f32 v[86:87], v[230:231], v[190:191], v[86:87] op_sel_hi:[1,0,1]
s_mov_b32 s26, -1
s_mov_b32 s27, 0
s_mov_b32 s28, 0
s_mov_b32 s29, -1
s_not_b64 s[22:23], s[38:39]
s_not_b64 s[42:43], s[40:41]
s_barrier
v_cvt_pk_bf16_f32 v88, v16, v17
v_cvt_pk_bf16_f32 v89, v18, v19
ds_write_b64 v232, v[88:89] offset:0
v_cvt_pk_bf16_f32 v90, v48, v49
v_cvt_pk_bf16_f32 v91, v50, v51
ds_write_b64 v232, v[90:91] offset:768
v_cvt_pk_bf16_f32 v92, v20, v21
v_cvt_pk_bf16_f32 v93, v22, v23
ds_write_b64 v233, v[92:93] offset:0
v_cvt_pk_bf16_f32 v94, v52, v53
v_cvt_pk_bf16_f32 v95, v54, v55
ds_write_b64 v233, v[94:95] offset:768
v_cvt_pk_bf16_f32 v96, v36, v37
v_cvt_pk_bf16_f32 v97, v38, v39
ds_write_b64 v235, v[96:97] offset:0
v_cvt_pk_bf16_f32 v98, v68, v69
v_cvt_pk_bf16_f32 v99, v70, v71
ds_write_b64 v235, v[98:99] offset:768
v_cvt_pk_bf16_f32 v100, v40, v41
v_cvt_pk_bf16_f32 v101, v42, v43
ds_write_b64 v236, v[100:101] offset:0
v_cvt_pk_bf16_f32 v102, v72, v73
v_cvt_pk_bf16_f32 v103, v74, v75
ds_write_b64 v236, v[102:103] offset:768
ds_write_b128 v239, v[28:31] offset:0
ds_write_b128 v239, v[60:63] offset:1280
ds_write_b128 v240, v[32:35] offset:0
ds_write_b128 v240, v[64:67] offset:1280
v_cvt_pk_bf16_f32 v88, v24, v25
v_cvt_pk_bf16_f32 v89, v26, v27
v_cvt_pk_bf16_f32 v90, v56, v57
v_cvt_pk_bf16_f32 v91, v58, v59
v_cvt_pk_bf16_f32 v92, v44, v45
v_cvt_pk_bf16_f32 v93, v46, v47
v_cvt_pk_bf16_f32 v94, v76, v77
v_cvt_pk_bf16_f32 v95, v78, v79
v_cvt_pk_bf16_f32 v96, v80, v81
v_cvt_pk_bf16_f32 v97, v82, v83
v_cvt_pk_bf16_f32 v98, v84, v85
v_cvt_pk_bf16_f32 v99, v86, v87
s_mov_b64 exec, s[26:27]
ds_write_b64 v234, v[88:89] offset:0
ds_write_b64 v234, v[90:91] offset:768
ds_write_b64 v237, v[92:93] offset:0
ds_write_b64 v237, v[94:95] offset:768
s_mov_b64 exec, s[28:29]
ds_write_b128 v238, v[24:27] offset:0
ds_write_b128 v238, v[56:59] offset:1280
s_mov_b64 exec, s[38:39]
ds_write_b64 v241, v[96:97]
s_mov_b64 exec, s[22:23]
ds_write_b128 v243, v[80:83]
s_mov_b64 exec, s[40:41]
ds_write_b64 v242, v[98:99]
s_mov_b64 exec, s[42:43]
ds_write_b128 v244, v[84:87]
s_mov_b64 exec, -1
s_waitcnt lgkmcnt(0)
s_barrier
v_and_b32 v10, 127, v0
v_lshrrev_b32 v11, 7, v0
v_add_u32 v12, 2, v10
v_mul_u32_u24 v13, 48, v12
v_mul_u32_u24 v14, 6912, v11
v_add_u32 v13, v13, v14
v_add_u32 v15, 14496, v13
v_mul_u32_u24 v14, 80, v12
v_mul_u32_u24 v9, 11520, v11
v_add_u32 v14, v14, v9
v_add_u32 v14, 27648, v14
ds_read_b128 v[16:19], v15 offset:0
ds_read_b128 v[20:23], v15 offset:16
ds_read_b128 v[24:27], v15 offset:32
ds_read_b128 v[28:31], v13 offset:672
ds_read_b128 v[32:35], v13 offset:688
ds_read_b128 v[36:39], v13 offset:704
ds_read_b128 v[40:43], v13 offset:576
ds_read_b128 v[44:47], v13 offset:592
ds_read_b128 v[48:51], v13 offset:608
ds_read_b128 v[52:55], v13 offset:480
ds_read_b128 v[56:59], v13 offset:496
ds_read_b128 v[60:63], v13 offset:512
ds_read_b128 v[64:67], v13 offset:384
ds_read_b128 v[68:71], v13 offset:400
ds_read_b128 v[72:75], v13 offset:416
ds_read_b128 v[76:79], v13 offset:288
ds_read_b128 v[80:83], v13 offset:304
ds_read_b128 v[84:87], v13 offset:320
ds_read_b128 v[88:91], v13 offset:192
ds_read_b128 v[92:95], v13 offset:208
ds_read_b128 v[96:99], v13 offset:224
ds_read_b128 v[100:103], v13 offset:96
ds_read_b128 v[104:107], v13 offset:112
ds_read_b128 v[108:111], v13 offset:128
ds_read_b128 v[112:115], v13 offset:0
ds_read_b128 v[116:119], v13 offset:16
ds_read_b128 v[120:123], v13 offset:32
s_waitcnt lgkmcnt(0)
ds_read_b128 v[124:127], v14 offset:1120
ds_read_b128 v[128:131], v14 offset:1136
ds_read_b128 v[132:135], v14 offset:1152
ds_read_b128 v[136:139], v14 offset:1168
ds_read_b128 v[140:143], v14 offset:1184
ds_read_b128 v[144:147], v14 offset:960
ds_read_b128 v[148:151], v14 offset:976
ds_read_b128 v[152:155], v14 offset:992
ds_read_b128 v[156:159], v14 offset:1008
ds_read_b128 v[160:163], v14 offset:1024
ds_read_b128 v[164:167], v14 offset:800
ds_read_b128 v[168:171], v14 offset:816
ds_read_b128 v[172:175], v14 offset:832
ds_read_b128 v[176:179], v14 offset:848
ds_read_b128 v[180:183], v14 offset:864
ds_read_b128 v[184:187], v14 offset:640
ds_read_b128 v[188:191], v14 offset:656
ds_read_b128 v[192:195], v14 offset:672
ds_read_b128 v[196:199], v14 offset:688
ds_read_b128 v[200:203], v14 offset:704
v_dot2_f32_bf16 v204, v16, v28, 0
v_dot2_f32_bf16 v205, v16, v40, 0
v_dot2_f32_bf16 v206, v16, v52, 0
v_dot2_f32_bf16 v207, v16, v64, 0
v_dot2_f32_bf16 v208, v16, v76, 0
v_dot2_f32_bf16 v209, v16, v88, 0
v_dot2_f32_bf16 v210, v16, v100, 0
v_dot2_f32_bf16 v211, v16, v112, 0
v_dot2_f32_bf16 v204, v17, v29, v204
v_dot2_f32_bf16 v205, v17, v41, v205
v_dot2_f32_bf16 v206, v17, v53, v206
v_dot2_f32_bf16 v207, v17, v65, v207
v_dot2_f32_bf16 v208, v17, v77, v208
v_dot2_f32_bf16 v209, v17, v89, v209
v_dot2_f32_bf16 v210, v17, v101, v210
v_dot2_f32_bf16 v211, v17, v113, v211
v_dot2_f32_bf16 v204, v18, v30, v204
v_dot2_f32_bf16 v205, v18, v42, v205
v_dot2_f32_bf16 v206, v18, v54, v206
v_dot2_f32_bf16 v207, v18, v66, v207
v_dot2_f32_bf16 v208, v18, v78, v208
v_dot2_f32_bf16 v209, v18, v90, v209
v_dot2_f32_bf16 v210, v18, v102, v210
v_dot2_f32_bf16 v211, v18, v114, v211
v_dot2_f32_bf16 v204, v19, v31, v204
v_dot2_f32_bf16 v205, v19, v43, v205
v_dot2_f32_bf16 v206, v19, v55, v206
v_dot2_f32_bf16 v207, v19, v67, v207
v_dot2_f32_bf16 v208, v19, v79, v208
v_dot2_f32_bf16 v209, v19, v91, v209
v_dot2_f32_bf16 v210, v19, v103, v210
v_dot2_f32_bf16 v211, v19, v115, v211
v_dot2_f32_bf16 v204, v20, v32, v204
v_dot2_f32_bf16 v205, v20, v44, v205
v_dot2_f32_bf16 v206, v20, v56, v206
v_dot2_f32_bf16 v207, v20, v68, v207
v_dot2_f32_bf16 v208, v20, v80, v208
v_dot2_f32_bf16 v209, v20, v92, v209
v_dot2_f32_bf16 v210, v20, v104, v210
v_dot2_f32_bf16 v211, v20, v116, v211
v_dot2_f32_bf16 v204, v21, v33, v204
v_dot2_f32_bf16 v205, v21, v45, v205
v_dot2_f32_bf16 v206, v21, v57, v206
v_dot2_f32_bf16 v207, v21, v69, v207
v_dot2_f32_bf16 v208, v21, v81, v208
v_dot2_f32_bf16 v209, v21, v93, v209
v_dot2_f32_bf16 v210, v21, v105, v210
v_dot2_f32_bf16 v211, v21, v117, v211
v_dot2_f32_bf16 v204, v22, v34, v204
v_dot2_f32_bf16 v205, v22, v46, v205
v_dot2_f32_bf16 v206, v22, v58, v206
v_dot2_f32_bf16 v207, v22, v70, v207
v_dot2_f32_bf16 v208, v22, v82, v208
v_dot2_f32_bf16 v209, v22, v94, v209
v_dot2_f32_bf16 v210, v22, v106, v210
v_dot2_f32_bf16 v211, v22, v118, v211
v_dot2_f32_bf16 v204, v23, v35, v204
v_dot2_f32_bf16 v205, v23, v47, v205
v_dot2_f32_bf16 v206, v23, v59, v206
v_dot2_f32_bf16 v207, v23, v71, v207
v_dot2_f32_bf16 v208, v23, v83, v208
v_dot2_f32_bf16 v209, v23, v95, v209
v_dot2_f32_bf16 v210, v23, v107, v210
v_dot2_f32_bf16 v211, v23, v119, v211
v_dot2_f32_bf16 v204, v24, v36, v204
v_dot2_f32_bf16 v205, v24, v48, v205
v_dot2_f32_bf16 v206, v24, v60, v206
v_dot2_f32_bf16 v207, v24, v72, v207
v_dot2_f32_bf16 v208, v24, v84, v208
v_dot2_f32_bf16 v209, v24, v96, v209
v_dot2_f32_bf16 v210, v24, v108, v210
v_dot2_f32_bf16 v211, v24, v120, v211
v_dot2_f32_bf16 v204, v25, v37, v204
v_dot2_f32_bf16 v205, v25, v49, v205
v_dot2_f32_bf16 v206, v25, v61, v206
v_dot2_f32_bf16 v207, v25, v73, v207
v_dot2_f32_bf16 v208, v25, v85, v208
v_dot2_f32_bf16 v209, v25, v97, v209
v_dot2_f32_bf16 v210, v25, v109, v210
v_dot2_f32_bf16 v211, v25, v121, v211
s_nop 2
s_waitcnt lgkmcnt(0)
ds_read_b128 v[28:31], v14 offset:480
ds_read_b128 v[32:35], v14 offset:496
ds_read_b128 v[36:39], v14 offset:512
ds_read_b128 v[40:43], v14 offset:528
ds_read_b128 v[44:47], v14 offset:544
ds_read_b128 v[48:51], v14 offset:320
ds_read_b128 v[52:55], v14 offset:336
ds_read_b128 v[56:59], v14 offset:352
ds_read_b128 v[60:63], v14 offset:368
ds_read_b128 v[64:67], v14 offset:384
ds_read_b128 v[68:71], v14 offset:160
ds_read_b128 v[72:75], v14 offset:176
ds_read_b128 v[76:79], v14 offset:192
ds_read_b128 v[80:83], v14 offset:208
ds_read_b128 v[84:87], v14 offset:224
ds_read_b128 v[88:91], v14 offset:0
ds_read_b128 v[92:95], v14 offset:16
ds_read_b128 v[96:99], v14 offset:32
ds_read_b128 v[100:103], v14 offset:48
ds_read_b128 v[104:107], v14 offset:64
s_mov_b32 s24, 0x3ea52b5c
s_lshl_b32 s25, s4, 7
v_add_u32 v9, s25, v10
v_mov_b32 v8, 0xceabfb8f
v_mul_f32 v204, s24, v204
v_mul_f32 v205, s24, v205
v_mul_f32 v206, s24, v206
v_mul_f32 v207, s24, v207
v_mul_f32 v208, s24, v208
v_mul_f32 v209, s24, v209
v_mul_f32 v210, s24, v210
v_mul_f32 v211, s24, v211
v_cmp_le_u32 vcc, 2, v9
s_nop 1
v_cndmask_b32 v205, v8, v205, vcc
v_cmp_le_u32 vcc, 4, v9
s_nop 1
v_cndmask_b32 v206, v8, v206, vcc
v_cmp_le_u32 vcc, 6, v9
s_nop 1
v_cndmask_b32 v207, v8, v207, vcc
v_cmp_le_u32 vcc, 8, v9
s_nop 1
v_cndmask_b32 v208, v8, v208, vcc
v_cmp_le_u32 vcc, 10, v9
s_nop 1
v_cndmask_b32 v209, v8, v209, vcc
v_cmp_le_u32 vcc, 12, v9
s_nop 1
v_cndmask_b32 v210, v8, v210, vcc
v_cmp_le_u32 vcc, 14, v9
s_nop 1
v_cndmask_b32 v211, v8, v211, vcc
v_max3_f32 v7, v204, v205, v206
v_max3_f32 v7, v7, v207, v208
v_max3_f32 v7, v7, v209, v210
v_max_f32 v7, v7, v211
v_sub_f32 v204, v204, v7
v_sub_f32 v205, v205, v7
v_sub_f32 v206, v206, v7
v_sub_f32 v207, v207, v7
v_sub_f32 v208, v208, v7
v_sub_f32 v209, v209, v7
v_sub_f32 v210, v210, v7
v_sub_f32 v211, v211, v7
v_exp_f32 v232, v204
v_exp_f32 v233, v205
v_exp_f32 v234, v206
v_exp_f32 v235, v207
v_exp_f32 v236, v208
v_exp_f32 v237, v209
v_exp_f32 v238, v210
v_exp_f32 v239, v211
s_nop 1
v_add_f32 v7, v232, v233
v_add_f32 v7, v7, v234
v_add_f32 v7, v7, v235
v_add_f32 v7, v7, v236
v_add_f32 v7, v7, v237
v_add_f32 v7, v7, v238
v_add_f32 v7, v7, v239
v_rcp_f32 v7, v7
v_pk_mul_f32 v[212:213], v[124:125], v[232:233] op_sel:[0,0] op_sel_hi:[1,0]
v_pk_mul_f32 v[214:215], v[126:127], v[232:233] op_sel:[0,0] op_sel_hi:[1,0]
v_pk_mul_f32 v[216:217], v[128:129], v[232:233] op_sel:[0,0] op_sel_hi:[1,0]
v_pk_mul_f32 v[218:219], v[130:131], v[232:233] op_sel:[0,0] op_sel_hi:[1,0]
v_pk_mul_f32 v[220:221], v[132:133], v[232:233] op_sel:[0,0] op_sel_hi:[1,0]
v_pk_mul_f32 v[222:223], v[134:135], v[232:233] op_sel:[0,0] op_sel_hi:[1,0]
v_pk_mul_f32 v[224:225], v[136:137], v[232:233] op_sel:[0,0] op_sel_hi:[1,0]
v_pk_mul_f32 v[226:227], v[138:139], v[232:233] op_sel:[0,0] op_sel_hi:[1,0]
v_pk_mul_f32 v[228:229], v[140:141], v[232:233] op_sel:[0,0] op_sel_hi:[1,0]
v_pk_mul_f32 v[230:231], v[142:143], v[232:233] op_sel:[0,0] op_sel_hi:[1,0]
v_pk_fma_f32 v[212:213], v[144:145], v[232:233], v[212:213] op_sel:[0,1,0] op_sel_hi:[1,1,1]
v_pk_fma_f32 v[214:215], v[146:147], v[232:233], v[214:215] op_sel:[0,1,0] op_sel_hi:[1,1,1]
v_pk_fma_f32 v[216:217], v[148:149], v[232:233], v[216:217] op_sel:[0,1,0] op_sel_hi:[1,1,1]
v_pk_fma_f32 v[218:219], v[150:151], v[232:233], v[218:219] op_sel:[0,1,0] op_sel_hi:[1,1,1]
v_pk_fma_f32 v[220:221], v[152:153], v[232:233], v[220:221] op_sel:[0,1,0] op_sel_hi:[1,1,1]
v_pk_fma_f32 v[222:223], v[154:155], v[232:233], v[222:223] op_sel:[0,1,0] op_sel_hi:[1,1,1]
v_pk_fma_f32 v[224:225], v[156:157], v[232:233], v[224:225] op_sel:[0,1,0] op_sel_hi:[1,1,1]
v_pk_fma_f32 v[226:227], v[158:159], v[232:233], v[226:227] op_sel:[0,1,0] op_sel_hi:[1,1,1]
v_pk_fma_f32 v[228:229], v[160:161], v[232:233], v[228:229] op_sel:[0,1,0] op_sel_hi:[1,1,1]
v_pk_fma_f32 v[230:231], v[162:163], v[232:233], v[230:231] op_sel:[0,1,0] op_sel_hi:[1,1,1]
v_pk_fma_f32 v[212:213], v[164:165], v[234:235], v[212:213] op_sel:[0,0,0] op_sel_hi:[1,0,1]
v_pk_fma_f32 v[214:215], v[166:167], v[234:235], v[214:215] op_sel:[0,0,0] op_sel_hi:[1,0,1]
v_pk_fma_f32 v[216:217], v[168:169], v[234:235], v[216:217] op_sel:[0,0,0] op_sel_hi:[1,0,1]
v_pk_fma_f32 v[218:219], v[170:171], v[234:235], v[218:219] op_sel:[0,0,0] op_sel_hi:[1,0,1]
v_pk_fma_f32 v[220:221], v[172:173], v[234:235], v[220:221] op_sel:[0,0,0] op_sel_hi:[1,0,1]
v_pk_fma_f32 v[222:223], v[174:175], v[234:235], v[222:223] op_sel:[0,0,0] op_sel_hi:[1,0,1]
v_pk_fma_f32 v[224:225], v[176:177], v[234:235], v[224:225] op_sel:[0,0,0] op_sel_hi:[1,0,1]
v_pk_fma_f32 v[226:227], v[178:179], v[234:235], v[226:227] op_sel:[0,0,0] op_sel_hi:[1,0,1]
v_pk_fma_f32 v[228:229], v[180:181], v[234:235], v[228:229] op_sel:[0,0,0] op_sel_hi:[1,0,1]
v_pk_fma_f32 v[230:231], v[182:183], v[234:235], v[230:231] op_sel:[0,0,0] op_sel_hi:[1,0,1]
v_pk_fma_f32 v[212:213], v[184:185], v[234:235], v[212:213] op_sel:[0,1,0] op_sel_hi:[1,1,1]
v_pk_fma_f32 v[214:215], v[186:187], v[234:235], v[214:215] op_sel:[0,1,0] op_sel_hi:[1,1,1]
v_pk_fma_f32 v[216:217], v[188:189], v[234:235], v[216:217] op_sel:[0,1,0] op_sel_hi:[1,1,1]
v_pk_fma_f32 v[218:219], v[190:191], v[234:235], v[218:219] op_sel:[0,1,0] op_sel_hi:[1,1,1]
v_pk_fma_f32 v[220:221], v[192:193], v[234:235], v[220:221] op_sel:[0,1,0] op_sel_hi:[1,1,1]
v_pk_fma_f32 v[222:223], v[194:195], v[234:235], v[222:223] op_sel:[0,1,0] op_sel_hi:[1,1,1]
v_pk_fma_f32 v[224:225], v[196:197], v[234:235], v[224:225] op_sel:[0,1,0] op_sel_hi:[1,1,1]
v_pk_fma_f32 v[226:227], v[198:199], v[234:235], v[226:227] op_sel:[0,1,0] op_sel_hi:[1,1,1]
v_pk_fma_f32 v[228:229], v[200:201], v[234:235], v[228:229] op_sel:[0,1,0] op_sel_hi:[1,1,1]
v_pk_fma_f32 v[230:231], v[202:203], v[234:235], v[230:231] op_sel:[0,1,0] op_sel_hi:[1,1,1]
s_waitcnt lgkmcnt(0)
v_pk_fma_f32 v[212:213], v[28:29], v[236:237], v[212:213] op_sel:[0,0,0] op_sel_hi:[1,0,1]
v_pk_fma_f32 v[214:215], v[30:31], v[236:237], v[214:215] op_sel:[0,0,0] op_sel_hi:[1,0,1]
v_pk_fma_f32 v[216:217], v[32:33], v[236:237], v[216:217] op_sel:[0,0,0] op_sel_hi:[1,0,1]
v_pk_fma_f32 v[218:219], v[34:35], v[236:237], v[218:219] op_sel:[0,0,0] op_sel_hi:[1,0,1]
v_pk_fma_f32 v[220:221], v[36:37], v[236:237], v[220:221] op_sel:[0,0,0] op_sel_hi:[1,0,1]
v_pk_fma_f32 v[222:223], v[38:39], v[236:237], v[222:223] op_sel:[0,0,0] op_sel_hi:[1,0,1]
v_pk_fma_f32 v[224:225], v[40:41], v[236:237], v[224:225] op_sel:[0,0,0] op_sel_hi:[1,0,1]
v_pk_fma_f32 v[226:227], v[42:43], v[236:237], v[226:227] op_sel:[0,0,0] op_sel_hi:[1,0,1]
v_pk_fma_f32 v[228:229], v[44:45], v[236:237], v[228:229] op_sel:[0,0,0] op_sel_hi:[1,0,1]
v_pk_fma_f32 v[230:231], v[46:47], v[236:237], v[230:231] op_sel:[0,0,0] op_sel_hi:[1,0,1]
v_pk_fma_f32 v[212:213], v[48:49], v[236:237], v[212:213] op_sel:[0,1,0] op_sel_hi:[1,1,1]
v_pk_fma_f32 v[214:215], v[50:51], v[236:237], v[214:215] op_sel:[0,1,0] op_sel_hi:[1,1,1]
v_pk_fma_f32 v[216:217], v[52:53], v[236:237], v[216:217] op_sel:[0,1,0] op_sel_hi:[1,1,1]
v_pk_fma_f32 v[218:219], v[54:55], v[236:237], v[218:219] op_sel:[0,1,0] op_sel_hi:[1,1,1]
v_pk_fma_f32 v[220:221], v[56:57], v[236:237], v[220:221] op_sel:[0,1,0] op_sel_hi:[1,1,1]
v_pk_fma_f32 v[222:223], v[58:59], v[236:237], v[222:223] op_sel:[0,1,0] op_sel_hi:[1,1,1]
v_pk_fma_f32 v[224:225], v[60:61], v[236:237], v[224:225] op_sel:[0,1,0] op_sel_hi:[1,1,1]
v_pk_fma_f32 v[226:227], v[62:63], v[236:237], v[226:227] op_sel:[0,1,0] op_sel_hi:[1,1,1]
v_pk_fma_f32 v[228:229], v[64:65], v[236:237], v[228:229] op_sel:[0,1,0] op_sel_hi:[1,1,1]
v_pk_fma_f32 v[230:231], v[66:67], v[236:237], v[230:231] op_sel:[0,1,0] op_sel_hi:[1,1,1]
v_pk_fma_f32 v[212:213], v[68:69], v[238:239], v[212:213] op_sel:[0,0,0] op_sel_hi:[1,0,1]
v_pk_fma_f32 v[214:215], v[70:71], v[238:239], v[214:215] op_sel:[0,0,0] op_sel_hi:[1,0,1]
v_pk_fma_f32 v[216:217], v[72:73], v[238:239], v[216:217] op_sel:[0,0,0] op_sel_hi:[1,0,1]
v_pk_fma_f32 v[218:219], v[74:75], v[238:239], v[218:219] op_sel:[0,0,0] op_sel_hi:[1,0,1]
v_pk_fma_f32 v[220:221], v[76:77], v[238:239], v[220:221] op_sel:[0,0,0] op_sel_hi:[1,0,1]
v_pk_fma_f32 v[222:223], v[78:79], v[238:239], v[222:223] op_sel:[0,0,0] op_sel_hi:[1,0,1]
v_pk_fma_f32 v[224:225], v[80:81], v[238:239], v[224:225] op_sel:[0,0,0] op_sel_hi:[1,0,1]
v_pk_fma_f32 v[226:227], v[82:83], v[238:239], v[226:227] op_sel:[0,0,0] op_sel_hi:[1,0,1]
v_pk_fma_f32 v[228:229], v[84:85], v[238:239], v[228:229] op_sel:[0,0,0] op_sel_hi:[1,0,1]
v_pk_fma_f32 v[230:231], v[86:87], v[238:239], v[230:231] op_sel:[0,0,0] op_sel_hi:[1,0,1]
v_pk_fma_f32 v[212:213], v[88:89], v[238:239], v[212:213] op_sel:[0,1,0] op_sel_hi:[1,1,1]
v_pk_fma_f32 v[214:215], v[90:91], v[238:239], v[214:215] op_sel:[0,1,0] op_sel_hi:[1,1,1]
v_pk_fma_f32 v[216:217], v[92:93], v[238:239], v[216:217] op_sel:[0,1,0] op_sel_hi:[1,1,1]
v_pk_fma_f32 v[218:219], v[94:95], v[238:239], v[218:219] op_sel:[0,1,0] op_sel_hi:[1,1,1]
v_pk_fma_f32 v[220:221], v[96:97], v[238:239], v[220:221] op_sel:[0,1,0] op_sel_hi:[1,1,1]
v_pk_fma_f32 v[222:223], v[98:99], v[238:239], v[222:223] op_sel:[0,1,0] op_sel_hi:[1,1,1]
v_pk_fma_f32 v[224:225], v[100:101], v[238:239], v[224:225] op_sel:[0,1,0] op_sel_hi:[1,1,1]
v_pk_fma_f32 v[226:227], v[102:103], v[238:239], v[226:227] op_sel:[0,1,0] op_sel_hi:[1,1,1]
v_pk_fma_f32 v[228:229], v[104:105], v[238:239], v[228:229] op_sel:[0,1,0] op_sel_hi:[1,1,1]
v_pk_fma_f32 v[230:231], v[106:107], v[238:239], v[230:231] op_sel:[0,1,0] op_sel_hi:[1,1,1]
v_mov_b32 v6, v7
v_pk_mul_f32 v[212:213], v[212:213], v[6:7]
v_pk_mul_f32 v[214:215], v[214:215], v[6:7]
v_pk_mul_f32 v[216:217], v[216:217], v[6:7]
v_pk_mul_f32 v[218:219], v[218:219], v[6:7]
v_pk_mul_f32 v[220:221], v[220:221], v[6:7]
v_pk_mul_f32 v[222:223], v[222:223], v[6:7]
v_pk_mul_f32 v[224:225], v[224:225], v[6:7]
v_pk_mul_f32 v[226:227], v[226:227], v[6:7]
v_pk_mul_f32 v[228:229], v[228:229], v[6:7]
v_pk_mul_f32 v[230:231], v[230:231], v[6:7]
v_cvt_pk_bf16_f32 v16, v212, v213
v_cvt_pk_bf16_f32 v17, v214, v215
v_cvt_pk_bf16_f32 v18, v216, v217
v_cvt_pk_bf16_f32 v19, v218, v219
v_cvt_pk_bf16_f32 v20, v220, v221
v_cvt_pk_bf16_f32 v21, v222, v223
v_cvt_pk_bf16_f32 v22, v224, v225
v_cvt_pk_bf16_f32 v23, v226, v227
v_cvt_pk_bf16_f32 v24, v228, v229
v_cvt_pk_bf16_f32 v25, v230, v231
v_lshrrev_b32 v12, 4, v10
s_lshl_b32 s24, s4, 3
v_add_u32 v12, s24, v12
v_mul_u32_u24 v12, 20480, v12
v_and_b32 v13, 15, v10
v_lshlrev_b32 v13, 4, v13
v_add_u32 v12, v12, v13
v_lshlrev_b32 v13, 9, v11
v_add_u32 v13, v12, v13
v_lshlrev_b32 v14, 3, v11
v_add_u32 v14, v12, v14
s_mul_i32 s24, s5, 1280
s_add_u32 s24, s24, 32505856
buffer_store_dwordx4 v[16:19], v13, s[8:11], s24 offen sc1
buffer_store_dwordx4 v[20:23], v13, s[8:11], s24 offen offset:256 sc1
buffer_store_dwordx2 v[24:25], v14, s[8:11], s24 offen offset:1024 sc1
s_lshr_b32 s30, s89, 1
s_mul_i32 s32, s30, 102400
s_mul_i32 s33, s6, 25600
s_add_u32 s32, s32, s33
s_add_u32 s32, s32, 6291456
s_add_u32 s33, s32, 0
buffer_load_dwordx4 a[0:3], v2, s[8:11], s33 offen offset:0
s_add_u32 s33, s32, 0
buffer_load_dwordx4 a[4:7], v2, s[8:11], s33 offen offset:1024
s_add_u32 s33, s32, 0
buffer_load_dwordx4 a[8:11], v2, s[8:11], s33 offen offset:2048
s_add_u32 s33, s32, 0
buffer_load_dwordx4 a[12:15], v2, s[8:11], s33 offen offset:3072
s_add_u32 s33, s32, 4096
buffer_load_dwordx4 a[16:19], v2, s[8:11], s33 offen offset:0
s_add_u32 s33, s32, 4096
buffer_load_dwordx4 a[20:23], v2, s[8:11], s33 offen offset:1024
s_add_u32 s33, s32, 4096
buffer_load_dwordx4 a[24:27], v2, s[8:11], s33 offen offset:2048
s_add_u32 s33, s32, 4096
buffer_load_dwordx4 a[28:31], v2, s[8:11], s33 offen offset:3072
s_add_u32 s33, s32, 8192
buffer_load_dwordx4 a[32:35], v2, s[8:11], s33 offen offset:0
s_add_u32 s33, s32, 8192
buffer_load_dwordx4 a[36:39], v2, s[8:11], s33 offen offset:1024
s_add_u32 s33, s32, 8192
buffer_load_dwordx4 a[40:43], v2, s[8:11], s33 offen offset:2048
s_add_u32 s33, s32, 8192
buffer_load_dwordx4 a[44:47], v2, s[8:11], s33 offen offset:3072
s_waitcnt vmcnt(12)
s_barrier
s_cmp_lg_u32 s6, 0
s_cbranch_scc1 L_ar_36
v_mov_b32 v8, 1
v_mov_b32 v9, s20
s_mov_b64 exec, 1
buffer_atomic_add v8, v9, s[8:11], 0 offen sc1
s_mov_b64 exec, -1
L_ar_36:
s_mov_b32 s4, s88
s_mov_b32 s5, s89
s_mov_b32 s20, s90
s_lshr_b32 s30, s5, 1
s_and_b32 s31, s5, 1
s_add_u32 s33, s32, 12288
buffer_load_dwordx4 a[48:51], v2, s[8:11], s33 offen offset:0
s_add_u32 s33, s32, 12288
buffer_load_dwordx4 a[52:55], v2, s[8:11], s33 offen offset:1024
s_add_u32 s33, s32, 12288
buffer_load_dwordx4 a[56:59], v2, s[8:11], s33 offen offset:2048
s_add_u32 s33, s32, 12288
buffer_load_dwordx4 a[60:63], v2, s[8:11], s33 offen offset:3072
s_add_u32 s33, s32, 16384
buffer_load_dwordx4 a[64:67], v2, s[8:11], s33 offen offset:0
s_add_u32 s33, s32, 16384
buffer_load_dwordx4 a[68:71], v2, s[8:11], s33 offen offset:1024
s_add_u32 s33, s32, 16384
buffer_load_dwordx4 a[72:75], v2, s[8:11], s33 offen offset:2048
s_add_u32 s33, s32, 16384
buffer_load_dwordx4 a[76:79], v2, s[8:11], s33 offen offset:3072
s_add_u32 s33, s32, 20480
buffer_load_dwordx4 a[80:83], v2, s[8:11], s33 offen offset:0
s_add_u32 s33, s32, 20480
buffer_load_dwordx4 a[84:87], v2, s[8:11], s33 offen offset:1024
s_add_u32 s33, s32, 20480
buffer_load_dwordx4 a[88:91], v2, s[8:11], s33 offen offset:2048
s_add_u32 s33, s32, 20480
buffer_load_dwordx4 a[92:95], v2, s[8:11], s33 offen offset:3072
s_add_u32 s33, s32, 24576
buffer_load_dwordx4 a[96:99], v2, s[8:11], s33 offen offset:0
s_cmp_eq_u32 s6, 0
s_cbranch_scc1 L_dm_37
s_sub_u32 s58, s6, 1
s_mul_i32 s58, s58, 28672
s_add_u32 s58, s58, 61440
s_mul_i32 s59, s89, 143360
s_add_u32 s59, s59, s58
s_add_u32 s59, s59, 3145728
s_mov_b32 m0, s58
s_nop 0
buffer_load_dwordx4 v2, s[8:11], s59 offen offset:0 lds
buffer_load_dwordx4 v2, s[8:11], s59 offen offset:1024 lds
buffer_load_dwordx4 v2, s[8:11], s59 offen offset:2048 lds
buffer_load_dwordx4 v2, s[8:11], s59 offen offset:3072 lds
s_add_u32 s58, s58, 4096
s_add_u32 s59, s59, 4096
s_mov_b32 m0, s58
s_nop 0
buffer_load_dwordx4 v2, s[8:11], s59 offen offset:0 lds
buffer_load_dwordx4 v2, s[8:11], s59 offen offset:1024 lds
buffer_load_dwordx4 v2, s[8:11], s59 offen offset:2048 lds
buffer_load_dwordx4 v2, s[8:11], s59 offen offset:3072 lds
s_add_u32 s58, s58, 4096
s_add_u32 s59, s59, 4096
s_mov_b32 m0, s58
s_nop 0
buffer_load_dwordx4 v2, s[8:11], s59 offen offset:0 lds
buffer_load_dwordx4 v2, s[8:11], s59 offen offset:1024 lds
buffer_load_dwordx4 v2, s[8:11], s59 offen offset:2048 lds
buffer_load_dwordx4 v2, s[8:11], s59 offen offset:3072 lds
s_add_u32 s58, s58, 4096
s_add_u32 s59, s59, 4096
s_mov_b32 m0, s58
s_nop 0
buffer_load_dwordx4 v2, s[8:11], s59 offen offset:0 lds
buffer_load_dwordx4 v2, s[8:11], s59 offen offset:1024 lds
buffer_load_dwordx4 v2, s[8:11], s59 offen offset:2048 lds
buffer_load_dwordx4 v2, s[8:11], s59 offen offset:3072 lds
s_add_u32 s58, s58, 4096
s_add_u32 s59, s59, 4096
s_mov_b32 m0, s58
s_nop 0
buffer_load_dwordx4 v2, s[8:11], s59 offen offset:0 lds
buffer_load_dwordx4 v2, s[8:11], s59 offen offset:1024 lds
buffer_load_dwordx4 v2, s[8:11], s59 offen offset:2048 lds
buffer_load_dwordx4 v2, s[8:11], s59 offen offset:3072 lds
s_add_u32 s58, s58, 4096
s_add_u32 s59, s59, 4096
s_mov_b32 m0, s58
s_nop 0
buffer_load_dwordx4 v2, s[8:11], s59 offen offset:0 lds
buffer_load_dwordx4 v2, s[8:11], s59 offen offset:1024 lds
buffer_load_dwordx4 v2, s[8:11], s59 offen offset:2048 lds
buffer_load_dwordx4 v2, s[8:11], s59 offen offset:3072 lds
s_add_u32 s58, s58, 4096
s_add_u32 s59, s59, 4096
s_cmp_eq_u32 s6, 3
s_cbranch_scc1 L_dx_38
s_mov_b32 m0, s58
s_nop 0
buffer_load_dwordx4 v2, s[8:11], s59 offen offset:0 lds
buffer_load_dwordx4 v2, s[8:11], s59 offen offset:1024 lds
buffer_load_dwordx4 v2, s[8:11], s59 offen offset:2048 lds
buffer_load_dwordx4 v2, s[8:11], s59 offen offset:3072 lds
s_add_u32 s58, s58, 4096
s_add_u32 s59, s59, 4096
L_dx_38:
L_dm_37:
s_cmp_lg_u32 s6, 0
s_cbranch_scc1 L_pl_39
v_mov_b32 v9, s20
s_mov_b64 exec, 1
s_mov_b32 s21, 80
s_mov_b32 s22, 0
L_lp_40:
buffer_load_dword v6, v9, s[8:11], 0 offen sc1
s_waitcnt vmcnt(0)
v_cmp_gt_u32 vcc, s21, v6
s_cbranch_vccz L_dn_41
s_add_u32 s22, s22, 1
s_cmp_lt_u32 s22, 40000
s_cbranch_scc1 L_lp_40
L_dn_41:
s_mov_b64 exec, -1
L_pl_39:
s_barrier
s_lshl_b32 s34, s4, 3
s_lshl_b32 s35, s31, 2
s_add_u32 s34, s34, s35
s_add_u32 s35, s6, 0
s_and_b32 s35, s35, 3
s_add_u32 s35, s35, s34
s_mov_b32 s36, s35
s_mul_i32 s35, s35, 20480
v_add_u32 v232, s35, v2
s_add_u32 s35, s6, 1
s_and_b32 s35, s35, 3
s_add_u32 s35, s35, s34
s_mul_i32 s35, s35, 20480
v_add_u32 v233, s35, v2
s_add_u32 s35, s6, 2
s_and_b32 s35, s35, 3
s_add_u32 s35, s35, s34
s_mul_i32 s35, s35, 20480
v_add_u32 v234, s35, v2
s_add_u32 s35, s6, 3
s_and_b32 s35, s35, 3
s_add_u32 s35, s35, s34
s_mul_i32 s35, s35, 20480
v_add_u32 v235, s35, v2
s_mul_i32 s37, s6, 5120
s_add_u32 s37, s37, 32505856
buffer_load_dwordx4 v[120:123], v232, s[8:11], s37 offen offset:0 sc1
buffer_load_dwordx4 v[124:127], v233, s[8:11], s37 offen offset:0 sc1
buffer_load_dwordx4 v[128:131], v234, s[8:11], s37 offen offset:0 sc1
buffer_load_dwordx4 v[132:135], v235, s[8:11], s37 offen offset:0 sc1
buffer_load_dwordx4 v[136:139], v232, s[8:11], s37 offen offset:1024 sc1
buffer_load_dwordx4 v[140:143], v233, s[8:11], s37 offen offset:1024 sc1
buffer_load_dwordx4 v[144:147], v234, s[8:11], s37 offen offset:1024 sc1
buffer_load_dwordx4 v[148:151], v235, s[8:11], s37 offen offset:1024 sc1
buffer_load_dwordx4 v[152:155], v232, s[8:11], s37 offen offset:2048 sc1
buffer_load_dwordx4 v[156:159], v233, s[8:11], s37 offen offset:2048 sc1
buffer_load_dwordx4 v[160:163], v234, s[8:11], s37 offen offset:2048 sc1
buffer_load_dwordx4 v[164:167], v235, s[8:11], s37 offen offset:2048 sc1
buffer_load_dwordx4 v[168:171], v232, s[8:11], s37 offen offset:3072 sc1
buffer_load_dwordx4 v[172:175], v233, s[8:11], s37 offen offset:3072 sc1
buffer_load_dwordx4 v[176:179], v234, s[8:11], s37 offen offset:3072 sc1
buffer_load_dwordx4 v[180:183], v235, s[8:11], s37 offen offset:3072 sc1
s_add_u32 s37, s37, 4096
buffer_load_dwordx4 v[184:187], v232, s[8:11], s37 offen offset:0 sc1
buffer_load_dwordx4 v[188:191], v233, s[8:11], s37 offen offset:0 sc1
buffer_load_dwordx4 v[192:195], v234, s[8:11], s37 offen offset:0 sc1
buffer_load_dwordx4 v[196:199], v235, s[8:11], s37 offen offset:0 sc1
s_and_b32 s38, s30, 1
s_mul_i32 s39, s30, 5
s_add_u32 s40, s39, s38
s_lshr_b32 s40, s40, 1
s_xor_b32 s41, s38, 1
s_lshl_b32 s41, s41, 2
s_add_u32 s41, s41, s39
s_lshr_b32 s41, s41, 1
s_lshl_b32 s40, s40, 10
s_lshl_b32 s41, s41, 10
s_lshl_b32 s42, s38, 3
s_add_u32 s41, s41, s42
s_mul_i32 s42, s36, 20480
s_add_u32 s40, s40, s42
s_add_u32 s41, s41, s42
s_add_u32 s43, s40, 23068672
s_add_u32 s44, s41, 23068672
s_and_b32 s52, s88, 3
s_and_b32 s53, s89, 1
s_lshl_b32 s53, s53, 2
s_add_u32 s53, s53, s52
s_lshr_b32 s54, s89, 1
s_mul_i32 s56, s54, 286720
s_mul_i32 s60, s53, 35840
s_add_u32 s56, s56, s60
s_mul_i32 s60, s6, 8192
s_add_u32 s56, s56, s60
s_add_u32 s56, s56, 7340032
s_waitcnt vmcnt(16)
v_mfma_f32_16x16x32_bf16 v[16:19], a[0:3], v[120:123], 0
v_mfma_f32_16x16x32_bf16 v[20:23], a[4:7], v[120:123], 0
buffer_load_dwordx4 v[240:243], v2, s[8:11], s43 offen sc1
v_mfma_f32_16x16x32_bf16 v[24:27], a[8:11], v[120:123], 0
v_mfma_f32_16x16x32_bf16 v[28:31], a[12:15], v[120:123], 0
v_mfma_f32_16x16x32_bf16 v[32:35], a[16:19], v[120:123], 0
v_mfma_f32_16x16x32_bf16 v[36:39], a[0:3], v[124:127], 0
v_mfma_f32_16x16x32_bf16 v[40:43], a[4:7], v[124:127], 0
v_mfma_f32_16x16x32_bf16 v[44:47], a[8:11], v[124:127], 0
buffer_load_dwordx4 v[244:247], v2, s[8:11], s43 offen offset:1024 sc1
v_mfma_f32_16x16x32_bf16 v[48:51], a[12:15], v[124:127], 0
v_mfma_f32_16x16x32_bf16 v[52:55], a[16:19], v[124:127], 0
v_mfma_f32_16x16x32_bf16 v[56:59], a[0:3], v[128:131], 0
v_mfma_f32_16x16x32_bf16 v[60:63], a[4:7], v[128:131], 0
v_mfma_f32_16x16x32_bf16 v[64:67], a[8:11], v[128:131], 0
v_mfma_f32_16x16x32_bf16 v[68:71], a[12:15], v[128:131], 0
v_mfma_f32_16x16x32_bf16 v[72:75], a[16:19], v[128:131], 0
buffer_load_dwordx2 v[248:249], v2, s[8:11], s44 offen sc1
v_mfma_f32_16x16x32_bf16 v[76:79], a[0:3], v[132:135], 0
v_mfma_f32_16x16x32_bf16 v[80:83], a[4:7], v[132:135], 0
v_mfma_f32_16x16x32_bf16 v[84:87], a[8:11], v[132:135], 0
v_mfma_f32_16x16x32_bf16 v[88:91], a[12:15], v[132:135], 0
v_mfma_f32_16x16x32_bf16 v[92:95], a[16:19], v[132:135], 0
s_waitcnt vmcnt(15)
v_mfma_f32_16x16x32_bf16 v[16:19], a[20:23], v[136:139], v[16:19]
v_mfma_f32_16x16x32_bf16 v[20:23], a[24:27], v[136:139], v[20:23]
buffer_load_dword v254, v253, s[8:11], s56 offen
v_mfma_f32_16x16x32_bf16 v[24:27], a[28:31], v[136:139], v[24:27]
v_mfma_f32_16x16x32_bf16 v[28:31], a[32:35], v[136:139], v[28:31]
v_mfma_f32_16x16x32_bf16 v[32:35], a[36:39], v[136:139], v[32:35]
v_mfma_f32_16x16x32_bf16 v[36:39], a[20:23], v[140:143], v[36:39]
v_mfma_f32_16x16x32_bf16 v[40:43], a[24:27], v[140:143], v[40:43]
v_mfma_f32_16x16x32_bf16 v[44:47], a[28:31], v[140:143], v[44:47]
v_mfma_f32_16x16x32_bf16 v[48:51], a[32:35], v[140:143], v[48:51]
v_mfma_f32_16x16x32_bf16 v[52:55], a[36:39], v[140:143], v[52:55]
v_mfma_f32_16x16x32_bf16 v[56:59], a[20:23], v[144:147], v[56:59]
v_mfma_f32_16x16x32_bf16 v[60:63], a[24:27], v[144:147], v[60:63]
v_mfma_f32_16x16x32_bf16 v[64:67], a[28:31], v[144:147], v[64:67]
v_mfma_f32_16x16x32_bf16 v[68:71], a[32:35], v[144:147], v[68:71]
v_mfma_f32_16x16x32_bf16 v[72:75], a[36:39], v[144:147], v[72:75]
v_mfma_f32_16x16x32_bf16 v[76:79], a[20:23], v[148:151], v[76:79]
v_mfma_f32_16x16x32_bf16 v[80:83], a[24:27], v[148:151], v[80:83]
v_mfma_f32_16x16x32_bf16 v[84:87], a[28:31], v[148:151], v[84:87]
v_mfma_f32_16x16x32_bf16 v[88:91], a[32:35], v[148:151], v[88:91]
v_mfma_f32_16x16x32_bf16 v[92:95], a[36:39], v[148:151], v[92:95]
s_waitcnt vmcnt(12)
v_mfma_f32_16x16x32_bf16 v[16:19], a[40:43], v[152:155], v[16:19]
v_mfma_f32_16x16x32_bf16 v[20:23], a[44:47], v[152:155], v[20:23]
v_mfma_f32_16x16x32_bf16 v[24:27], a[48:51], v[152:155], v[24:27]
v_mfma_f32_16x16x32_bf16 v[28:31], a[52:55], v[152:155], v[28:31]
v_mfma_f32_16x16x32_bf16 v[32:35], a[56:59], v[152:155], v[32:35]
v_mfma_f32_16x16x32_bf16 v[36:39], a[40:43], v[156:159], v[36:39]
v_mfma_f32_16x16x32_bf16 v[40:43], a[44:47], v[156:159], v[40:43]
v_mfma_f32_16x16x32_bf16 v[44:47], a[48:51], v[156:159], v[44:47]
v_mfma_f32_16x16x32_bf16 v[48:51], a[52:55], v[156:159], v[48:51]
v_mfma_f32_16x16x32_bf16 v[52:55], a[56:59], v[156:159], v[52:55]
v_mfma_f32_16x16x32_bf16 v[56:59], a[40:43], v[160:163], v[56:59]
v_mfma_f32_16x16x32_bf16 v[60:63], a[44:47], v[160:163], v[60:63]
v_mfma_f32_16x16x32_bf16 v[64:67], a[48:51], v[160:163], v[64:67]
v_mfma_f32_16x16x32_bf16 v[68:71], a[52:55], v[160:163], v[68:71]
v_mfma_f32_16x16x32_bf16 v[72:75], a[56:59], v[160:163], v[72:75]
v_mfma_f32_16x16x32_bf16 v[76:79], a[40:43], v[164:167], v[76:79]
v_mfma_f32_16x16x32_bf16 v[80:83], a[44:47], v[164:167], v[80:83]
v_mfma_f32_16x16x32_bf16 v[84:87], a[48:51], v[164:167], v[84:87]
v_mfma_f32_16x16x32_bf16 v[88:91], a[52:55], v[164:167], v[88:91]
v_mfma_f32_16x16x32_bf16 v[92:95], a[56:59], v[164:167], v[92:95]
s_waitcnt vmcnt(8)
v_mfma_f32_16x16x32_bf16 v[16:19], a[60:63], v[168:171], v[16:19]
v_mfma_f32_16x16x32_bf16 v[20:23], a[64:67], v[168:171], v[20:23]
v_mfma_f32_16x16x32_bf16 v[24:27], a[68:71], v[168:171], v[24:27]
v_mfma_f32_16x16x32_bf16 v[28:31], a[72:75], v[168:171], v[28:31]
v_mfma_f32_16x16x32_bf16 v[32:35], a[76:79], v[168:171], v[32:35]
v_mfma_f32_16x16x32_bf16 v[36:39], a[60:63], v[172:175], v[36:39]
v_mfma_f32_16x16x32_bf16 v[40:43], a[64:67], v[172:175], v[40:43]
v_mfma_f32_16x16x32_bf16 v[44:47], a[68:71], v[172:175], v[44:47]
v_mfma_f32_16x16x32_bf16 v[48:51], a[72:75], v[172:175], v[48:51]
v_mfma_f32_16x16x32_bf16 v[52:55], a[76:79], v[172:175], v[52:55]
v_mfma_f32_16x16x32_bf16 v[56:59], a[60:63], v[176:179], v[56:59]
v_mfma_f32_16x16x32_bf16 v[60:63], a[64:67], v[176:179], v[60:63]
v_mfma_f32_16x16x32_bf16 v[64:67], a[68:71], v[176:179], v[64:67]
v_mfma_f32_16x16x32_bf16 v[68:71], a[72:75], v[176:179], v[68:71]
v_mfma_f32_16x16x32_bf16 v[72:75], a[76:79], v[176:179], v[72:75]
v_mfma_f32_16x16x32_bf16 v[76:79], a[60:63], v[180:183], v[76:79]
v_mfma_f32_16x16x32_bf16 v[80:83], a[64:67], v[180:183], v[80:83]
v_mfma_f32_16x16x32_bf16 v[84:87], a[68:71], v[180:183], v[84:87]
v_mfma_f32_16x16x32_bf16 v[88:91], a[72:75], v[180:183], v[88:91]
v_mfma_f32_16x16x32_bf16 v[92:95], a[76:79], v[180:183], v[92:95]
s_waitcnt vmcnt(4)
v_mfma_f32_16x16x32_bf16 v[16:19], a[80:83], v[184:187], v[16:19]
v_mfma_f32_16x16x32_bf16 v[20:23], a[84:87], v[184:187], v[20:23]
v_mfma_f32_16x16x32_bf16 v[24:27], a[88:91], v[184:187], v[24:27]
v_mfma_f32_16x16x32_bf16 v[28:31], a[92:95], v[184:187], v[28:31]
v_mfma_f32_16x16x32_bf16 v[32:35], a[96:99], v[184:187], v[32:35]
v_mfma_f32_16x16x32_bf16 v[36:39], a[80:83], v[188:191], v[36:39]
v_mfma_f32_16x16x32_bf16 v[40:43], a[84:87], v[188:191], v[40:43]
v_mfma_f32_16x16x32_bf16 v[44:47], a[88:91], v[188:191], v[44:47]
v_mfma_f32_16x16x32_bf16 v[48:51], a[92:95], v[188:191], v[48:51]
v_mfma_f32_16x16x32_bf16 v[52:55], a[96:99], v[188:191], v[52:55]
v_mfma_f32_16x16x32_bf16 v[56:59], a[80:83], v[192:195], v[56:59]
v_mfma_f32_16x16x32_bf16 v[60:63], a[84:87], v[192:195], v[60:63]
v_mfma_f32_16x16x32_bf16 v[64:67], a[88:91], v[192:195], v[64:67]
v_mfma_f32_16x16x32_bf16 v[68:71], a[92:95], v[192:195], v[68:71]
v_mfma_f32_16x16x32_bf16 v[72:75], a[96:99], v[192:195], v[72:75]
v_mfma_f32_16x16x32_bf16 v[76:79], a[80:83], v[196:199], v[76:79]
v_mfma_f32_16x16x32_bf16 v[80:83], a[84:87], v[196:199], v[80:83]
v_mfma_f32_16x16x32_bf16 v[84:87], a[88:91], v[196:199], v[84:87]
v_mfma_f32_16x16x32_bf16 v[88:91], a[92:95], v[196:199], v[88:91]
v_mfma_f32_16x16x32_bf16 v[92:95], a[96:99], v[196:199], v[92:95]
s_nop 7
s_add_u32 s35, s6, 1
s_and_b32 s35, s35, 3
s_mul_i32 s35, s35, 15360
s_add_u32 s35, s35, 0
v_add_u32 v233, s35, v2
ds_write_b128 v233, v[36:39] offset:0
ds_write_b128 v233, v[40:43] offset:1024
ds_write_b128 v233, v[44:47] offset:2048
ds_write_b128 v233, v[48:51] offset:3072
ds_write_b128 v233, v[52:55] offset:4096
s_add_u32 s35, s6, 2
s_and_b32 s35, s35, 3
s_mul_i32 s35, s35, 15360
s_add_u32 s35, s35, 5120
v_add_u32 v234, s35, v2
ds_write_b128 v234, v[56:59] offset:0
ds_write_b128 v234, v[60:63] offset:1024
ds_write_b128 v234, v[64:67] offset:2048
ds_write_b128 v234, v[68:71] offset:3072
ds_write_b128 v234, v[72:75] offset:4096
s_add_u32 s35, s6, 3
s_and_b32 s35, s35, 3
s_mul_i32 s35, s35, 15360
s_add_u32 s35, s35, 10240
v_add_u32 v235, s35, v2
ds_write_b128 v235, v[76:79] offset:0
ds_write_b128 v235, v[80:83] offset:1024
ds_write_b128 v235, v[84:87] offset:2048
ds_write_b128 v235, v[88:91] offset:3072
ds_write_b128 v235, v[92:95] offset:4096
s_waitcnt lgkmcnt(0)
s_barrier
s_mul_i32 s35, s6, 15360
v_add_u32 v232, s35, v2
ds_read_b128 v[120:123], v232 offset:0
ds_read_b128 v[124:127], v232 offset:1024
ds_read_b128 v[128:131], v232 offset:2048
ds_read_b128 v[132:135], v232 offset:3072
ds_read_b128 v[136:139], v232 offset:4096
ds_read_b128 v[140:143], v232 offset:5120
ds_read_b128 v[144:147], v232 offset:6144
ds_read_b128 v[148:151], v232 offset:7168
ds_read_b128 v[152:155], v232 offset:8192
ds_read_b128 v[156:159], v232 offset:9216
ds_read_b128 v[160:163], v232 offset:10240
ds_read_b128 v[164:167], v232 offset:11264
ds_read_b128 v[168:171], v232 offset:12288
ds_read_b128 v[172:175], v232 offset:13312
ds_read_b128 v[176:179], v232 offset:14336
s_waitcnt lgkmcnt(10)
v_pk_add_f32 v[16:17], v[16:17], v[120:121]
v_pk_add_f32 v[18:19], v[18:19], v[122:123]
v_pk_add_f32 v[20:21], v[20:21], v[124:125]
v_pk_add_f32 v[22:23], v[22:23], v[126:127]
v_pk_add_f32 v[24:25], v[24:25], v[128:129]
v_pk_add_f32 v[26:27], v[26:27], v[130:131]
v_pk_add_f32 v[28:29], v[28:29], v[132:133]
v_pk_add_f32 v[30:31], v[30:31], v[134:135]
v_pk_add_f32 v[32:33], v[32:33], v[136:137]
v_pk_add_f32 v[34:35], v[34:35], v[138:139]
s_waitcnt lgkmcnt(5)
v_pk_add_f32 v[16:17], v[16:17], v[140:141]
v_pk_add_f32 v[18:19], v[18:19], v[142:143]
v_pk_add_f32 v[20:21], v[20:21], v[144:145]
v_pk_add_f32 v[22:23], v[22:23], v[146:147]
v_pk_add_f32 v[24:25], v[24:25], v[148:149]
v_pk_add_f32 v[26:27], v[26:27], v[150:151]
v_pk_add_f32 v[28:29], v[28:29], v[152:153]
v_pk_add_f32 v[30:31], v[30:31], v[154:155]
v_pk_add_f32 v[32:33], v[32:33], v[156:157]
v_pk_add_f32 v[34:35], v[34:35], v[158:159]
s_waitcnt vmcnt(1) lgkmcnt(0)
v_pk_add_f32 v[16:17], v[16:17], v[160:161]
v_pk_add_f32 v[18:19], v[18:19], v[162:163]
v_pk_add_f32 v[20:21], v[20:21], v[164:165]
v_pk_add_f32 v[22:23], v[22:23], v[166:167]
v_pk_add_f32 v[24:25], v[24:25], v[168:169]
v_pk_add_f32 v[26:27], v[26:27], v[170:171]
v_pk_add_f32 v[28:29], v[28:29], v[172:173]
v_pk_add_f32 v[30:31], v[30:31], v[174:175]
v_pk_add_f32 v[32:33], v[32:33], v[176:177]
v_pk_add_f32 v[34:35], v[34:35], v[178:179]
v_lshlrev_b32 v120, 16, v240
v_and_b32 v121, 0xffff0000, v240
v_add_f32 v16, v16, v120
v_add_f32 v17, v17, v121
v_cvt_pk_bf16_f32 v240, v16, v17
v_lshlrev_b32 v120, 16, v241
v_and_b32 v121, 0xffff0000, v241
v_add_f32 v18, v18, v120
v_add_f32 v19, v19, v121
v_cvt_pk_bf16_f32 v241, v18, v19
v_lshlrev_b32 v120, 16, v242
v_and_b32 v121, 0xffff0000, v242
v_add_f32 v20, v20, v120
v_add_f32 v21, v21, v121
v_cvt_pk_bf16_f32 v242, v20, v21
v_lshlrev_b32 v120, 16, v243
v_and_b32 v121, 0xffff0000, v243
v_add_f32 v22, v22, v120
v_add_f32 v23, v23, v121
v_cvt_pk_bf16_f32 v243, v22, v23
v_lshlrev_b32 v120, 16, v244
v_and_b32 v121, 0xffff0000, v244
v_add_f32 v24, v24, v120
v_add_f32 v25, v25, v121
v_cvt_pk_bf16_f32 v244, v24, v25
v_lshlrev_b32 v120, 16, v245
v_and_b32 v121, 0xffff0000, v245
v_add_f32 v26, v26, v120
v_add_f32 v27, v27, v121
v_cvt_pk_bf16_f32 v245, v26, v27
v_lshlrev_b32 v120, 16, v246
v_and_b32 v121, 0xffff0000, v246
v_add_f32 v28, v28, v120
v_add_f32 v29, v29, v121
v_cvt_pk_bf16_f32 v246, v28, v29
v_lshlrev_b32 v120, 16, v247
v_and_b32 v121, 0xffff0000, v247
v_add_f32 v30, v30, v120
v_add_f32 v31, v31, v121
v_cvt_pk_bf16_f32 v247, v30, v31
v_lshlrev_b32 v120, 16, v248
v_and_b32 v121, 0xffff0000, v248
v_add_f32 v32, v32, v120
v_add_f32 v33, v33, v121
v_cvt_pk_bf16_f32 v248, v32, v33
v_lshlrev_b32 v120, 16, v249
v_and_b32 v121, 0xffff0000, v249
v_add_f32 v34, v34, v120
v_add_f32 v35, v35, v121
v_cvt_pk_bf16_f32 v249, v34, v35
s_add_u32 s43, s40, 26214400
s_add_u32 s44, s41, 26214400
buffer_store_dwordx4 v[240:243], v2, s[8:11], s43 offen sc1
buffer_store_dwordx4 v[244:247], v2, s[8:11], s43 offen offset:1024 sc1
buffer_store_dwordx2 v[248:249], v2, s[8:11], s44 offen sc1
v_mov_b32 v6, 0
v_mov_b32 v7, 0
v_dot2_f32_bf16 v6, v240, s62, v6
v_dot2_f32_bf16 v7, v240, v240, v7
v_dot2_f32_bf16 v6, v241, s62, v6
v_dot2_f32_bf16 v7, v241, v241, v7
v_dot2_f32_bf16 v6, v242, s62, v6
v_dot2_f32_bf16 v7, v242, v242, v7
v_dot2_f32_bf16 v6, v243, s62, v6
v_dot2_f32_bf16 v7, v243, v243, v7
v_dot2_f32_bf16 v6, v244, s62, v6
v_dot2_f32_bf16 v7, v244, v244, v7
v_dot2_f32_bf16 v6, v245, s62, v6
v_dot2_f32_bf16 v7, v245, v245, v7
v_dot2_f32_bf16 v6, v246, s62, v6
v_dot2_f32_bf16 v7, v246, v246, v7
v_dot2_f32_bf16 v6, v247, s62, v6
v_dot2_f32_bf16 v7, v247, v247, v7
v_dot2_f32_bf16 v6, v248, s62, v6
v_dot2_f32_bf16 v7, v248, v248, v7
v_dot2_f32_bf16 v6, v249, s62, v6
v_dot2_f32_bf16 v7, v249, v249, v7
s_nop 2
v_mov_b32 v8, v6
s_nop 1
v_permlane32_swap_b32 v6, v8
s_nop 1
v_add_f32 v6, v6, v8
v_mov_b32 v8, v6
s_nop 1
v_permlane16_swap_b32 v6, v8
s_nop 1
v_add_f32 v6, v6, v8
v_mov_b32 v8, v7
s_nop 1
v_permlane32_swap_b32 v7, v8
s_nop 1
v_add_f32 v7, v7, v8
v_mov_b32 v8, v7
s_nop 1
v_permlane16_swap_b32 v7, v8
s_nop 1
v_add_f32 v7, v7, v8
s_lshl_b32 s35, s36, 10
s_lshl_b32 s42, s30, 7
s_add_u32 s35, s35, s42
s_add_u32 s35, s35, 52822016
v_lshlrev_b32 v8, 3, v3
s_mov_b64 exec, 0xffff
buffer_store_dwordx2 v[6:7], v8, s[8:11], s35 offen sc1
s_mov_b64 exec, -1
s_waitcnt vmcnt(0)
s_barrier
s_cmp_lg_u32 s6, 0
s_cbranch_scc1 L_ar_42
v_mov_b32 v8, 1
v_mov_b32 v9, s20
s_mov_b64 exec, 1
buffer_atomic_add v8, v9, s[8:11], 0 offen sc1
s_mov_b64 exec, -1
L_ar_42:
s_mov_b32 s4, s88
s_mov_b32 s5, s89
s_mov_b32 s20, s90
s_mul_i32 s30, s5, 143360
s_add_u32 s30, s30, 3145728
s_lshl_b32 s31, s2, 10
s_add_u32 s31, s31, 11010048
v_lshlrev_b32 v6, 4, v4
s_add_u32 s49, s31, 512
buffer_load_dwordx4 v[192:195], v6, s[8:11], s49 offen offset:0 sc1
buffer_load_dwordx4 v[196:199], v6, s[8:11], s49 offen offset:64 sc1
buffer_load_dwordx4 v[200:203], v6, s[8:11], s49 offen offset:128 sc1
buffer_load_dwordx4 v[204:207], v6, s[8:11], s49 offen offset:192 sc1
buffer_load_dwordx4 v[208:211], v6, s[8:11], s49 offen offset:256 sc1
buffer_load_dwordx4 v[212:215], v6, s[8:11], s49 offen offset:320 sc1
buffer_load_dwordx4 v[216:219], v6, s[8:11], s49 offen offset:384 sc1
s_cmp_eq_u32 s6, 0
s_cbranch_scc1 L_dm_43
s_mov_b32 s24, 0
s_cmp_eq_u32 s6, 2
s_cselect_b32 s24, 20480, s24
s_cmp_eq_u32 s6, 3
s_cselect_b32 s24, 40960, s24
s_add_u32 s25, s30, s24
s_mov_b32 m0, s24
s_nop 0
buffer_load_dwordx4 v2, s[8:11], s25 offen offset:0 lds
buffer_load_dwordx4 v2, s[8:11], s25 offen offset:1024 lds
buffer_load_dwordx4 v2, s[8:11], s25 offen offset:2048 lds
buffer_load_dwordx4 v2, s[8:11], s25 offen offset:3072 lds
s_add_u32 s24, s24, 4096
s_add_u32 s25, s25, 4096
s_mov_b32 m0, s24
s_nop 0
buffer_load_dwordx4 v2, s[8:11], s25 offen offset:0 lds
buffer_load_dwordx4 v2, s[8:11], s25 offen offset:1024 lds
buffer_load_dwordx4 v2, s[8:11], s25 offen offset:2048 lds
buffer_load_dwordx4 v2, s[8:11], s25 offen offset:3072 lds
s_add_u32 s24, s24, 4096
s_add_u32 s25, s25, 4096
s_mov_b32 m0, s24
s_nop 0
buffer_load_dwordx4 v2, s[8:11], s25 offen offset:0 lds
buffer_load_dwordx4 v2, s[8:11], s25 offen offset:1024 lds
buffer_load_dwordx4 v2, s[8:11], s25 offen offset:2048 lds
buffer_load_dwordx4 v2, s[8:11], s25 offen offset:3072 lds
s_add_u32 s24, s24, 4096
s_add_u32 s25, s25, 4096
s_mov_b32 m0, s24
s_nop 0
buffer_load_dwordx4 v2, s[8:11], s25 offen offset:0 lds
buffer_load_dwordx4 v2, s[8:11], s25 offen offset:1024 lds
buffer_load_dwordx4 v2, s[8:11], s25 offen offset:2048 lds
buffer_load_dwordx4 v2, s[8:11], s25 offen offset:3072 lds
s_add_u32 s24, s24, 4096
s_add_u32 s25, s25, 4096
s_mov_b32 m0, s24
s_nop 0
buffer_load_dwordx4 v2, s[8:11], s25 offen offset:0 lds
buffer_load_dwordx4 v2, s[8:11], s25 offen offset:1024 lds
buffer_load_dwordx4 v2, s[8:11], s25 offen offset:2048 lds
buffer_load_dwordx4 v2, s[8:11], s25 offen offset:3072 lds
s_add_u32 s24, s24, 4096
s_add_u32 s25, s25, 4096
L_dm_43:
s_cmp_lg_u32 s6, 0
s_cbranch_scc1 L_pl_44
v_mov_b32 v9, s20
s_mov_b64 exec, 1
s_mov_b32 s21, 96
s_mov_b32 s22, 0
L_lp_45:
buffer_load_dword v6, v9, s[8:11], 0 offen sc1
s_waitcnt vmcnt(0)
v_cmp_gt_u32 vcc, s21, v6
s_cbranch_vccz L_dn_46
s_add_u32 s22, s22, 1
s_cmp_lt_u32 s22, 40000
s_cbranch_scc1 L_lp_45
L_dn_46:
s_mov_b64 exec, -1
L_pl_44:
s_waitcnt vmcnt(0)
s_barrier
s_lshl_b32 s32, s4, 3
s_lshl_b32 s33, s6, 1
s_add_u32 s32, s32, s33
s_add_u32 s33, s32, 1
s_mul_i32 s24, s32, 20480
v_add_u32 v10, s24, v2
s_mul_i32 s24, s33, 20480
v_add_u32 v11, s24, v2
s_mov_b32 s45, 26214400
buffer_load_dwordx4 a[0:3], v10, s[8:11], s45 offen offset:0 sc1
buffer_load_dwordx4 a[4:7], v11, s[8:11], s45 offen offset:0 sc1
buffer_load_dwordx4 a[8:11], v10, s[8:11], s45 offen offset:1024 sc1
buffer_load_dwordx4 a[12:15], v11, s[8:11], s45 offen offset:1024 sc1
buffer_load_dwordx4 a[16:19], v10, s[8:11], s45 offen offset:2048 sc1
buffer_load_dwordx4 a[20:23], v11, s[8:11], s45 offen offset:2048 sc1
buffer_load_dwordx4 a[24:27], v10, s[8:11], s45 offen offset:3072 sc1
buffer_load_dwordx4 a[28:31], v11, s[8:11], s45 offen offset:3072 sc1
s_add_u32 s45, s45, 4096
buffer_load_dwordx4 a[32:35], v10, s[8:11], s45 offen offset:0 sc1
buffer_load_dwordx4 a[36:39], v11, s[8:11], s45 offen offset:0 sc1
buffer_load_dwordx4 a[40:43], v10, s[8:11], s45 offen offset:1024 sc1
buffer_load_dwordx4 a[44:47], v11, s[8:11], s45 offen offset:1024 sc1
v_lshlrev_b32 v5, 8, v4
v_lshlrev_b32 v6, 3, v3
v_add_u32 v5, v5, v6
s_lshl_b32 s46, s32, 10
s_add_u32 s46, s46, 52822016
s_lshl_b32 s47, s33, 10
s_add_u32 s47, s47, 52822016
s_and_b32 s52, s88, 3
s_and_b32 s53, s89, 1
s_lshl_b32 s53, s53, 2
s_add_u32 s53, s53, s52
s_lshr_b32 s54, s89, 1
v_mov_b32 v13, v2
ds_read_b128 v[88:91], v13 offset:0
ds_read_b128 v[92:95], v13 offset:1024
ds_read_b128 v[96:99], v13 offset:2048
ds_read_b128 v[100:103], v13 offset:3072
ds_read_b128 v[104:107], v13 offset:4096
ds_read_b128 v[108:111], v13 offset:5120
ds_read_b128 v[112:115], v13 offset:6144
s_waitcnt vmcnt(10) lgkmcnt(0)
v_mfma_f32_16x16x32_bf16 v[16:19], v[88:91], a[0:3], 0
ds_read_b128 v[128:131], v13 offset:7168
v_mfma_f32_16x16x32_bf16 v[44:47], v[88:91], a[4:7], 0
ds_read_b128 v[132:135], v13 offset:8192
buffer_load_dwordx4 a[48:51], v10, s[8:11], s45 offen offset:2048 sc1
v_mfma_f32_16x16x32_bf16 v[20:23], v[92:95], a[0:3], 0
ds_read_b128 v[136:139], v13 offset:9216
v_mfma_f32_16x16x32_bf16 v[48:51], v[92:95], a[4:7], 0
ds_read_b128 v[140:143], v13 offset:10240
v_mfma_f32_16x16x32_bf16 v[24:27], v[96:99], a[0:3], 0
ds_read_b128 v[144:147], v13 offset:11264
v_mfma_f32_16x16x32_bf16 v[52:55], v[96:99], a[4:7], 0
ds_read_b128 v[148:151], v13 offset:12288
v_mfma_f32_16x16x32_bf16 v[28:31], v[100:103], a[0:3], 0
ds_read_b128 v[152:155], v13 offset:13312
v_mfma_f32_16x16x32_bf16 v[56:59], v[100:103], a[4:7], 0
v_mfma_f32_16x16x32_bf16 v[32:35], v[104:107], a[0:3], 0
buffer_load_dwordx4 a[52:55], v11, s[8:11], s45 offen offset:2048 sc1
v_mfma_f32_16x16x32_bf16 v[60:63], v[104:107], a[4:7], 0
v_mfma_f32_16x16x32_bf16 v[36:39], v[108:111], a[0:3], 0
v_mfma_f32_16x16x32_bf16 v[64:67], v[108:111], a[4:7], 0
v_mfma_f32_16x16x32_bf16 v[40:43], v[112:115], a[0:3], 0
v_mfma_f32_16x16x32_bf16 v[68:71], v[112:115], a[4:7], 0
s_waitcnt vmcnt(10) lgkmcnt(0)
v_mfma_f32_16x16x32_bf16 v[16:19], v[128:131], a[8:11], v[16:19]
ds_read_b128 v[88:91], v13 offset:14336
v_mfma_f32_16x16x32_bf16 v[44:47], v[128:131], a[12:15], v[44:47]
ds_read_b128 v[92:95], v13 offset:15360
buffer_load_dwordx4 a[56:59], v10, s[8:11], s45 offen offset:3072 sc1
v_mfma_f32_16x16x32_bf16 v[20:23], v[132:135], a[8:11], v[20:23]
ds_read_b128 v[96:99], v13 offset:16384
v_mfma_f32_16x16x32_bf16 v[48:51], v[132:135], a[12:15], v[48:51]
ds_read_b128 v[100:103], v13 offset:17408
v_mfma_f32_16x16x32_bf16 v[24:27], v[136:139], a[8:11], v[24:27]
ds_read_b128 v[104:107], v13 offset:18432
v_mfma_f32_16x16x32_bf16 v[52:55], v[136:139], a[12:15], v[52:55]
ds_read_b128 v[108:111], v13 offset:19456
buffer_load_dwordx4 a[60:63], v11, s[8:11], s45 offen offset:3072 sc1
v_mfma_f32_16x16x32_bf16 v[28:31], v[140:143], a[8:11], v[28:31]
ds_read_b128 v[112:115], v13 offset:20480
v_mfma_f32_16x16x32_bf16 v[56:59], v[140:143], a[12:15], v[56:59]
v_mfma_f32_16x16x32_bf16 v[32:35], v[144:147], a[8:11], v[32:35]
v_mfma_f32_16x16x32_bf16 v[60:63], v[144:147], a[12:15], v[60:63]
v_mfma_f32_16x16x32_bf16 v[36:39], v[148:151], a[8:11], v[36:39]
buffer_load_dwordx2 v[168:169], v5, s[8:11], s46 offen sc1
v_mfma_f32_16x16x32_bf16 v[64:67], v[148:151], a[12:15], v[64:67]
v_mfma_f32_16x16x32_bf16 v[40:43], v[152:155], a[8:11], v[40:43]
v_mfma_f32_16x16x32_bf16 v[68:71], v[152:155], a[12:15], v[68:71]
s_waitcnt vmcnt(11) lgkmcnt(0)
v_mfma_f32_16x16x32_bf16 v[16:19], v[88:91], a[16:19], v[16:19]
ds_read_b128 v[128:131], v13 offset:21504
v_mfma_f32_16x16x32_bf16 v[44:47], v[88:91], a[20:23], v[44:47]
ds_read_b128 v[132:135], v13 offset:22528
s_add_u32 s45, s45, 4096
buffer_load_dwordx4 a[64:67], v10, s[8:11], s45 offen offset:0 sc1
v_mfma_f32_16x16x32_bf16 v[20:23], v[92:95], a[16:19], v[20:23]
ds_read_b128 v[136:139], v13 offset:23552
v_mfma_f32_16x16x32_bf16 v[48:51], v[92:95], a[20:23], v[48:51]
ds_read_b128 v[140:143], v13 offset:24576
v_mfma_f32_16x16x32_bf16 v[24:27], v[96:99], a[16:19], v[24:27]
ds_read_b128 v[144:147], v13 offset:25600
v_mfma_f32_16x16x32_bf16 v[52:55], v[96:99], a[20:23], v[52:55]
ds_read_b128 v[148:151], v13 offset:26624
buffer_load_dwordx4 a[68:71], v11, s[8:11], s45 offen offset:0 sc1
v_mfma_f32_16x16x32_bf16 v[28:31], v[100:103], a[16:19], v[28:31]
ds_read_b128 v[152:155], v13 offset:27648
v_mfma_f32_16x16x32_bf16 v[56:59], v[100:103], a[20:23], v[56:59]
v_mfma_f32_16x16x32_bf16 v[32:35], v[104:107], a[16:19], v[32:35]
v_mfma_f32_16x16x32_bf16 v[60:63], v[104:107], a[20:23], v[60:63]
v_mfma_f32_16x16x32_bf16 v[36:39], v[108:111], a[16:19], v[36:39]
buffer_load_dwordx2 v[170:171], v5, s[8:11], s46 offen offset:128 sc1
v_mfma_f32_16x16x32_bf16 v[64:67], v[108:111], a[20:23], v[64:67]
v_mfma_f32_16x16x32_bf16 v[40:43], v[112:115], a[16:19], v[40:43]
v_mfma_f32_16x16x32_bf16 v[68:71], v[112:115], a[20:23], v[68:71]
s_waitcnt vmcnt(12) lgkmcnt(0)
v_mfma_f32_16x16x32_bf16 v[16:19], v[128:131], a[24:27], v[16:19]
ds_read_b128 v[88:91], v13 offset:28672
v_mfma_f32_16x16x32_bf16 v[44:47], v[128:131], a[28:31], v[44:47]
ds_read_b128 v[92:95], v13 offset:29696
buffer_load_dwordx4 a[72:75], v10, s[8:11], s45 offen offset:1024 sc1
v_mfma_f32_16x16x32_bf16 v[20:23], v[132:135], a[24:27], v[20:23]
ds_read_b128 v[96:99], v13 offset:30720
v_mfma_f32_16x16x32_bf16 v[48:51], v[132:135], a[28:31], v[48:51]
ds_read_b128 v[100:103], v13 offset:31744
v_mfma_f32_16x16x32_bf16 v[24:27], v[136:139], a[24:27], v[24:27]
ds_read_b128 v[104:107], v13 offset:32768
v_mfma_f32_16x16x32_bf16 v[52:55], v[136:139], a[28:31], v[52:55]
ds_read_b128 v[108:111], v13 offset:33792
buffer_load_dwordx4 a[76:79], v11, s[8:11], s45 offen offset:1024 sc1
v_mfma_f32_16x16x32_bf16 v[28:31], v[140:143], a[24:27], v[28:31]
ds_read_b128 v[112:115], v13 offset:34816
v_mfma_f32_16x16x32_bf16 v[56:59], v[140:143], a[28:31], v[56:59]
v_mfma_f32_16x16x32_bf16 v[32:35], v[144:147], a[24:27], v[32:35]
v_mfma_f32_16x16x32_bf16 v[60:63], v[144:147], a[28:31], v[60:63]
v_mfma_f32_16x16x32_bf16 v[36:39], v[148:151], a[24:27], v[36:39]
buffer_load_dwordx2 v[172:173], v5, s[8:11], s47 offen sc1
v_mfma_f32_16x16x32_bf16 v[64:67], v[148:151], a[28:31], v[64:67]
v_mfma_f32_16x16x32_bf16 v[40:43], v[152:155], a[24:27], v[40:43]
v_mfma_f32_16x16x32_bf16 v[68:71], v[152:155], a[28:31], v[68:71]
s_waitcnt vmcnt(13) lgkmcnt(0)
v_mfma_f32_16x16x32_bf16 v[16:19], v[88:91], a[32:35], v[16:19]
ds_read_b128 v[128:131], v13 offset:35840
v_mfma_f32_16x16x32_bf16 v[44:47], v[88:91], a[36:39], v[44:47]
ds_read_b128 v[132:135], v13 offset:36864
buffer_load_dwordx4 a[80:83], v10, s[8:11], s45 offen offset:2048 sc1
v_mfma_f32_16x16x32_bf16 v[20:23], v[92:95], a[32:35], v[20:23]
ds_read_b128 v[136:139], v13 offset:37888
v_mfma_f32_16x16x32_bf16 v[48:51], v[92:95], a[36:39], v[48:51]
ds_read_b128 v[140:143], v13 offset:38912
v_mfma_f32_16x16x32_bf16 v[24:27], v[96:99], a[32:35], v[24:27]
ds_read_b128 v[144:147], v13 offset:39936
v_mfma_f32_16x16x32_bf16 v[52:55], v[96:99], a[36:39], v[52:55]
ds_read_b128 v[148:151], v13 offset:40960
buffer_load_dwordx4 a[84:87], v11, s[8:11], s45 offen offset:2048 sc1
v_mfma_f32_16x16x32_bf16 v[28:31], v[100:103], a[32:35], v[28:31]
ds_read_b128 v[152:155], v13 offset:41984
v_mfma_f32_16x16x32_bf16 v[56:59], v[100:103], a[36:39], v[56:59]
v_mfma_f32_16x16x32_bf16 v[32:35], v[104:107], a[32:35], v[32:35]
v_mfma_f32_16x16x32_bf16 v[60:63], v[104:107], a[36:39], v[60:63]
v_mfma_f32_16x16x32_bf16 v[36:39], v[108:111], a[32:35], v[36:39]
buffer_load_dwordx2 v[174:175], v5, s[8:11], s47 offen offset:128 sc1
v_mfma_f32_16x16x32_bf16 v[64:67], v[108:111], a[36:39], v[64:67]
v_mfma_f32_16x16x32_bf16 v[40:43], v[112:115], a[32:35], v[40:43]
v_mfma_f32_16x16x32_bf16 v[68:71], v[112:115], a[36:39], v[68:71]
s_waitcnt vmcnt(14) lgkmcnt(0)
v_mfma_f32_16x16x32_bf16 v[16:19], v[128:131], a[40:43], v[16:19]
ds_read_b128 v[88:91], v13 offset:43008
v_mfma_f32_16x16x32_bf16 v[44:47], v[128:131], a[44:47], v[44:47]
ds_read_b128 v[92:95], v13 offset:44032
buffer_load_dwordx4 a[88:91], v10, s[8:11], s45 offen offset:3072 sc1
v_mfma_f32_16x16x32_bf16 v[20:23], v[132:135], a[40:43], v[20:23]
ds_read_b128 v[96:99], v13 offset:45056
v_mfma_f32_16x16x32_bf16 v[48:51], v[132:135], a[44:47], v[48:51]
ds_read_b128 v[100:103], v13 offset:46080
v_mfma_f32_16x16x32_bf16 v[24:27], v[136:139], a[40:43], v[24:27]
ds_read_b128 v[104:107], v13 offset:47104
v_mfma_f32_16x16x32_bf16 v[52:55], v[136:139], a[44:47], v[52:55]
ds_read_b128 v[108:111], v13 offset:48128
v_mfma_f32_16x16x32_bf16 v[28:31], v[140:143], a[40:43], v[28:31]
ds_read_b128 v[112:115], v13 offset:49152
v_mfma_f32_16x16x32_bf16 v[56:59], v[140:143], a[44:47], v[56:59]
v_mfma_f32_16x16x32_bf16 v[32:35], v[144:147], a[40:43], v[32:35]
buffer_load_dwordx4 a[92:95], v11, s[8:11], s45 offen offset:3072 sc1
v_mfma_f32_16x16x32_bf16 v[60:63], v[144:147], a[44:47], v[60:63]
v_mfma_f32_16x16x32_bf16 v[36:39], v[148:151], a[40:43], v[36:39]
v_mfma_f32_16x16x32_bf16 v[64:67], v[148:151], a[44:47], v[64:67]
v_mfma_f32_16x16x32_bf16 v[40:43], v[152:155], a[40:43], v[40:43]
v_mfma_f32_16x16x32_bf16 v[68:71], v[152:155], a[44:47], v[68:71]
s_waitcnt vmcnt(14) lgkmcnt(0)
v_mfma_f32_16x16x32_bf16 v[16:19], v[88:91], a[48:51], v[16:19]
ds_read_b128 v[128:131], v13 offset:50176
v_mfma_f32_16x16x32_bf16 v[44:47], v[88:91], a[52:55], v[44:47]
ds_read_b128 v[132:135], v13 offset:51200
s_add_u32 s45, s45, 4096
buffer_load_dwordx4 a[96:99], v10, s[8:11], s45 offen offset:0 sc1
v_mfma_f32_16x16x32_bf16 v[20:23], v[92:95], a[48:51], v[20:23]
ds_read_b128 v[136:139], v13 offset:52224
v_mfma_f32_16x16x32_bf16 v[48:51], v[92:95], a[52:55], v[48:51]
ds_read_b128 v[140:143], v13 offset:53248
v_mfma_f32_16x16x32_bf16 v[24:27], v[96:99], a[48:51], v[24:27]
ds_read_b128 v[144:147], v13 offset:54272
v_mfma_f32_16x16x32_bf16 v[52:55], v[96:99], a[52:55], v[52:55]
ds_read_b128 v[148:151], v13 offset:55296
v_mfma_f32_16x16x32_bf16 v[28:31], v[100:103], a[48:51], v[28:31]
ds_read_b128 v[152:155], v13 offset:56320
v_mfma_f32_16x16x32_bf16 v[56:59], v[100:103], a[52:55], v[56:59]
v_mfma_f32_16x16x32_bf16 v[32:35], v[104:107], a[48:51], v[32:35]
buffer_load_dwordx4 a[100:103], v11, s[8:11], s45 offen offset:0 sc1
v_mfma_f32_16x16x32_bf16 v[60:63], v[104:107], a[52:55], v[60:63]
v_mfma_f32_16x16x32_bf16 v[36:39], v[108:111], a[48:51], v[36:39]
v_mfma_f32_16x16x32_bf16 v[64:67], v[108:111], a[52:55], v[64:67]
v_mfma_f32_16x16x32_bf16 v[40:43], v[112:115], a[48:51], v[40:43]
v_mfma_f32_16x16x32_bf16 v[68:71], v[112:115], a[52:55], v[68:71]
s_waitcnt vmcnt(14) lgkmcnt(0)
v_mfma_f32_16x16x32_bf16 v[16:19], v[128:131], a[56:59], v[16:19]
ds_read_b128 v[88:91], v13 offset:57344
v_mfma_f32_16x16x32_bf16 v[44:47], v[128:131], a[60:63], v[44:47]
ds_read_b128 v[92:95], v13 offset:58368
buffer_load_dwordx4 a[104:107], v10, s[8:11], s45 offen offset:1024 sc1
v_mfma_f32_16x16x32_bf16 v[20:23], v[132:135], a[56:59], v[20:23]
ds_read_b128 v[96:99], v13 offset:59392
v_mfma_f32_16x16x32_bf16 v[48:51], v[132:135], a[60:63], v[48:51]
ds_read_b128 v[100:103], v13 offset:60416
v_mfma_f32_16x16x32_bf16 v[24:27], v[136:139], a[56:59], v[24:27]
ds_read_b128 v[104:107], v13 offset:61440
v_mfma_f32_16x16x32_bf16 v[52:55], v[136:139], a[60:63], v[52:55]
ds_read_b128 v[108:111], v13 offset:62464
v_mfma_f32_16x16x32_bf16 v[28:31], v[140:143], a[56:59], v[28:31]
ds_read_b128 v[112:115], v13 offset:63488
v_mfma_f32_16x16x32_bf16 v[56:59], v[140:143], a[60:63], v[56:59]
v_mfma_f32_16x16x32_bf16 v[32:35], v[144:147], a[56:59], v[32:35]
buffer_load_dwordx4 a[108:111], v11, s[8:11], s45 offen offset:1024 sc1
v_mfma_f32_16x16x32_bf16 v[60:63], v[144:147], a[60:63], v[60:63]
v_mfma_f32_16x16x32_bf16 v[36:39], v[148:151], a[56:59], v[36:39]
v_mfma_f32_16x16x32_bf16 v[64:67], v[148:151], a[60:63], v[64:67]
v_mfma_f32_16x16x32_bf16 v[40:43], v[152:155], a[56:59], v[40:43]
v_mfma_f32_16x16x32_bf16 v[68:71], v[152:155], a[60:63], v[68:71]
s_waitcnt vmcnt(13) lgkmcnt(0)
v_add_u32 v13, 64512, v13
v_mfma_f32_16x16x32_bf16 v[16:19], v[88:91], a[64:67], v[16:19]
ds_read_b128 v[128:131], v13 offset:0
v_mfma_f32_16x16x32_bf16 v[44:47], v[88:91], a[68:71], v[44:47]
ds_read_b128 v[132:135], v13 offset:1024
buffer_load_dwordx4 a[112:115], v10, s[8:11], s45 offen offset:2048 sc1
v_mfma_f32_16x16x32_bf16 v[20:23], v[92:95], a[64:67], v[20:23]
ds_read_b128 v[136:139], v13 offset:2048
v_mfma_f32_16x16x32_bf16 v[48:51], v[92:95], a[68:71], v[48:51]
ds_read_b128 v[140:143], v13 offset:3072
v_mfma_f32_16x16x32_bf16 v[24:27], v[96:99], a[64:67], v[24:27]
ds_read_b128 v[144:147], v13 offset:4096
v_mfma_f32_16x16x32_bf16 v[52:55], v[96:99], a[68:71], v[52:55]
ds_read_b128 v[148:151], v13 offset:5120
v_mfma_f32_16x16x32_bf16 v[28:31], v[100:103], a[64:67], v[28:31]
ds_read_b128 v[152:155], v13 offset:6144
v_mfma_f32_16x16x32_bf16 v[56:59], v[100:103], a[68:71], v[56:59]
v_mfma_f32_16x16x32_bf16 v[32:35], v[104:107], a[64:67], v[32:35]
buffer_load_dwordx4 a[116:119], v11, s[8:11], s45 offen offset:2048 sc1
v_mfma_f32_16x16x32_bf16 v[60:63], v[104:107], a[68:71], v[60:63]
v_mfma_f32_16x16x32_bf16 v[36:39], v[108:111], a[64:67], v[36:39]
v_mfma_f32_16x16x32_bf16 v[64:67], v[108:111], a[68:71], v[64:67]
v_mfma_f32_16x16x32_bf16 v[40:43], v[112:115], a[64:67], v[40:43]
v_mfma_f32_16x16x32_bf16 v[68:71], v[112:115], a[68:71], v[68:71]
s_waitcnt vmcnt(12) lgkmcnt(0)
v_mfma_f32_16x16x32_bf16 v[16:19], v[128:131], a[72:75], v[16:19]
ds_read_b128 v[88:91], v13 offset:7168
v_mfma_f32_16x16x32_bf16 v[44:47], v[128:131], a[76:79], v[44:47]
ds_read_b128 v[92:95], v13 offset:8192
buffer_load_dwordx4 a[120:123], v10, s[8:11], s45 offen offset:3072 sc1
v_mfma_f32_16x16x32_bf16 v[20:23], v[132:135], a[72:75], v[20:23]
ds_read_b128 v[96:99], v13 offset:9216
v_mfma_f32_16x16x32_bf16 v[48:51], v[132:135], a[76:79], v[48:51]
ds_read_b128 v[100:103], v13 offset:10240
v_mfma_f32_16x16x32_bf16 v[24:27], v[136:139], a[72:75], v[24:27]
ds_read_b128 v[104:107], v13 offset:11264
v_mfma_f32_16x16x32_bf16 v[52:55], v[136:139], a[76:79], v[52:55]
ds_read_b128 v[108:111], v13 offset:12288
v_mfma_f32_16x16x32_bf16 v[28:31], v[140:143], a[72:75], v[28:31]
ds_read_b128 v[112:115], v13 offset:13312
v_mfma_f32_16x16x32_bf16 v[56:59], v[140:143], a[76:79], v[56:59]
v_mfma_f32_16x16x32_bf16 v[32:35], v[144:147], a[72:75], v[32:35]
buffer_load_dwordx4 a[124:127], v11, s[8:11], s45 offen offset:3072 sc1
v_mfma_f32_16x16x32_bf16 v[60:63], v[144:147], a[76:79], v[60:63]
v_mfma_f32_16x16x32_bf16 v[36:39], v[148:151], a[72:75], v[36:39]
v_mfma_f32_16x16x32_bf16 v[64:67], v[148:151], a[76:79], v[64:67]
v_mfma_f32_16x16x32_bf16 v[40:43], v[152:155], a[72:75], v[40:43]
v_mfma_f32_16x16x32_bf16 v[68:71], v[152:155], a[76:79], v[68:71]
s_waitcnt vmcnt(11) lgkmcnt(0)
v_mfma_f32_16x16x32_bf16 v[16:19], v[88:91], a[80:83], v[16:19]
ds_read_b128 v[128:131], v13 offset:14336
v_mfma_f32_16x16x32_bf16 v[44:47], v[88:91], a[84:87], v[44:47]
ds_read_b128 v[132:135], v13 offset:15360
s_add_u32 s45, s45, 4096
buffer_load_dwordx4 a[128:131], v10, s[8:11], s45 offen offset:0 sc1
v_mfma_f32_16x16x32_bf16 v[20:23], v[92:95], a[80:83], v[20:23]
ds_read_b128 v[136:139], v13 offset:16384
v_mfma_f32_16x16x32_bf16 v[48:51], v[92:95], a[84:87], v[48:51]
ds_read_b128 v[140:143], v13 offset:17408
v_mfma_f32_16x16x32_bf16 v[24:27], v[96:99], a[80:83], v[24:27]
ds_read_b128 v[144:147], v13 offset:18432
v_mfma_f32_16x16x32_bf16 v[52:55], v[96:99], a[84:87], v[52:55]
ds_read_b128 v[148:151], v13 offset:19456
v_mfma_f32_16x16x32_bf16 v[28:31], v[100:103], a[80:83], v[28:31]
ds_read_b128 v[152:155], v13 offset:20480
v_mfma_f32_16x16x32_bf16 v[56:59], v[100:103], a[84:87], v[56:59]
v_mfma_f32_16x16x32_bf16 v[32:35], v[104:107], a[80:83], v[32:35]
buffer_load_dwordx4 a[132:135], v11, s[8:11], s45 offen offset:0 sc1
v_mfma_f32_16x16x32_bf16 v[60:63], v[104:107], a[84:87], v[60:63]
v_mfma_f32_16x16x32_bf16 v[36:39], v[108:111], a[80:83], v[36:39]
v_mfma_f32_16x16x32_bf16 v[64:67], v[108:111], a[84:87], v[64:67]
v_mfma_f32_16x16x32_bf16 v[40:43], v[112:115], a[80:83], v[40:43]
v_mfma_f32_16x16x32_bf16 v[68:71], v[112:115], a[84:87], v[68:71]
s_waitcnt vmcnt(10) lgkmcnt(0)
v_mfma_f32_16x16x32_bf16 v[16:19], v[128:131], a[88:91], v[16:19]
ds_read_b128 v[88:91], v13 offset:21504
v_mfma_f32_16x16x32_bf16 v[44:47], v[128:131], a[92:95], v[44:47]
ds_read_b128 v[92:95], v13 offset:22528
buffer_load_dwordx4 a[136:139], v10, s[8:11], s45 offen offset:1024 sc1
v_mfma_f32_16x16x32_bf16 v[20:23], v[132:135], a[88:91], v[20:23]
ds_read_b128 v[96:99], v13 offset:23552
v_mfma_f32_16x16x32_bf16 v[48:51], v[132:135], a[92:95], v[48:51]
ds_read_b128 v[100:103], v13 offset:24576
v_mfma_f32_16x16x32_bf16 v[24:27], v[136:139], a[88:91], v[24:27]
ds_read_b128 v[104:107], v13 offset:25600
v_mfma_f32_16x16x32_bf16 v[52:55], v[136:139], a[92:95], v[52:55]
ds_read_b128 v[108:111], v13 offset:26624
v_mfma_f32_16x16x32_bf16 v[28:31], v[140:143], a[88:91], v[28:31]
ds_read_b128 v[112:115], v13 offset:27648
v_mfma_f32_16x16x32_bf16 v[56:59], v[140:143], a[92:95], v[56:59]
v_add_f32 v168, v168, v170
v_add_f32 v169, v169, v171
v_mfma_f32_16x16x32_bf16 v[32:35], v[144:147], a[88:91], v[32:35]
buffer_load_dwordx4 a[140:143], v11, s[8:11], s45 offen offset:1024 sc1
v_mov_b32 v9, v168
s_nop 1
v_mfma_f32_16x16x32_bf16 v[60:63], v[144:147], a[92:95], v[60:63]
v_permlane32_swap_b32 v168, v9
s_nop 1
v_mfma_f32_16x16x32_bf16 v[36:39], v[148:151], a[88:91], v[36:39]
v_add_f32 v168, v168, v9
v_mov_b32 v9, v168
v_mfma_f32_16x16x32_bf16 v[64:67], v[148:151], a[92:95], v[64:67]
s_nop 1
v_permlane16_swap_b32 v168, v9
v_mfma_f32_16x16x32_bf16 v[40:43], v[152:155], a[88:91], v[40:43]
s_nop 1
v_add_f32 v168, v168, v9
v_mfma_f32_16x16x32_bf16 v[68:71], v[152:155], a[92:95], v[68:71]
v_mov_b32 v9, v169
s_nop 1
s_waitcnt vmcnt(10) lgkmcnt(0)
v_mfma_f32_16x16x32_bf16 v[16:19], v[88:91], a[96:99], v[16:19]
ds_read_b128 v[128:131], v13 offset:28672
v_mfma_f32_16x16x32_bf16 v[44:47], v[88:91], a[100:103], v[44:47]
ds_read_b128 v[132:135], v13 offset:29696
buffer_load_dwordx4 a[144:147], v10, s[8:11], s45 offen offset:2048 sc1
v_mfma_f32_16x16x32_bf16 v[20:23], v[92:95], a[96:99], v[20:23]
ds_read_b128 v[136:139], v13 offset:30720
v_mfma_f32_16x16x32_bf16 v[48:51], v[92:95], a[100:103], v[48:51]
ds_read_b128 v[140:143], v13 offset:31744
v_mfma_f32_16x16x32_bf16 v[24:27], v[96:99], a[96:99], v[24:27]
ds_read_b128 v[144:147], v13 offset:32768
v_mfma_f32_16x16x32_bf16 v[52:55], v[96:99], a[100:103], v[52:55]
ds_read_b128 v[148:151], v13 offset:33792
v_mfma_f32_16x16x32_bf16 v[28:31], v[100:103], a[96:99], v[28:31]
ds_read_b128 v[152:155], v13 offset:34816
v_mfma_f32_16x16x32_bf16 v[56:59], v[100:103], a[100:103], v[56:59]
v_permlane32_swap_b32 v169, v9
s_nop 1
v_mfma_f32_16x16x32_bf16 v[32:35], v[104:107], a[96:99], v[32:35]
buffer_load_dwordx4 a[148:151], v11, s[8:11], s45 offen offset:2048 sc1
v_add_f32 v169, v169, v9
v_mov_b32 v9, v169
v_mfma_f32_16x16x32_bf16 v[60:63], v[104:107], a[100:103], v[60:63]
s_nop 1
v_permlane16_swap_b32 v169, v9
v_mfma_f32_16x16x32_bf16 v[36:39], v[108:111], a[96:99], v[36:39]
s_nop 1
v_add_f32 v169, v169, v9
v_mfma_f32_16x16x32_bf16 v[64:67], v[108:111], a[100:103], v[64:67]
v_mul_f32 v168, 0x3acccccd, v168
v_mul_f32 v169, 0x3acccccd, v169
v_mfma_f32_16x16x32_bf16 v[40:43], v[112:115], a[96:99], v[40:43]
v_fma_f32 v169, -v168, v168, v169
v_max_f32 v169, 0, v169
v_mfma_f32_16x16x32_bf16 v[68:71], v[112:115], a[100:103], v[68:71]
v_add_f32 v169, 0x3727c5ac, v169
v_rsq_f32 v180, v169
s_waitcnt vmcnt(10) lgkmcnt(0)
v_mfma_f32_16x16x32_bf16 v[16:19], v[128:131], a[104:107], v[16:19]
ds_read_b128 v[88:91], v13 offset:35840
v_mfma_f32_16x16x32_bf16 v[44:47], v[128:131], a[108:111], v[44:47]
ds_read_b128 v[92:95], v13 offset:36864
buffer_load_dwordx4 a[152:155], v10, s[8:11], s45 offen offset:3072 sc1
v_mfma_f32_16x16x32_bf16 v[20:23], v[132:135], a[104:107], v[20:23]
ds_read_b128 v[96:99], v13 offset:37888
v_mfma_f32_16x16x32_bf16 v[48:51], v[132:135], a[108:111], v[48:51]
ds_read_b128 v[100:103], v13 offset:38912
v_mfma_f32_16x16x32_bf16 v[24:27], v[136:139], a[104:107], v[24:27]
ds_read_b128 v[104:107], v13 offset:39936
v_mfma_f32_16x16x32_bf16 v[52:55], v[136:139], a[108:111], v[52:55]
ds_read_b128 v[108:111], v13 offset:40960
v_mfma_f32_16x16x32_bf16 v[28:31], v[140:143], a[104:107], v[28:31]
ds_read_b128 v[112:115], v13 offset:41984
v_mfma_f32_16x16x32_bf16 v[56:59], v[140:143], a[108:111], v[56:59]
s_nop 1
v_mul_f32 v186, v168, v180
v_mfma_f32_16x16x32_bf16 v[32:35], v[144:147], a[104:107], v[32:35]
buffer_load_dwordx4 a[156:159], v11, s[8:11], s45 offen offset:3072 sc1
v_sub_f32 v186, 0, v186
v_add_f32 v172, v172, v174
v_mfma_f32_16x16x32_bf16 v[60:63], v[144:147], a[108:111], v[60:63]
v_add_f32 v173, v173, v175
v_mov_b32 v9, v172
v_mfma_f32_16x16x32_bf16 v[36:39], v[148:151], a[104:107], v[36:39]
s_nop 1
v_permlane32_swap_b32 v172, v9
v_mfma_f32_16x16x32_bf16 v[64:67], v[148:151], a[108:111], v[64:67]
s_nop 1
v_add_f32 v172, v172, v9
v_mfma_f32_16x16x32_bf16 v[40:43], v[152:155], a[104:107], v[40:43]
v_mov_b32 v9, v172
s_nop 1
v_mfma_f32_16x16x32_bf16 v[68:71], v[152:155], a[108:111], v[68:71]
v_permlane16_swap_b32 v172, v9
s_nop 1
s_waitcnt vmcnt(10) lgkmcnt(0)
v_mfma_f32_16x16x32_bf16 v[16:19], v[88:91], a[112:115], v[16:19]
ds_read_b128 v[128:131], v13 offset:43008
v_mfma_f32_16x16x32_bf16 v[44:47], v[88:91], a[116:119], v[44:47]
ds_read_b128 v[132:135], v13 offset:44032
v_mfma_f32_16x16x32_bf16 v[20:23], v[92:95], a[112:115], v[20:23]
ds_read_b128 v[136:139], v13 offset:45056
v_mfma_f32_16x16x32_bf16 v[48:51], v[92:95], a[116:119], v[48:51]
ds_read_b128 v[140:143], v13 offset:46080
v_mfma_f32_16x16x32_bf16 v[24:27], v[96:99], a[112:115], v[24:27]
ds_read_b128 v[144:147], v13 offset:47104
v_mfma_f32_16x16x32_bf16 v[52:55], v[96:99], a[116:119], v[52:55]
ds_read_b128 v[148:151], v13 offset:48128
v_mfma_f32_16x16x32_bf16 v[28:31], v[100:103], a[112:115], v[28:31]
ds_read_b128 v[152:155], v13 offset:49152
v_mfma_f32_16x16x32_bf16 v[56:59], v[100:103], a[116:119], v[56:59]
v_add_f32 v172, v172, v9
v_mov_b32 v9, v173
v_mfma_f32_16x16x32_bf16 v[32:35], v[104:107], a[112:115], v[32:35]
s_nop 1
v_permlane32_swap_b32 v173, v9
v_mfma_f32_16x16x32_bf16 v[60:63], v[104:107], a[116:119], v[60:63]
s_nop 1
v_add_f32 v173, v173, v9
v_mfma_f32_16x16x32_bf16 v[36:39], v[108:111], a[112:115], v[36:39]
v_mov_b32 v9, v173
s_nop 1
v_mfma_f32_16x16x32_bf16 v[64:67], v[108:111], a[116:119], v[64:67]
v_permlane16_swap_b32 v173, v9
s_nop 1
v_mfma_f32_16x16x32_bf16 v[40:43], v[112:115], a[112:115], v[40:43]
v_add_f32 v173, v173, v9
v_mul_f32 v172, 0x3acccccd, v172
v_mfma_f32_16x16x32_bf16 v[68:71], v[112:115], a[116:119], v[68:71]
v_mul_f32 v173, 0x3acccccd, v173
v_fma_f32 v173, -v172, v172, v173
s_waitcnt vmcnt(8) lgkmcnt(0)
v_mfma_f32_16x16x32_bf16 v[16:19], v[128:131], a[120:123], v[16:19]
ds_read_b128 v[88:91], v13 offset:50176
v_mfma_f32_16x16x32_bf16 v[44:47], v[128:131], a[124:127], v[44:47]
ds_read_b128 v[92:95], v13 offset:51200
v_mfma_f32_16x16x32_bf16 v[20:23], v[132:135], a[120:123], v[20:23]
ds_read_b128 v[96:99], v13 offset:52224
v_mfma_f32_16x16x32_bf16 v[48:51], v[132:135], a[124:127], v[48:51]
ds_read_b128 v[100:103], v13 offset:53248
v_mfma_f32_16x16x32_bf16 v[24:27], v[136:139], a[120:123], v[24:27]
ds_read_b128 v[104:107], v13 offset:54272
v_mfma_f32_16x16x32_bf16 v[52:55], v[136:139], a[124:127], v[52:55]
ds_read_b128 v[108:111], v13 offset:55296
v_mfma_f32_16x16x32_bf16 v[28:31], v[140:143], a[120:123], v[28:31]
ds_read_b128 v[112:115], v13 offset:56320
v_mfma_f32_16x16x32_bf16 v[56:59], v[140:143], a[124:127], v[56:59]
v_max_f32 v173, 0, v173
v_add_f32 v173, 0x3727c5ac, v173
v_mfma_f32_16x16x32_bf16 v[32:35], v[144:147], a[120:123], v[32:35]
v_rsq_f32 v182, v173
s_nop 1
v_mfma_f32_16x16x32_bf16 v[60:63], v[144:147], a[124:127], v[60:63]
v_mul_f32 v188, v172, v182
v_sub_f32 v188, 0, v188
v_mfma_f32_16x16x32_bf16 v[36:39], v[148:151], a[120:123], v[36:39]
v_mfma_f32_16x16x32_bf16 v[64:67], v[148:151], a[124:127], v[64:67]
v_mfma_f32_16x16x32_bf16 v[40:43], v[152:155], a[120:123], v[40:43]
v_mfma_f32_16x16x32_bf16 v[68:71], v[152:155], a[124:127], v[68:71]
s_waitcnt vmcnt(6) lgkmcnt(0)
v_mfma_f32_16x16x32_bf16 v[16:19], v[88:91], a[128:131], v[16:19]
ds_read_b128 v[128:131], v13 offset:57344
v_mfma_f32_16x16x32_bf16 v[44:47], v[88:91], a[132:135], v[44:47]
ds_read_b128 v[132:135], v13 offset:58368
v_mfma_f32_16x16x32_bf16 v[20:23], v[92:95], a[128:131], v[20:23]
ds_read_b128 v[136:139], v13 offset:59392
v_mfma_f32_16x16x32_bf16 v[48:51], v[92:95], a[132:135], v[48:51]
ds_read_b128 v[140:143], v13 offset:60416
v_mfma_f32_16x16x32_bf16 v[24:27], v[96:99], a[128:131], v[24:27]
ds_read_b128 v[144:147], v13 offset:61440
v_mfma_f32_16x16x32_bf16 v[52:55], v[96:99], a[132:135], v[52:55]
ds_read_b128 v[148:151], v13 offset:62464
v_mfma_f32_16x16x32_bf16 v[28:31], v[100:103], a[128:131], v[28:31]
ds_read_b128 v[152:155], v13 offset:63488
v_mfma_f32_16x16x32_bf16 v[56:59], v[100:103], a[132:135], v[56:59]
v_mfma_f32_16x16x32_bf16 v[32:35], v[104:107], a[128:131], v[32:35]
v_mfma_f32_16x16x32_bf16 v[60:63], v[104:107], a[132:135], v[60:63]
v_mfma_f32_16x16x32_bf16 v[36:39], v[108:111], a[128:131], v[36:39]
v_mfma_f32_16x16x32_bf16 v[64:67], v[108:111], a[132:135], v[64:67]
v_mfma_f32_16x16x32_bf16 v[40:43], v[112:115], a[128:131], v[40:43]
v_mfma_f32_16x16x32_bf16 v[68:71], v[112:115], a[132:135], v[68:71]
s_waitcnt vmcnt(4) lgkmcnt(0)
v_add_u32 v13, 64512, v13
v_mfma_f32_16x16x32_bf16 v[16:19], v[128:131], a[136:139], v[16:19]
ds_read_b128 v[88:91], v13 offset:0
v_mfma_f32_16x16x32_bf16 v[44:47], v[128:131], a[140:143], v[44:47]
ds_read_b128 v[92:95], v13 offset:1024
v_mfma_f32_16x16x32_bf16 v[20:23], v[132:135], a[136:139], v[20:23]
ds_read_b128 v[96:99], v13 offset:2048
v_mfma_f32_16x16x32_bf16 v[48:51], v[132:135], a[140:143], v[48:51]
ds_read_b128 v[100:103], v13 offset:3072
v_mfma_f32_16x16x32_bf16 v[24:27], v[136:139], a[136:139], v[24:27]
ds_read_b128 v[104:107], v13 offset:4096
v_mfma_f32_16x16x32_bf16 v[52:55], v[136:139], a[140:143], v[52:55]
ds_read_b128 v[108:111], v13 offset:5120
v_mfma_f32_16x16x32_bf16 v[28:31], v[140:143], a[136:139], v[28:31]
ds_read_b128 v[112:115], v13 offset:6144
v_mfma_f32_16x16x32_bf16 v[56:59], v[140:143], a[140:143], v[56:59]
v_mfma_f32_16x16x32_bf16 v[32:35], v[144:147], a[136:139], v[32:35]
v_mfma_f32_16x16x32_bf16 v[60:63], v[144:147], a[140:143], v[60:63]
v_mfma_f32_16x16x32_bf16 v[36:39], v[148:151], a[136:139], v[36:39]
v_mfma_f32_16x16x32_bf16 v[64:67], v[148:151], a[140:143], v[64:67]
v_mfma_f32_16x16x32_bf16 v[40:43], v[152:155], a[136:139], v[40:43]
v_mfma_f32_16x16x32_bf16 v[68:71], v[152:155], a[140:143], v[68:71]
s_waitcnt vmcnt(2) lgkmcnt(0)
v_mfma_f32_16x16x32_bf16 v[16:19], v[88:91], a[144:147], v[16:19]
ds_read_b128 v[128:131], v13 offset:7168
v_mfma_f32_16x16x32_bf16 v[44:47], v[88:91], a[148:151], v[44:47]
ds_read_b128 v[132:135], v13 offset:8192
v_mfma_f32_16x16x32_bf16 v[20:23], v[92:95], a[144:147], v[20:23]
ds_read_b128 v[136:139], v13 offset:9216
v_mfma_f32_16x16x32_bf16 v[48:51], v[92:95], a[148:151], v[48:51]
ds_read_b128 v[140:143], v13 offset:10240
v_mfma_f32_16x16x32_bf16 v[24:27], v[96:99], a[144:147], v[24:27]
ds_read_b128 v[144:147], v13 offset:11264
v_mfma_f32_16x16x32_bf16 v[52:55], v[96:99], a[148:151], v[52:55]
ds_read_b128 v[148:151], v13 offset:12288
v_mfma_f32_16x16x32_bf16 v[28:31], v[100:103], a[144:147], v[28:31]
ds_read_b128 v[152:155], v13 offset:13312
v_mfma_f32_16x16x32_bf16 v[56:59], v[100:103], a[148:151], v[56:59]
v_mfma_f32_16x16x32_bf16 v[32:35], v[104:107], a[144:147], v[32:35]
v_mfma_f32_16x16x32_bf16 v[60:63], v[104:107], a[148:151], v[60:63]
v_mfma_f32_16x16x32_bf16 v[36:39], v[108:111], a[144:147], v[36:39]
v_mfma_f32_16x16x32_bf16 v[64:67], v[108:111], a[148:151], v[64:67]
v_mfma_f32_16x16x32_bf16 v[40:43], v[112:115], a[144:147], v[40:43]
v_mfma_f32_16x16x32_bf16 v[68:71], v[112:115], a[148:151], v[68:71]
s_waitcnt vmcnt(0) lgkmcnt(0)
v_mfma_f32_16x16x32_bf16 v[16:19], v[128:131], a[152:155], v[16:19]
v_mfma_f32_16x16x32_bf16 v[44:47], v[128:131], a[156:159], v[44:47]
v_mfma_f32_16x16x32_bf16 v[20:23], v[132:135], a[152:155], v[20:23]
v_mfma_f32_16x16x32_bf16 v[48:51], v[132:135], a[156:159], v[48:51]
v_mfma_f32_16x16x32_bf16 v[24:27], v[136:139], a[152:155], v[24:27]
v_mfma_f32_16x16x32_bf16 v[52:55], v[136:139], a[156:159], v[52:55]
v_mfma_f32_16x16x32_bf16 v[28:31], v[140:143], a[152:155], v[28:31]
v_mfma_f32_16x16x32_bf16 v[56:59], v[140:143], a[156:159], v[56:59]
v_mfma_f32_16x16x32_bf16 v[32:35], v[144:147], a[152:155], v[32:35]
v_mfma_f32_16x16x32_bf16 v[60:63], v[144:147], a[156:159], v[60:63]
v_mfma_f32_16x16x32_bf16 v[36:39], v[148:151], a[152:155], v[36:39]
v_mfma_f32_16x16x32_bf16 v[64:67], v[148:151], a[156:159], v[64:67]
v_mfma_f32_16x16x32_bf16 v[40:43], v[152:155], a[152:155], v[40:43]
v_mfma_f32_16x16x32_bf16 v[68:71], v[152:155], a[156:159], v[68:71]
s_waitcnt vmcnt(0)
s_nop 7
v_pk_mul_f32 v[16:17], v[16:17], v[180:181] op_sel_hi:[1,0]
v_pk_mul_f32 v[18:19], v[18:19], v[180:181] op_sel_hi:[1,0]
v_pk_fma_f32 v[16:17], v[192:193], v[186:187], v[16:17] op_sel_hi:[1,0,1]
v_pk_fma_f32 v[18:19], v[194:195], v[186:187], v[18:19] op_sel_hi:[1,0,1]
v_pk_mul_f32 v[20:21], v[20:21], v[180:181] op_sel_hi:[1,0]
v_pk_mul_f32 v[22:23], v[22:23], v[180:181] op_sel_hi:[1,0]
v_pk_fma_f32 v[20:21], v[196:197], v[186:187], v[20:21] op_sel_hi:[1,0,1]
v_pk_fma_f32 v[22:23], v[198:199], v[186:187], v[22:23] op_sel_hi:[1,0,1]
v_pk_mul_f32 v[24:25], v[24:25], v[180:181] op_sel_hi:[1,0]
v_pk_mul_f32 v[26:27], v[26:27], v[180:181] op_sel_hi:[1,0]
v_pk_fma_f32 v[24:25], v[200:201], v[186:187], v[24:25] op_sel_hi:[1,0,1]
v_pk_fma_f32 v[26:27], v[202:203], v[186:187], v[26:27] op_sel_hi:[1,0,1]
v_pk_mul_f32 v[28:29], v[28:29], v[180:181] op_sel_hi:[1,0]
v_pk_mul_f32 v[30:31], v[30:31], v[180:181] op_sel_hi:[1,0]
v_pk_fma_f32 v[28:29], v[204:205], v[186:187], v[28:29] op_sel_hi:[1,0,1]
v_pk_fma_f32 v[30:31], v[206:207], v[186:187], v[30:31] op_sel_hi:[1,0,1]
v_pk_mul_f32 v[32:33], v[32:33], v[180:181] op_sel_hi:[1,0]
v_pk_mul_f32 v[34:35], v[34:35], v[180:181] op_sel_hi:[1,0]
v_pk_fma_f32 v[32:33], v[208:209], v[186:187], v[32:33] op_sel_hi:[1,0,1]
v_pk_fma_f32 v[34:35], v[210:211], v[186:187], v[34:35] op_sel_hi:[1,0,1]
v_pk_mul_f32 v[36:37], v[36:37], v[180:181] op_sel_hi:[1,0]
v_pk_mul_f32 v[38:39], v[38:39], v[180:181] op_sel_hi:[1,0]
v_pk_fma_f32 v[36:37], v[212:213], v[186:187], v[36:37] op_sel_hi:[1,0,1]
v_pk_fma_f32 v[38:39], v[214:215], v[186:187], v[38:39] op_sel_hi:[1,0,1]
v_pk_mul_f32 v[40:41], v[40:41], v[180:181] op_sel_hi:[1,0]
v_pk_mul_f32 v[42:43], v[42:43], v[180:181] op_sel_hi:[1,0]
v_pk_fma_f32 v[40:41], v[216:217], v[186:187], v[40:41] op_sel_hi:[1,0,1]
v_pk_fma_f32 v[42:43], v[218:219], v[186:187], v[42:43] op_sel_hi:[1,0,1]
v_pk_mul_f32 v[44:45], v[44:45], v[182:183] op_sel_hi:[1,0]
v_pk_mul_f32 v[46:47], v[46:47], v[182:183] op_sel_hi:[1,0]
v_pk_fma_f32 v[44:45], v[192:193], v[188:189], v[44:45] op_sel_hi:[1,0,1]
v_pk_fma_f32 v[46:47], v[194:195], v[188:189], v[46:47] op_sel_hi:[1,0,1]
v_pk_mul_f32 v[48:49], v[48:49], v[182:183] op_sel_hi:[1,0]
v_pk_mul_f32 v[50:51], v[50:51], v[182:183] op_sel_hi:[1,0]
v_pk_fma_f32 v[48:49], v[196:197], v[188:189], v[48:49] op_sel_hi:[1,0,1]
v_pk_fma_f32 v[50:51], v[198:199], v[188:189], v[50:51] op_sel_hi:[1,0,1]
v_pk_mul_f32 v[52:53], v[52:53], v[182:183] op_sel_hi:[1,0]
v_pk_mul_f32 v[54:55], v[54:55], v[182:183] op_sel_hi:[1,0]
v_pk_fma_f32 v[52:53], v[200:201], v[188:189], v[52:53] op_sel_hi:[1,0,1]
v_pk_fma_f32 v[54:55], v[202:203], v[188:189], v[54:55] op_sel_hi:[1,0,1]
v_pk_mul_f32 v[56:57], v[56:57], v[182:183] op_sel_hi:[1,0]
v_pk_mul_f32 v[58:59], v[58:59], v[182:183] op_sel_hi:[1,0]
v_pk_fma_f32 v[56:57], v[204:205], v[188:189], v[56:57] op_sel_hi:[1,0,1]
v_pk_fma_f32 v[58:59], v[206:207], v[188:189], v[58:59] op_sel_hi:[1,0,1]
v_pk_mul_f32 v[60:61], v[60:61], v[182:183] op_sel_hi:[1,0]
v_pk_mul_f32 v[62:63], v[62:63], v[182:183] op_sel_hi:[1,0]
v_pk_fma_f32 v[60:61], v[208:209], v[188:189], v[60:61] op_sel_hi:[1,0,1]
v_pk_fma_f32 v[62:63], v[210:211], v[188:189], v[62:63] op_sel_hi:[1,0,1]
v_pk_mul_f32 v[64:65], v[64:65], v[182:183] op_sel_hi:[1,0]
v_pk_mul_f32 v[66:67], v[66:67], v[182:183] op_sel_hi:[1,0]
v_pk_fma_f32 v[64:65], v[212:213], v[188:189], v[64:65] op_sel_hi:[1,0,1]
v_pk_fma_f32 v[66:67], v[214:215], v[188:189], v[66:67] op_sel_hi:[1,0,1]
v_pk_mul_f32 v[68:69], v[68:69], v[182:183] op_sel_hi:[1,0]
v_pk_mul_f32 v[70:71], v[70:71], v[182:183] op_sel_hi:[1,0]
v_pk_fma_f32 v[68:69], v[216:217], v[188:189], v[68:69] op_sel_hi:[1,0,1]
v_pk_fma_f32 v[70:71], v[218:219], v[188:189], v[70:71] op_sel_hi:[1,0,1]
s_and_b32 s24, s5, 1
s_mul_i32 s25, s5, 7
s_add_u32 s26, s25, s24
s_lshr_b32 s26, s26, 1
s_xor_b32 s27, s24, 1
s_mul_i32 s27, s27, 6
s_add_u32 s27, s27, s25
s_lshr_b32 s27, s27, 1
s_lshl_b32 s26, s26, 10
s_lshl_b32 s27, s27, 10
s_lshl_b32 s24, s24, 3
s_add_u32 s27, s27, s24
s_mul_i32 s28, s32, 57344
s_add_u32 s28, s28, 44040192
s_add_u32 s29, s28, s27
s_add_u32 s28, s28, s26
v_max_f32 v16, 0, v16
v_max_f32 v17, 0, v17
v_max_f32 v18, 0, v18
v_max_f32 v19, 0, v19
v_max_f32 v20, 0, v20
v_max_f32 v21, 0, v21
v_max_f32 v22, 0, v22
v_max_f32 v23, 0, v23
v_max_f32 v24, 0, v24
v_max_f32 v25, 0, v25
v_max_f32 v26, 0, v26
v_max_f32 v27, 0, v27
v_max_f32 v28, 0, v28
v_max_f32 v29, 0, v29
v_max_f32 v30, 0, v30
v_max_f32 v31, 0, v31
v_max_f32 v32, 0, v32
v_max_f32 v33, 0, v33
v_max_f32 v34, 0, v34
v_max_f32 v35, 0, v35
v_max_f32 v36, 0, v36
v_max_f32 v37, 0, v37
v_max_f32 v38, 0, v38
v_max_f32 v39, 0, v39
v_max_f32 v40, 0, v40
v_max_f32 v41, 0, v41
v_max_f32 v42, 0, v42
v_max_f32 v43, 0, v43
v_cvt_pk_bf16_f32 v88, v16, v17
v_cvt_pk_bf16_f32 v89, v18, v19
v_cvt_pk_bf16_f32 v90, v20, v21
v_cvt_pk_bf16_f32 v91, v22, v23
v_cvt_pk_bf16_f32 v92, v24, v25
v_cvt_pk_bf16_f32 v93, v26, v27
v_cvt_pk_bf16_f32 v94, v28, v29
v_cvt_pk_bf16_f32 v95, v30, v31
v_cvt_pk_bf16_f32 v96, v32, v33
v_cvt_pk_bf16_f32 v97, v34, v35
v_cvt_pk_bf16_f32 v98, v36, v37
v_cvt_pk_bf16_f32 v99, v38, v39
v_cvt_pk_bf16_f32 v100, v40, v41
v_cvt_pk_bf16_f32 v101, v42, v43
buffer_store_dwordx4 v[88:91], v2, s[8:11], s28 offen offset:0 sc1
buffer_store_dwordx4 v[92:95], v2, s[8:11], s28 offen offset:1024 sc1
buffer_store_dwordx4 v[96:99], v2, s[8:11], s28 offen offset:2048 sc1
buffer_store_dwordx2 v[100:101], v2, s[8:11], s29 offen sc1
s_mul_i32 s28, s33, 57344
s_add_u32 s28, s28, 44040192
s_add_u32 s29, s28, s27
s_add_u32 s28, s28, s26
v_max_f32 v44, 0, v44
v_max_f32 v45, 0, v45
v_max_f32 v46, 0, v46
v_max_f32 v47, 0, v47
v_max_f32 v48, 0, v48
v_max_f32 v49, 0, v49
v_max_f32 v50, 0, v50
v_max_f32 v51, 0, v51
v_max_f32 v52, 0, v52
v_max_f32 v53, 0, v53
v_max_f32 v54, 0, v54
v_max_f32 v55, 0, v55
v_max_f32 v56, 0, v56
v_max_f32 v57, 0, v57
v_max_f32 v58, 0, v58
v_max_f32 v59, 0, v59
v_max_f32 v60, 0, v60
v_max_f32 v61, 0, v61
v_max_f32 v62, 0, v62
v_max_f32 v63, 0, v63
v_max_f32 v64, 0, v64
v_max_f32 v65, 0, v65
v_max_f32 v66, 0, v66
v_max_f32 v67, 0, v67
v_max_f32 v68, 0, v68
v_max_f32 v69, 0, v69
v_max_f32 v70, 0, v70
v_max_f32 v71, 0, v71
v_cvt_pk_bf16_f32 v104, v44, v45
v_cvt_pk_bf16_f32 v105, v46, v47
v_cvt_pk_bf16_f32 v106, v48, v49
v_cvt_pk_bf16_f32 v107, v50, v51
v_cvt_pk_bf16_f32 v108, v52, v53
v_cvt_pk_bf16_f32 v109, v54, v55
v_cvt_pk_bf16_f32 v110, v56, v57
v_cvt_pk_bf16_f32 v111, v58, v59
v_cvt_pk_bf16_f32 v112, v60, v61
v_cvt_pk_bf16_f32 v113, v62, v63
v_cvt_pk_bf16_f32 v114, v64, v65
v_cvt_pk_bf16_f32 v115, v66, v67
v_cvt_pk_bf16_f32 v116, v68, v69
v_cvt_pk_bf16_f32 v117, v70, v71
buffer_store_dwordx4 v[104:107], v2, s[8:11], s28 offen offset:0 sc1
buffer_store_dwordx4 v[108:111], v2, s[8:11], s28 offen offset:1024 sc1
buffer_store_dwordx4 v[112:115], v2, s[8:11], s28 offen offset:2048 sc1
buffer_store_dwordx2 v[116:117], v2, s[8:11], s29 offen sc1
s_lshr_b32 s30, s89, 1
s_mul_i32 s32, s30, 286720
s_mul_i32 s33, s6, 71680
s_add_u32 s32, s32, s33
s_add_u32 s32, s32, 7340032
s_add_u32 s33, s32, 0
buffer_load_dwordx4 a[0:3], v2, s[8:11], s33 offen offset:0
s_add_u32 s33, s32, 0
buffer_load_dwordx4 a[4:7], v2, s[8:11], s33 offen offset:1024
s_add_u32 s33, s32, 0
buffer_load_dwordx4 a[8:11], v2, s[8:11], s33 offen offset:2048
s_add_u32 s33, s32, 0
buffer_load_dwordx4 a[12:15], v2, s[8:11], s33 offen offset:3072
s_add_u32 s33, s32, 4096
buffer_load_dwordx4 a[16:19], v2, s[8:11], s33 offen offset:0
s_add_u32 s33, s32, 4096
buffer_load_dwordx4 a[20:23], v2, s[8:11], s33 offen offset:1024
s_add_u32 s33, s32, 4096
buffer_load_dwordx4 a[24:27], v2, s[8:11], s33 offen offset:2048
s_add_u32 s33, s32, 4096
buffer_load_dwordx4 a[28:31], v2, s[8:11], s33 offen offset:3072
s_add_u32 s33, s32, 8192
buffer_load_dwordx4 a[32:35], v2, s[8:11], s33 offen offset:0
s_add_u32 s33, s32, 8192
buffer_load_dwordx4 a[36:39], v2, s[8:11], s33 offen offset:1024
s_add_u32 s33, s32, 8192
buffer_load_dwordx4 a[40:43], v2, s[8:11], s33 offen offset:2048
s_add_u32 s33, s32, 8192
buffer_load_dwordx4 a[44:47], v2, s[8:11], s33 offen offset:3072
s_add_u32 s33, s32, 12288
buffer_load_dwordx4 a[48:51], v2, s[8:11], s33 offen offset:0
s_add_u32 s33, s32, 12288
buffer_load_dwordx4 a[52:55], v2, s[8:11], s33 offen offset:1024
s_add_u32 s33, s32, 12288
buffer_load_dwordx4 a[56:59], v2, s[8:11], s33 offen offset:2048
s_add_u32 s33, s32, 12288
buffer_load_dwordx4 a[60:63], v2, s[8:11], s33 offen offset:3072
s_add_u32 s33, s32, 16384
buffer_load_dwordx4 a[64:67], v2, s[8:11], s33 offen offset:0
s_add_u32 s33, s32, 16384
buffer_load_dwordx4 a[68:71], v2, s[8:11], s33 offen offset:1024
s_add_u32 s33, s32, 16384
buffer_load_dwordx4 a[72:75], v2, s[8:11], s33 offen offset:2048
s_add_u32 s33, s32, 16384
buffer_load_dwordx4 a[76:79], v2, s[8:11], s33 offen offset:3072
s_waitcnt vmcnt(20)
s_barrier
s_cmp_lg_u32 s6, 0
s_cbranch_scc1 L_ar_47
v_mov_b32 v8, 1
v_mov_b32 v9, s20
s_mov_b64 exec, 1
buffer_atomic_add v8, v9, s[8:11], 0 offen sc1
s_mov_b64 exec, -1
L_ar_47:
s_mov_b32 s4, s88
s_mov_b32 s5, s89
s_mov_b32 s20, s90
s_lshr_b32 s30, s5, 1
s_and_b32 s31, s5, 1
s_add_u32 s33, s32, 20480
buffer_load_dwordx4 a[80:83], v2, s[8:11], s33 offen offset:0
s_add_u32 s33, s32, 20480
buffer_load_dwordx4 a[84:87], v2, s[8:11], s33 offen offset:1024
s_add_u32 s33, s32, 20480
buffer_load_dwordx4 a[88:91], v2, s[8:11], s33 offen offset:2048
s_add_u32 s33, s32, 20480
buffer_load_dwordx4 a[92:95], v2, s[8:11], s33 offen offset:3072
s_add_u32 s33, s32, 24576
buffer_load_dwordx4 a[96:99], v2, s[8:11], s33 offen offset:0
s_add_u32 s33, s32, 24576
buffer_load_dwordx4 a[100:103], v2, s[8:11], s33 offen offset:1024
s_add_u32 s33, s32, 24576
buffer_load_dwordx4 a[104:107], v2, s[8:11], s33 offen offset:2048
s_add_u32 s33, s32, 24576
buffer_load_dwordx4 a[108:111], v2, s[8:11], s33 offen offset:3072
s_add_u32 s33, s32, 28672
buffer_load_dwordx4 a[112:115], v2, s[8:11], s33 offen offset:0
s_add_u32 s33, s32, 28672
buffer_load_dwordx4 a[116:119], v2, s[8:11], s33 offen offset:1024
s_add_u32 s33, s32, 28672
buffer_load_dwordx4 a[120:123], v2, s[8:11], s33 offen offset:2048
s_add_u32 s33, s32, 28672
buffer_load_dwordx4 a[124:127], v2, s[8:11], s33 offen offset:3072
s_add_u32 s33, s32, 32768
buffer_load_dwordx4 a[128:131], v2, s[8:11], s33 offen offset:0
s_add_u32 s33, s32, 32768
buffer_load_dwordx4 a[132:135], v2, s[8:11], s33 offen offset:1024
s_add_u32 s33, s32, 32768
buffer_load_dwordx4 a[136:139], v2, s[8:11], s33 offen offset:2048
s_add_u32 s33, s32, 32768
buffer_load_dwordx4 a[140:143], v2, s[8:11], s33 offen offset:3072
s_add_u32 s33, s32, 36864
buffer_load_dwordx4 a[144:147], v2, s[8:11], s33 offen offset:0
s_add_u32 s33, s32, 36864
buffer_load_dwordx4 a[148:151], v2, s[8:11], s33 offen offset:1024
s_add_u32 s33, s32, 36864
buffer_load_dwordx4 a[152:155], v2, s[8:11], s33 offen offset:2048
s_add_u32 s33, s32, 36864
buffer_load_dwordx4 a[156:159], v2, s[8:11], s33 offen offset:3072
s_add_u32 s33, s32, 40960
buffer_load_dwordx4 a[160:163], v2, s[8:11], s33 offen offset:0
s_add_u32 s33, s32, 40960
buffer_load_dwordx4 a[164:167], v2, s[8:11], s33 offen offset:1024
s_add_u32 s33, s32, 40960
buffer_load_dwordx4 a[168:171], v2, s[8:11], s33 offen offset:2048
s_add_u32 s33, s32, 40960
buffer_load_dwordx4 a[172:175], v2, s[8:11], s33 offen offset:3072
s_add_u32 s33, s32, 45056
buffer_load_dwordx4 a[176:179], v2, s[8:11], s33 offen offset:0
s_add_u32 s33, s32, 45056
buffer_load_dwordx4 a[180:183], v2, s[8:11], s33 offen offset:1024
s_add_u32 s33, s32, 45056
buffer_load_dwordx4 a[184:187], v2, s[8:11], s33 offen offset:2048
s_add_u32 s33, s32, 45056
buffer_load_dwordx4 a[188:191], v2, s[8:11], s33 offen offset:3072
s_add_u32 s33, s32, 49152
buffer_load_dwordx4 a[192:195], v2, s[8:11], s33 offen offset:0
s_add_u32 s33, s32, 49152
buffer_load_dwordx4 a[196:199], v2, s[8:11], s33 offen offset:1024
s_add_u32 s33, s32, 49152
buffer_load_dwordx4 a[200:203], v2, s[8:11], s33 offen offset:2048
s_add_u32 s33, s32, 49152
buffer_load_dwordx4 a[204:207], v2, s[8:11], s33 offen offset:3072
s_add_u32 s33, s32, 53248
buffer_load_dwordx4 a[208:211], v2, s[8:11], s33 offen offset:0
s_add_u32 s33, s32, 53248
buffer_load_dwordx4 a[212:215], v2, s[8:11], s33 offen offset:1024
s_add_u32 s33, s32, 53248
buffer_load_dwordx4 a[216:219], v2, s[8:11], s33 offen offset:2048
s_add_u32 s33, s32, 53248
buffer_load_dwordx4 a[220:223], v2, s[8:11], s33 offen offset:3072
s_add_u32 s33, s32, 57344
buffer_load_dwordx4 a[224:227], v2, s[8:11], s33 offen offset:0
s_add_u32 s33, s32, 57344
buffer_load_dwordx4 a[228:231], v2, s[8:11], s33 offen offset:1024
s_add_u32 s33, s32, 57344
buffer_load_dwordx4 a[232:235], v2, s[8:11], s33 offen offset:2048
s_add_u32 s33, s32, 57344
buffer_load_dwordx4 a[236:239], v2, s[8:11], s33 offen offset:3072
s_add_u32 s33, s32, 61440
buffer_load_dwordx4 a[240:243], v2, s[8:11], s33 offen offset:0
s_add_u32 s33, s32, 61440
buffer_load_dwordx4 a[244:247], v2, s[8:11], s33 offen offset:1024
s_add_u32 s33, s32, 61440
buffer_load_dwordx4 a[248:251], v2, s[8:11], s33 offen offset:2048
s_add_u32 s33, s32, 61440
buffer_load_dwordx4 a[252:255], v2, s[8:11], s33 offen offset:3072
s_add_u32 s33, s32, 65536
buffer_load_dwordx4 v[96:99], v2, s[8:11], s33 offen offset:0
s_cmp_lg_u32 s6, 0
s_cbranch_scc1 L_pl_48
v_mov_b32 v9, s20
s_mov_b64 exec, 1
s_mov_b32 s21, 112
s_mov_b32 s22, 0
L_lp_49:
buffer_load_dword v6, v9, s[8:11], 0 offen sc1
s_waitcnt vmcnt(0)
v_cmp_gt_u32 vcc, s21, v6
s_cbranch_vccz L_dn_50
s_add_u32 s22, s22, 1
s_cmp_lt_u32 s22, 40000
s_cbranch_scc1 L_lp_49
L_dn_50:
s_mov_b64 exec, -1
L_pl_48:
s_barrier
s_lshl_b32 s34, s4, 3
s_lshl_b32 s35, s31, 2
s_add_u32 s34, s34, s35
s_add_u32 s35, s6, 0
s_and_b32 s35, s35, 3
s_add_u32 s35, s35, s34
s_mov_b32 s36, s35
s_mul_i32 s35, s35, 57344
v_add_u32 v232, s35, v2
s_add_u32 s35, s6, 1
s_and_b32 s35, s35, 3
s_add_u32 s35, s35, s34
s_mul_i32 s35, s35, 57344
v_add_u32 v233, s35, v2
s_add_u32 s35, s6, 2
s_and_b32 s35, s35, 3
s_add_u32 s35, s35, s34
s_mul_i32 s35, s35, 57344
v_add_u32 v234, s35, v2
s_add_u32 s35, s6, 3
s_and_b32 s35, s35, 3
s_add_u32 s35, s35, s34
s_mul_i32 s35, s35, 57344
v_add_u32 v235, s35, v2
s_mul_i32 s37, s6, 14336
s_add_u32 s37, s37, 44040192
buffer_load_dwordx4 v[120:123], v232, s[8:11], s37 offen offset:0 sc1
buffer_load_dwordx4 v[124:127], v233, s[8:11], s37 offen offset:0 sc1
buffer_load_dwordx4 v[128:131], v234, s[8:11], s37 offen offset:0 sc1
buffer_load_dwordx4 v[132:135], v235, s[8:11], s37 offen offset:0 sc1
buffer_load_dwordx4 v[136:139], v232, s[8:11], s37 offen offset:1024 sc1
buffer_load_dwordx4 v[140:143], v233, s[8:11], s37 offen offset:1024 sc1
buffer_load_dwordx4 v[144:147], v234, s[8:11], s37 offen offset:1024 sc1
buffer_load_dwordx4 v[148:151], v235, s[8:11], s37 offen offset:1024 sc1
buffer_load_dwordx4 v[152:155], v232, s[8:11], s37 offen offset:2048 sc1
buffer_load_dwordx4 v[156:159], v233, s[8:11], s37 offen offset:2048 sc1
buffer_load_dwordx4 v[160:163], v234, s[8:11], s37 offen offset:2048 sc1
buffer_load_dwordx4 v[164:167], v235, s[8:11], s37 offen offset:2048 sc1
buffer_load_dwordx4 v[168:171], v232, s[8:11], s37 offen offset:3072 sc1
buffer_load_dwordx4 v[172:175], v233, s[8:11], s37 offen offset:3072 sc1
buffer_load_dwordx4 v[176:179], v234, s[8:11], s37 offen offset:3072 sc1
buffer_load_dwordx4 v[180:183], v235, s[8:11], s37 offen offset:3072 sc1
s_add_u32 s37, s37, 4096
buffer_load_dwordx4 v[184:187], v232, s[8:11], s37 offen offset:0 sc1
buffer_load_dwordx4 v[188:191], v233, s[8:11], s37 offen offset:0 sc1
buffer_load_dwordx4 v[192:195], v234, s[8:11], s37 offen offset:0 sc1
buffer_load_dwordx4 v[196:199], v235, s[8:11], s37 offen offset:0 sc1
buffer_load_dwordx4 v[200:203], v232, s[8:11], s37 offen offset:1024 sc1
buffer_load_dwordx4 v[204:207], v233, s[8:11], s37 offen offset:1024 sc1
buffer_load_dwordx4 v[208:211], v234, s[8:11], s37 offen offset:1024 sc1
buffer_load_dwordx4 v[212:215], v235, s[8:11], s37 offen offset:1024 sc1
buffer_load_dwordx4 v[216:219], v232, s[8:11], s37 offen offset:2048 sc1
buffer_load_dwordx4 v[220:223], v233, s[8:11], s37 offen offset:2048 sc1
buffer_load_dwordx4 v[224:227], v234, s[8:11], s37 offen offset:2048 sc1
buffer_load_dwordx4 v[228:231], v235, s[8:11], s37 offen offset:2048 sc1
s_and_b32 s38, s30, 1
s_mul_i32 s39, s30, 5
s_add_u32 s40, s39, s38
s_lshr_b32 s40, s40, 1
s_xor_b32 s41, s38, 1
s_lshl_b32 s41, s41, 2
s_add_u32 s41, s41, s39
s_lshr_b32 s41, s41, 1
s_lshl_b32 s40, s40, 10
s_lshl_b32 s41, s41, 10
s_lshl_b32 s42, s38, 3
s_add_u32 s41, s41, s42
s_mul_i32 s42, s36, 20480
s_add_u32 s40, s40, s42
s_add_u32 s41, s41, s42
s_add_u32 s43, s40, 26214400
s_add_u32 s44, s41, 26214400
s_and_b32 s52, s88, 3
s_and_b32 s53, s89, 1
s_lshl_b32 s53, s53, 2
s_add_u32 s53, s53, s52
s_lshr_b32 s54, s89, 1
s_waitcnt vmcnt(24)
v_mfma_f32_16x16x32_bf16 v[16:19], a[0:3], v[120:123], 0
v_mfma_f32_16x16x32_bf16 v[20:23], a[4:7], v[120:123], 0
s_add_u32 s45, s32, 65536
buffer_load_dwordx4 v[100:103], v2, s[8:11], s45 offen offset:1024
v_mfma_f32_16x16x32_bf16 v[24:27], a[8:11], v[120:123], 0
v_mfma_f32_16x16x32_bf16 v[28:31], a[12:15], v[120:123], 0
v_mfma_f32_16x16x32_bf16 v[32:35], a[16:19], v[120:123], 0
v_mfma_f32_16x16x32_bf16 v[36:39], a[0:3], v[124:127], 0
buffer_load_dwordx4 v[104:107], v2, s[8:11], s45 offen offset:2048
v_mfma_f32_16x16x32_bf16 v[40:43], a[4:7], v[124:127], 0
v_mfma_f32_16x16x32_bf16 v[44:47], a[8:11], v[124:127], 0
v_mfma_f32_16x16x32_bf16 v[48:51], a[12:15], v[124:127], 0
v_mfma_f32_16x16x32_bf16 v[52:55], a[16:19], v[124:127], 0
buffer_load_dwordx4 v[108:111], v2, s[8:11], s45 offen offset:3072
v_mfma_f32_16x16x32_bf16 v[56:59], a[0:3], v[128:131], 0
v_mfma_f32_16x16x32_bf16 v[60:63], a[4:7], v[128:131], 0
v_mfma_f32_16x16x32_bf16 v[64:67], a[8:11], v[128:131], 0
v_mfma_f32_16x16x32_bf16 v[68:71], a[12:15], v[128:131], 0
s_add_u32 s45, s32, 69632
buffer_load_dwordx4 v[112:115], v2, s[8:11], s45 offen offset:0
v_mfma_f32_16x16x32_bf16 v[72:75], a[16:19], v[128:131], 0
v_mfma_f32_16x16x32_bf16 v[76:79], a[0:3], v[132:135], 0
v_mfma_f32_16x16x32_bf16 v[80:83], a[4:7], v[132:135], 0
v_mfma_f32_16x16x32_bf16 v[84:87], a[8:11], v[132:135], 0
buffer_load_dwordx4 v[116:119], v2, s[8:11], s45 offen offset:1024
v_mfma_f32_16x16x32_bf16 v[88:91], a[12:15], v[132:135], 0
v_mfma_f32_16x16x32_bf16 v[92:95], a[16:19], v[132:135], 0
s_waitcnt vmcnt(25)
v_mfma_f32_16x16x32_bf16 v[16:19], a[20:23], v[136:139], v[16:19]
v_mfma_f32_16x16x32_bf16 v[20:23], a[24:27], v[136:139], v[20:23]
buffer_load_dwordx4 v[120:123], v232, s[8:11], s37 offen offset:3072 sc1
v_mfma_f32_16x16x32_bf16 v[24:27], a[28:31], v[136:139], v[24:27]
v_mfma_f32_16x16x32_bf16 v[28:31], a[32:35], v[136:139], v[28:31]
v_mfma_f32_16x16x32_bf16 v[32:35], a[36:39], v[136:139], v[32:35]
v_mfma_f32_16x16x32_bf16 v[36:39], a[20:23], v[140:143], v[36:39]
v_mfma_f32_16x16x32_bf16 v[40:43], a[24:27], v[140:143], v[40:43]
buffer_load_dwordx4 v[124:127], v233, s[8:11], s37 offen offset:3072 sc1
v_mfma_f32_16x16x32_bf16 v[44:47], a[28:31], v[140:143], v[44:47]
v_mfma_f32_16x16x32_bf16 v[48:51], a[32:35], v[140:143], v[48:51]
v_mfma_f32_16x16x32_bf16 v[52:55], a[36:39], v[140:143], v[52:55]
v_mfma_f32_16x16x32_bf16 v[56:59], a[20:23], v[144:147], v[56:59]
v_mfma_f32_16x16x32_bf16 v[60:63], a[24:27], v[144:147], v[60:63]
buffer_load_dwordx4 v[128:131], v234, s[8:11], s37 offen offset:3072 sc1
v_mfma_f32_16x16x32_bf16 v[64:67], a[28:31], v[144:147], v[64:67]
v_mfma_f32_16x16x32_bf16 v[68:71], a[32:35], v[144:147], v[68:71]
v_mfma_f32_16x16x32_bf16 v[72:75], a[36:39], v[144:147], v[72:75]
v_mfma_f32_16x16x32_bf16 v[76:79], a[20:23], v[148:151], v[76:79]
v_mfma_f32_16x16x32_bf16 v[80:83], a[24:27], v[148:151], v[80:83]
buffer_load_dwordx4 v[132:135], v235, s[8:11], s37 offen offset:3072 sc1
v_mfma_f32_16x16x32_bf16 v[84:87], a[28:31], v[148:151], v[84:87]
v_mfma_f32_16x16x32_bf16 v[88:91], a[32:35], v[148:151], v[88:91]
v_mfma_f32_16x16x32_bf16 v[92:95], a[36:39], v[148:151], v[92:95]
s_waitcnt vmcnt(25)
v_mfma_f32_16x16x32_bf16 v[16:19], a[40:43], v[152:155], v[16:19]
v_mfma_f32_16x16x32_bf16 v[20:23], a[44:47], v[152:155], v[20:23]
s_add_u32 s37, s37, 4096
buffer_load_dwordx4 v[136:139], v232, s[8:11], s37 offen offset:0 sc1
v_mfma_f32_16x16x32_bf16 v[24:27], a[48:51], v[152:155], v[24:27]
v_mfma_f32_16x16x32_bf16 v[28:31], a[52:55], v[152:155], v[28:31]
v_mfma_f32_16x16x32_bf16 v[32:35], a[56:59], v[152:155], v[32:35]
v_mfma_f32_16x16x32_bf16 v[36:39], a[40:43], v[156:159], v[36:39]
v_mfma_f32_16x16x32_bf16 v[40:43], a[44:47], v[156:159], v[40:43]
buffer_load_dwordx4 v[140:143], v233, s[8:11], s37 offen offset:0 sc1
v_mfma_f32_16x16x32_bf16 v[44:47], a[48:51], v[156:159], v[44:47]
v_mfma_f32_16x16x32_bf16 v[48:51], a[52:55], v[156:159], v[48:51]
v_mfma_f32_16x16x32_bf16 v[52:55], a[56:59], v[156:159], v[52:55]
v_mfma_f32_16x16x32_bf16 v[56:59], a[40:43], v[160:163], v[56:59]
v_mfma_f32_16x16x32_bf16 v[60:63], a[44:47], v[160:163], v[60:63]
buffer_load_dwordx4 v[144:147], v234, s[8:11], s37 offen offset:0 sc1
v_mfma_f32_16x16x32_bf16 v[64:67], a[48:51], v[160:163], v[64:67]
v_mfma_f32_16x16x32_bf16 v[68:71], a[52:55], v[160:163], v[68:71]
v_mfma_f32_16x16x32_bf16 v[72:75], a[56:59], v[160:163], v[72:75]
v_mfma_f32_16x16x32_bf16 v[76:79], a[40:43], v[164:167], v[76:79]
v_mfma_f32_16x16x32_bf16 v[80:83], a[44:47], v[164:167], v[80:83]
buffer_load_dwordx4 v[148:151], v235, s[8:11], s37 offen offset:0 sc1
v_mfma_f32_16x16x32_bf16 v[84:87], a[48:51], v[164:167], v[84:87]
v_mfma_f32_16x16x32_bf16 v[88:91], a[52:55], v[164:167], v[88:91]
v_mfma_f32_16x16x32_bf16 v[92:95], a[56:59], v[164:167], v[92:95]
s_waitcnt vmcnt(25)
v_mfma_f32_16x16x32_bf16 v[16:19], a[60:63], v[168:171], v[16:19]
v_mfma_f32_16x16x32_bf16 v[20:23], a[64:67], v[168:171], v[20:23]
buffer_load_dwordx4 v[152:155], v232, s[8:11], s37 offen offset:1024 sc1
v_mfma_f32_16x16x32_bf16 v[24:27], a[68:71], v[168:171], v[24:27]
v_mfma_f32_16x16x32_bf16 v[28:31], a[72:75], v[168:171], v[28:31]
v_mfma_f32_16x16x32_bf16 v[32:35], a[76:79], v[168:171], v[32:35]
v_mfma_f32_16x16x32_bf16 v[36:39], a[60:63], v[172:175], v[36:39]
v_mfma_f32_16x16x32_bf16 v[40:43], a[64:67], v[172:175], v[40:43]
buffer_load_dwordx4 v[156:159], v233, s[8:11], s37 offen offset:1024 sc1
v_mfma_f32_16x16x32_bf16 v[44:47], a[68:71], v[172:175], v[44:47]
v_mfma_f32_16x16x32_bf16 v[48:51], a[72:75], v[172:175], v[48:51]
v_mfma_f32_16x16x32_bf16 v[52:55], a[76:79], v[172:175], v[52:55]
v_mfma_f32_16x16x32_bf16 v[56:59], a[60:63], v[176:179], v[56:59]
v_mfma_f32_16x16x32_bf16 v[60:63], a[64:67], v[176:179], v[60:63]
buffer_load_dwordx4 v[160:163], v234, s[8:11], s37 offen offset:1024 sc1
v_mfma_f32_16x16x32_bf16 v[64:67], a[68:71], v[176:179], v[64:67]
v_mfma_f32_16x16x32_bf16 v[68:71], a[72:75], v[176:179], v[68:71]
v_mfma_f32_16x16x32_bf16 v[72:75], a[76:79], v[176:179], v[72:75]
v_mfma_f32_16x16x32_bf16 v[76:79], a[60:63], v[180:183], v[76:79]
v_mfma_f32_16x16x32_bf16 v[80:83], a[64:67], v[180:183], v[80:83]
buffer_load_dwordx4 v[164:167], v235, s[8:11], s37 offen offset:1024 sc1
v_mfma_f32_16x16x32_bf16 v[84:87], a[68:71], v[180:183], v[84:87]
v_mfma_f32_16x16x32_bf16 v[88:91], a[72:75], v[180:183], v[88:91]
v_mfma_f32_16x16x32_bf16 v[92:95], a[76:79], v[180:183], v[92:95]
s_waitcnt vmcnt(25)
v_mfma_f32_16x16x32_bf16 v[16:19], a[80:83], v[184:187], v[16:19]
v_mfma_f32_16x16x32_bf16 v[20:23], a[84:87], v[184:187], v[20:23]
buffer_load_dwordx4 v[168:171], v232, s[8:11], s37 offen offset:2048 sc1
v_mfma_f32_16x16x32_bf16 v[24:27], a[88:91], v[184:187], v[24:27]
v_mfma_f32_16x16x32_bf16 v[28:31], a[92:95], v[184:187], v[28:31]
v_mfma_f32_16x16x32_bf16 v[32:35], a[96:99], v[184:187], v[32:35]
v_mfma_f32_16x16x32_bf16 v[36:39], a[80:83], v[188:191], v[36:39]
v_mfma_f32_16x16x32_bf16 v[40:43], a[84:87], v[188:191], v[40:43]
buffer_load_dwordx4 v[172:175], v233, s[8:11], s37 offen offset:2048 sc1
v_mfma_f32_16x16x32_bf16 v[44:47], a[88:91], v[188:191], v[44:47]
v_mfma_f32_16x16x32_bf16 v[48:51], a[92:95], v[188:191], v[48:51]
v_mfma_f32_16x16x32_bf16 v[52:55], a[96:99], v[188:191], v[52:55]
v_mfma_f32_16x16x32_bf16 v[56:59], a[80:83], v[192:195], v[56:59]
v_mfma_f32_16x16x32_bf16 v[60:63], a[84:87], v[192:195], v[60:63]
buffer_load_dwordx4 v[176:179], v234, s[8:11], s37 offen offset:2048 sc1
v_mfma_f32_16x16x32_bf16 v[64:67], a[88:91], v[192:195], v[64:67]
v_mfma_f32_16x16x32_bf16 v[68:71], a[92:95], v[192:195], v[68:71]
v_mfma_f32_16x16x32_bf16 v[72:75], a[96:99], v[192:195], v[72:75]
v_mfma_f32_16x16x32_bf16 v[76:79], a[80:83], v[196:199], v[76:79]
v_mfma_f32_16x16x32_bf16 v[80:83], a[84:87], v[196:199], v[80:83]
buffer_load_dwordx4 v[180:183], v235, s[8:11], s37 offen offset:2048 sc1
v_mfma_f32_16x16x32_bf16 v[84:87], a[88:91], v[196:199], v[84:87]
v_mfma_f32_16x16x32_bf16 v[88:91], a[92:95], v[196:199], v[88:91]
v_mfma_f32_16x16x32_bf16 v[92:95], a[96:99], v[196:199], v[92:95]
s_waitcnt vmcnt(25)
v_mfma_f32_16x16x32_bf16 v[16:19], a[100:103], v[200:203], v[16:19]
v_mfma_f32_16x16x32_bf16 v[20:23], a[104:107], v[200:203], v[20:23]
buffer_load_dwordx4 v[184:187], v232, s[8:11], s37 offen offset:3072 sc1
v_mfma_f32_16x16x32_bf16 v[24:27], a[108:111], v[200:203], v[24:27]
v_mfma_f32_16x16x32_bf16 v[28:31], a[112:115], v[200:203], v[28:31]
v_mfma_f32_16x16x32_bf16 v[32:35], a[116:119], v[200:203], v[32:35]
v_mfma_f32_16x16x32_bf16 v[36:39], a[100:103], v[204:207], v[36:39]
v_mfma_f32_16x16x32_bf16 v[40:43], a[104:107], v[204:207], v[40:43]
buffer_load_dwordx4 v[188:191], v233, s[8:11], s37 offen offset:3072 sc1
v_mfma_f32_16x16x32_bf16 v[44:47], a[108:111], v[204:207], v[44:47]
v_mfma_f32_16x16x32_bf16 v[48:51], a[112:115], v[204:207], v[48:51]
v_mfma_f32_16x16x32_bf16 v[52:55], a[116:119], v[204:207], v[52:55]
v_mfma_f32_16x16x32_bf16 v[56:59], a[100:103], v[208:211], v[56:59]
v_mfma_f32_16x16x32_bf16 v[60:63], a[104:107], v[208:211], v[60:63]
buffer_load_dwordx4 v[192:195], v234, s[8:11], s37 offen offset:3072 sc1
v_mfma_f32_16x16x32_bf16 v[64:67], a[108:111], v[208:211], v[64:67]
v_mfma_f32_16x16x32_bf16 v[68:71], a[112:115], v[208:211], v[68:71]
v_mfma_f32_16x16x32_bf16 v[72:75], a[116:119], v[208:211], v[72:75]
v_mfma_f32_16x16x32_bf16 v[76:79], a[100:103], v[212:215], v[76:79]
v_mfma_f32_16x16x32_bf16 v[80:83], a[104:107], v[212:215], v[80:83]
buffer_load_dwordx4 v[196:199], v235, s[8:11], s37 offen offset:3072 sc1
v_mfma_f32_16x16x32_bf16 v[84:87], a[108:111], v[212:215], v[84:87]
v_mfma_f32_16x16x32_bf16 v[88:91], a[112:115], v[212:215], v[88:91]
v_mfma_f32_16x16x32_bf16 v[92:95], a[116:119], v[212:215], v[92:95]
s_waitcnt vmcnt(25)
v_mfma_f32_16x16x32_bf16 v[16:19], a[120:123], v[216:219], v[16:19]
v_mfma_f32_16x16x32_bf16 v[20:23], a[124:127], v[216:219], v[20:23]
s_add_u32 s37, s37, 4096
buffer_load_dwordx4 v[200:203], v232, s[8:11], s37 offen offset:0 sc1
v_mfma_f32_16x16x32_bf16 v[24:27], a[128:131], v[216:219], v[24:27]
v_mfma_f32_16x16x32_bf16 v[28:31], a[132:135], v[216:219], v[28:31]
v_mfma_f32_16x16x32_bf16 v[32:35], a[136:139], v[216:219], v[32:35]
v_mfma_f32_16x16x32_bf16 v[36:39], a[120:123], v[220:223], v[36:39]
v_mfma_f32_16x16x32_bf16 v[40:43], a[124:127], v[220:223], v[40:43]
buffer_load_dwordx4 v[204:207], v233, s[8:11], s37 offen offset:0 sc1
v_mfma_f32_16x16x32_bf16 v[44:47], a[128:131], v[220:223], v[44:47]
v_mfma_f32_16x16x32_bf16 v[48:51], a[132:135], v[220:223], v[48:51]
v_mfma_f32_16x16x32_bf16 v[52:55], a[136:139], v[220:223], v[52:55]
v_mfma_f32_16x16x32_bf16 v[56:59], a[120:123], v[224:227], v[56:59]
v_mfma_f32_16x16x32_bf16 v[60:63], a[124:127], v[224:227], v[60:63]
buffer_load_dwordx4 v[208:211], v234, s[8:11], s37 offen offset:0 sc1
v_mfma_f32_16x16x32_bf16 v[64:67], a[128:131], v[224:227], v[64:67]
v_mfma_f32_16x16x32_bf16 v[68:71], a[132:135], v[224:227], v[68:71]
v_mfma_f32_16x16x32_bf16 v[72:75], a[136:139], v[224:227], v[72:75]
v_mfma_f32_16x16x32_bf16 v[76:79], a[120:123], v[228:231], v[76:79]
v_mfma_f32_16x16x32_bf16 v[80:83], a[124:127], v[228:231], v[80:83]
buffer_load_dwordx4 v[212:215], v235, s[8:11], s37 offen offset:0 sc1
v_mfma_f32_16x16x32_bf16 v[84:87], a[128:131], v[228:231], v[84:87]
v_mfma_f32_16x16x32_bf16 v[88:91], a[132:135], v[228:231], v[88:91]
v_mfma_f32_16x16x32_bf16 v[92:95], a[136:139], v[228:231], v[92:95]
s_waitcnt vmcnt(20)
v_mfma_f32_16x16x32_bf16 v[16:19], a[140:143], v[120:123], v[16:19]
v_mfma_f32_16x16x32_bf16 v[20:23], a[144:147], v[120:123], v[20:23]
buffer_load_dwordx4 v[216:219], v232, s[8:11], s37 offen offset:1024 sc1
v_mfma_f32_16x16x32_bf16 v[24:27], a[148:151], v[120:123], v[24:27]
v_mfma_f32_16x16x32_bf16 v[28:31], a[152:155], v[120:123], v[28:31]
v_mfma_f32_16x16x32_bf16 v[32:35], a[156:159], v[120:123], v[32:35]
v_mfma_f32_16x16x32_bf16 v[36:39], a[140:143], v[124:127], v[36:39]
v_mfma_f32_16x16x32_bf16 v[40:43], a[144:147], v[124:127], v[40:43]
buffer_load_dwordx4 v[220:223], v233, s[8:11], s37 offen offset:1024 sc1
v_mfma_f32_16x16x32_bf16 v[44:47], a[148:151], v[124:127], v[44:47]
v_mfma_f32_16x16x32_bf16 v[48:51], a[152:155], v[124:127], v[48:51]
v_mfma_f32_16x16x32_bf16 v[52:55], a[156:159], v[124:127], v[52:55]
v_mfma_f32_16x16x32_bf16 v[56:59], a[140:143], v[128:131], v[56:59]
v_mfma_f32_16x16x32_bf16 v[60:63], a[144:147], v[128:131], v[60:63]
buffer_load_dwordx4 v[224:227], v234, s[8:11], s37 offen offset:1024 sc1
v_mfma_f32_16x16x32_bf16 v[64:67], a[148:151], v[128:131], v[64:67]
v_mfma_f32_16x16x32_bf16 v[68:71], a[152:155], v[128:131], v[68:71]
v_mfma_f32_16x16x32_bf16 v[72:75], a[156:159], v[128:131], v[72:75]
v_mfma_f32_16x16x32_bf16 v[76:79], a[140:143], v[132:135], v[76:79]
v_mfma_f32_16x16x32_bf16 v[80:83], a[144:147], v[132:135], v[80:83]
buffer_load_dwordx4 v[228:231], v235, s[8:11], s37 offen offset:1024 sc1
v_mfma_f32_16x16x32_bf16 v[84:87], a[148:151], v[132:135], v[84:87]
v_mfma_f32_16x16x32_bf16 v[88:91], a[152:155], v[132:135], v[88:91]
v_mfma_f32_16x16x32_bf16 v[92:95], a[156:159], v[132:135], v[92:95]
s_waitcnt vmcnt(20)
v_mfma_f32_16x16x32_bf16 v[16:19], a[160:163], v[136:139], v[16:19]
v_mfma_f32_16x16x32_bf16 v[20:23], a[164:167], v[136:139], v[20:23]
buffer_load_dwordx4 v[240:243], v2, s[8:11], s43 offen sc1
v_mfma_f32_16x16x32_bf16 v[24:27], a[168:171], v[136:139], v[24:27]
v_mfma_f32_16x16x32_bf16 v[28:31], a[172:175], v[136:139], v[28:31]
v_mfma_f32_16x16x32_bf16 v[32:35], a[176:179], v[136:139], v[32:35]
v_mfma_f32_16x16x32_bf16 v[36:39], a[160:163], v[140:143], v[36:39]
v_mfma_f32_16x16x32_bf16 v[40:43], a[164:167], v[140:143], v[40:43]
v_mfma_f32_16x16x32_bf16 v[44:47], a[168:171], v[140:143], v[44:47]
buffer_load_dwordx4 v[244:247], v2, s[8:11], s43 offen offset:1024 sc1
v_mfma_f32_16x16x32_bf16 v[48:51], a[172:175], v[140:143], v[48:51]
v_mfma_f32_16x16x32_bf16 v[52:55], a[176:179], v[140:143], v[52:55]
v_mfma_f32_16x16x32_bf16 v[56:59], a[160:163], v[144:147], v[56:59]
v_mfma_f32_16x16x32_bf16 v[60:63], a[164:167], v[144:147], v[60:63]
v_mfma_f32_16x16x32_bf16 v[64:67], a[168:171], v[144:147], v[64:67]
v_mfma_f32_16x16x32_bf16 v[68:71], a[172:175], v[144:147], v[68:71]
v_mfma_f32_16x16x32_bf16 v[72:75], a[176:179], v[144:147], v[72:75]
buffer_load_dwordx2 v[248:249], v2, s[8:11], s44 offen sc1
v_mfma_f32_16x16x32_bf16 v[76:79], a[160:163], v[148:151], v[76:79]
v_mfma_f32_16x16x32_bf16 v[80:83], a[164:167], v[148:151], v[80:83]
v_mfma_f32_16x16x32_bf16 v[84:87], a[168:171], v[148:151], v[84:87]
v_mfma_f32_16x16x32_bf16 v[88:91], a[172:175], v[148:151], v[88:91]
v_mfma_f32_16x16x32_bf16 v[92:95], a[176:179], v[148:151], v[92:95]
s_waitcnt vmcnt(19)
v_mfma_f32_16x16x32_bf16 v[16:19], a[180:183], v[152:155], v[16:19]
v_mfma_f32_16x16x32_bf16 v[20:23], a[184:187], v[152:155], v[20:23]
v_mfma_f32_16x16x32_bf16 v[24:27], a[188:191], v[152:155], v[24:27]
v_mfma_f32_16x16x32_bf16 v[28:31], a[192:195], v[152:155], v[28:31]
v_mfma_f32_16x16x32_bf16 v[32:35], a[196:199], v[152:155], v[32:35]
v_mfma_f32_16x16x32_bf16 v[36:39], a[180:183], v[156:159], v[36:39]
v_mfma_f32_16x16x32_bf16 v[40:43], a[184:187], v[156:159], v[40:43]
v_mfma_f32_16x16x32_bf16 v[44:47], a[188:191], v[156:159], v[44:47]
v_mfma_f32_16x16x32_bf16 v[48:51], a[192:195], v[156:159], v[48:51]
v_mfma_f32_16x16x32_bf16 v[52:55], a[196:199], v[156:159], v[52:55]
v_mfma_f32_16x16x32_bf16 v[56:59], a[180:183], v[160:163], v[56:59]
v_mfma_f32_16x16x32_bf16 v[60:63], a[184:187], v[160:163], v[60:63]
v_mfma_f32_16x16x32_bf16 v[64:67], a[188:191], v[160:163], v[64:67]
v_mfma_f32_16x16x32_bf16 v[68:71], a[192:195], v[160:163], v[68:71]
v_mfma_f32_16x16x32_bf16 v[72:75], a[196:199], v[160:163], v[72:75]
v_mfma_f32_16x16x32_bf16 v[76:79], a[180:183], v[164:167], v[76:79]
v_mfma_f32_16x16x32_bf16 v[80:83], a[184:187], v[164:167], v[80:83]
v_mfma_f32_16x16x32_bf16 v[84:87], a[188:191], v[164:167], v[84:87]
v_mfma_f32_16x16x32_bf16 v[88:91], a[192:195], v[164:167], v[88:91]
v_mfma_f32_16x16x32_bf16 v[92:95], a[196:199], v[164:167], v[92:95]
s_waitcnt vmcnt(15)
v_mfma_f32_16x16x32_bf16 v[16:19], a[200:203], v[168:171], v[16:19]
v_mfma_f32_16x16x32_bf16 v[20:23], a[204:207], v[168:171], v[20:23]
v_mfma_f32_16x16x32_bf16 v[24:27], a[208:211], v[168:171], v[24:27]
v_mfma_f32_16x16x32_bf16 v[28:31], a[212:215], v[168:171], v[28:31]
v_mfma_f32_16x16x32_bf16 v[32:35], a[216:219], v[168:171], v[32:35]
v_mfma_f32_16x16x32_bf16 v[36:39], a[200:203], v[172:175], v[36:39]
v_mfma_f32_16x16x32_bf16 v[40:43], a[204:207], v[172:175], v[40:43]
v_mfma_f32_16x16x32_bf16 v[44:47], a[208:211], v[172:175], v[44:47]
v_mfma_f32_16x16x32_bf16 v[48:51], a[212:215], v[172:175], v[48:51]
v_mfma_f32_16x16x32_bf16 v[52:55], a[216:219], v[172:175], v[52:55]
v_mfma_f32_16x16x32_bf16 v[56:59], a[200:203], v[176:179], v[56:59]
v_mfma_f32_16x16x32_bf16 v[60:63], a[204:207], v[176:179], v[60:63]
v_mfma_f32_16x16x32_bf16 v[64:67], a[208:211], v[176:179], v[64:67]
v_mfma_f32_16x16x32_bf16 v[68:71], a[212:215], v[176:179], v[68:71]
v_mfma_f32_16x16x32_bf16 v[72:75], a[216:219], v[176:179], v[72:75]
v_mfma_f32_16x16x32_bf16 v[76:79], a[200:203], v[180:183], v[76:79]
v_mfma_f32_16x16x32_bf16 v[80:83], a[204:207], v[180:183], v[80:83]
v_mfma_f32_16x16x32_bf16 v[84:87], a[208:211], v[180:183], v[84:87]
v_mfma_f32_16x16x32_bf16 v[88:91], a[212:215], v[180:183], v[88:91]
v_mfma_f32_16x16x32_bf16 v[92:95], a[216:219], v[180:183], v[92:95]
s_waitcnt vmcnt(11)
v_mfma_f32_16x16x32_bf16 v[16:19], a[220:223], v[184:187], v[16:19]
v_mfma_f32_16x16x32_bf16 v[20:23], a[224:227], v[184:187], v[20:23]
v_mfma_f32_16x16x32_bf16 v[24:27], a[228:231], v[184:187], v[24:27]
v_mfma_f32_16x16x32_bf16 v[28:31], a[232:235], v[184:187], v[28:31]
v_mfma_f32_16x16x32_bf16 v[32:35], a[236:239], v[184:187], v[32:35]
v_mfma_f32_16x16x32_bf16 v[36:39], a[220:223], v[188:191], v[36:39]
v_mfma_f32_16x16x32_bf16 v[40:43], a[224:227], v[188:191], v[40:43]
v_mfma_f32_16x16x32_bf16 v[44:47], a[228:231], v[188:191], v[44:47]
v_mfma_f32_16x16x32_bf16 v[48:51], a[232:235], v[188:191], v[48:51]
v_mfma_f32_16x16x32_bf16 v[52:55], a[236:239], v[188:191], v[52:55]
v_mfma_f32_16x16x32_bf16 v[56:59], a[220:223], v[192:195], v[56:59]
v_mfma_f32_16x16x32_bf16 v[60:63], a[224:227], v[192:195], v[60:63]
v_mfma_f32_16x16x32_bf16 v[64:67], a[228:231], v[192:195], v[64:67]
v_mfma_f32_16x16x32_bf16 v[68:71], a[232:235], v[192:195], v[68:71]
v_mfma_f32_16x16x32_bf16 v[72:75], a[236:239], v[192:195], v[72:75]
v_mfma_f32_16x16x32_bf16 v[76:79], a[220:223], v[196:199], v[76:79]
v_mfma_f32_16x16x32_bf16 v[80:83], a[224:227], v[196:199], v[80:83]
v_mfma_f32_16x16x32_bf16 v[84:87], a[228:231], v[196:199], v[84:87]
v_mfma_f32_16x16x32_bf16 v[88:91], a[232:235], v[196:199], v[88:91]
v_mfma_f32_16x16x32_bf16 v[92:95], a[236:239], v[196:199], v[92:95]
s_waitcnt vmcnt(7)
v_mfma_f32_16x16x32_bf16 v[16:19], a[240:243], v[200:203], v[16:19]
v_mfma_f32_16x16x32_bf16 v[20:23], a[244:247], v[200:203], v[20:23]
v_mfma_f32_16x16x32_bf16 v[24:27], a[248:251], v[200:203], v[24:27]
v_mfma_f32_16x16x32_bf16 v[28:31], a[252:255], v[200:203], v[28:31]
v_mfma_f32_16x16x32_bf16 v[32:35], v[96:99], v[200:203], v[32:35]
v_mfma_f32_16x16x32_bf16 v[36:39], a[240:243], v[204:207], v[36:39]
v_mfma_f32_16x16x32_bf16 v[40:43], a[244:247], v[204:207], v[40:43]
v_mfma_f32_16x16x32_bf16 v[44:47], a[248:251], v[204:207], v[44:47]
v_mfma_f32_16x16x32_bf16 v[48:51], a[252:255], v[204:207], v[48:51]
v_mfma_f32_16x16x32_bf16 v[52:55], v[96:99], v[204:207], v[52:55]
v_mfma_f32_16x16x32_bf16 v[56:59], a[240:243], v[208:211], v[56:59]
v_mfma_f32_16x16x32_bf16 v[60:63], a[244:247], v[208:211], v[60:63]
v_mfma_f32_16x16x32_bf16 v[64:67], a[248:251], v[208:211], v[64:67]
v_mfma_f32_16x16x32_bf16 v[68:71], a[252:255], v[208:211], v[68:71]
v_mfma_f32_16x16x32_bf16 v[72:75], v[96:99], v[208:211], v[72:75]
v_mfma_f32_16x16x32_bf16 v[76:79], a[240:243], v[212:215], v[76:79]
v_mfma_f32_16x16x32_bf16 v[80:83], a[244:247], v[212:215], v[80:83]
v_mfma_f32_16x16x32_bf16 v[84:87], a[248:251], v[212:215], v[84:87]
v_mfma_f32_16x16x32_bf16 v[88:91], a[252:255], v[212:215], v[88:91]
v_mfma_f32_16x16x32_bf16 v[92:95], v[96:99], v[212:215], v[92:95]
s_waitcnt vmcnt(3)
v_mfma_f32_16x16x32_bf16 v[16:19], v[100:103], v[216:219], v[16:19]
v_mfma_f32_16x16x32_bf16 v[20:23], v[104:107], v[216:219], v[20:23]
v_mfma_f32_16x16x32_bf16 v[24:27], v[108:111], v[216:219], v[24:27]
v_mfma_f32_16x16x32_bf16 v[28:31], v[112:115], v[216:219], v[28:31]
v_mfma_f32_16x16x32_bf16 v[32:35], v[116:119], v[216:219], v[32:35]
v_mfma_f32_16x16x32_bf16 v[36:39], v[100:103], v[220:223], v[36:39]
v_mfma_f32_16x16x32_bf16 v[40:43], v[104:107], v[220:223], v[40:43]
v_mfma_f32_16x16x32_bf16 v[44:47], v[108:111], v[220:223], v[44:47]
v_mfma_f32_16x16x32_bf16 v[48:51], v[112:115], v[220:223], v[48:51]
v_mfma_f32_16x16x32_bf16 v[52:55], v[116:119], v[220:223], v[52:55]
v_mfma_f32_16x16x32_bf16 v[56:59], v[100:103], v[224:227], v[56:59]
v_mfma_f32_16x16x32_bf16 v[60:63], v[104:107], v[224:227], v[60:63]
v_mfma_f32_16x16x32_bf16 v[64:67], v[108:111], v[224:227], v[64:67]
v_mfma_f32_16x16x32_bf16 v[68:71], v[112:115], v[224:227], v[68:71]
v_mfma_f32_16x16x32_bf16 v[72:75], v[116:119], v[224:227], v[72:75]
v_mfma_f32_16x16x32_bf16 v[76:79], v[100:103], v[228:231], v[76:79]
v_mfma_f32_16x16x32_bf16 v[80:83], v[104:107], v[228:231], v[80:83]
v_mfma_f32_16x16x32_bf16 v[84:87], v[108:111], v[228:231], v[84:87]
v_mfma_f32_16x16x32_bf16 v[88:91], v[112:115], v[228:231], v[88:91]
v_mfma_f32_16x16x32_bf16 v[92:95], v[116:119], v[228:231], v[92:95]
s_nop 7
s_add_u32 s35, s6, 1
s_and_b32 s35, s35, 3
s_mul_i32 s35, s35, 15360
s_add_u32 s35, s35, 0
v_add_u32 v233, s35, v2
ds_write_b128 v233, v[36:39] offset:0
ds_write_b128 v233, v[40:43] offset:1024
ds_write_b128 v233, v[44:47] offset:2048
ds_write_b128 v233, v[48:51] offset:3072
ds_write_b128 v233, v[52:55] offset:4096
s_add_u32 s35, s6, 2
s_and_b32 s35, s35, 3
s_mul_i32 s35, s35, 15360
s_add_u32 s35, s35, 5120
v_add_u32 v234, s35, v2
ds_write_b128 v234, v[56:59] offset:0
ds_write_b128 v234, v[60:63] offset:1024
ds_write_b128 v234, v[64:67] offset:2048
ds_write_b128 v234, v[68:71] offset:3072
ds_write_b128 v234, v[72:75] offset:4096
s_add_u32 s35, s6, 3
s_and_b32 s35, s35, 3
s_mul_i32 s35, s35, 15360
s_add_u32 s35, s35, 10240
v_add_u32 v235, s35, v2
ds_write_b128 v235, v[76:79] offset:0
ds_write_b128 v235, v[80:83] offset:1024
ds_write_b128 v235, v[84:87] offset:2048
ds_write_b128 v235, v[88:91] offset:3072
ds_write_b128 v235, v[92:95] offset:4096
s_waitcnt lgkmcnt(0)
s_barrier
s_mul_i32 s35, s6, 15360
v_add_u32 v232, s35, v2
ds_read_b128 v[120:123], v232 offset:0
ds_read_b128 v[124:127], v232 offset:1024
ds_read_b128 v[128:131], v232 offset:2048
ds_read_b128 v[132:135], v232 offset:3072
ds_read_b128 v[136:139], v232 offset:4096
ds_read_b128 v[140:143], v232 offset:5120
ds_read_b128 v[144:147], v232 offset:6144
ds_read_b128 v[148:151], v232 offset:7168
ds_read_b128 v[152:155], v232 offset:8192
ds_read_b128 v[156:159], v232 offset:9216
ds_read_b128 v[160:163], v232 offset:10240
ds_read_b128 v[164:167], v232 offset:11264
ds_read_b128 v[168:171], v232 offset:12288
ds_read_b128 v[172:175], v232 offset:13312
ds_read_b128 v[176:179], v232 offset:14336
s_waitcnt lgkmcnt(10)
v_pk_add_f32 v[16:17], v[16:17], v[120:121]
v_pk_add_f32 v[18:19], v[18:19], v[122:123]
v_pk_add_f32 v[20:21], v[20:21], v[124:125]
v_pk_add_f32 v[22:23], v[22:23], v[126:127]
v_pk_add_f32 v[24:25], v[24:25], v[128:129]
v_pk_add_f32 v[26:27], v[26:27], v[130:131]
v_pk_add_f32 v[28:29], v[28:29], v[132:133]
v_pk_add_f32 v[30:31], v[30:31], v[134:135]
v_pk_add_f32 v[32:33], v[32:33], v[136:137]
v_pk_add_f32 v[34:35], v[34:35], v[138:139]
s_waitcnt lgkmcnt(5)
v_pk_add_f32 v[16:17], v[16:17], v[140:141]
v_pk_add_f32 v[18:19], v[18:19], v[142:143]
v_pk_add_f32 v[20:21], v[20:21], v[144:145]
v_pk_add_f32 v[22:23], v[22:23], v[146:147]
v_pk_add_f32 v[24:25], v[24:25], v[148:149]
v_pk_add_f32 v[26:27], v[26:27], v[150:151]
v_pk_add_f32 v[28:29], v[28:29], v[152:153]
v_pk_add_f32 v[30:31], v[30:31], v[154:155]
v_pk_add_f32 v[32:33], v[32:33], v[156:157]
v_pk_add_f32 v[34:35], v[34:35], v[158:159]
s_waitcnt vmcnt(0) lgkmcnt(0)
v_pk_add_f32 v[16:17], v[16:17], v[160:161]
v_pk_add_f32 v[18:19], v[18:19], v[162:163]
v_pk_add_f32 v[20:21], v[20:21], v[164:165]
v_pk_add_f32 v[22:23], v[22:23], v[166:167]
v_pk_add_f32 v[24:25], v[24:25], v[168:169]
v_pk_add_f32 v[26:27], v[26:27], v[170:171]
v_pk_add_f32 v[28:29], v[28:29], v[172:173]
v_pk_add_f32 v[30:31], v[30:31], v[174:175]
v_pk_add_f32 v[32:33], v[32:33], v[176:177]
v_pk_add_f32 v[34:35], v[34:35], v[178:179]
v_lshlrev_b32 v120, 16, v240
v_and_b32 v121, 0xffff0000, v240
v_add_f32 v16, v16, v120
v_add_f32 v17, v17, v121
v_cvt_pk_bf16_f32 v240, v16, v17
v_lshlrev_b32 v120, 16, v241
v_and_b32 v121, 0xffff0000, v241
v_add_f32 v18, v18, v120
v_add_f32 v19, v19, v121
v_cvt_pk_bf16_f32 v241, v18, v19
v_lshlrev_b32 v120, 16, v242
v_and_b32 v121, 0xffff0000, v242
v_add_f32 v20, v20, v120
v_add_f32 v21, v21, v121
v_cvt_pk_bf16_f32 v242, v20, v21
v_lshlrev_b32 v120, 16, v243
v_and_b32 v121, 0xffff0000, v243
v_add_f32 v22, v22, v120
v_add_f32 v23, v23, v121
v_cvt_pk_bf16_f32 v243, v22, v23
v_lshlrev_b32 v120, 16, v244
v_and_b32 v121, 0xffff0000, v244
v_add_f32 v24, v24, v120
v_add_f32 v25, v25, v121
v_cvt_pk_bf16_f32 v244, v24, v25
v_lshlrev_b32 v120, 16, v245
v_and_b32 v121, 0xffff0000, v245
v_add_f32 v26, v26, v120
v_add_f32 v27, v27, v121
v_cvt_pk_bf16_f32 v245, v26, v27
v_lshlrev_b32 v120, 16, v246
v_and_b32 v121, 0xffff0000, v246
v_add_f32 v28, v28, v120
v_add_f32 v29, v29, v121
v_cvt_pk_bf16_f32 v246, v28, v29
v_lshlrev_b32 v120, 16, v247
v_and_b32 v121, 0xffff0000, v247
v_add_f32 v30, v30, v120
v_add_f32 v31, v31, v121
v_cvt_pk_bf16_f32 v247, v30, v31
v_lshlrev_b32 v120, 16, v248
v_and_b32 v121, 0xffff0000, v248
v_add_f32 v32, v32, v120
v_add_f32 v33, v33, v121
v_cvt_pk_bf16_f32 v248, v32, v33
v_lshlrev_b32 v120, 16, v249
v_and_b32 v121, 0xffff0000, v249
v_add_f32 v34, v34, v120
v_add_f32 v35, v35, v121
v_cvt_pk_bf16_f32 v249, v34, v35
s_lshl_b32 s35, s36, 4
v_add_u32 v8, s35, v3
v_mul_u32_u24 v8, 1280, v8
v_lshlrev_b32 v9, 3, v4
v_add_u32 v8, v8, v9
s_add_u32 s35, s39, s38
s_lshl_b32 s35, s35, 5
s_xor_b32 s42, s38, 1
s_lshl_b32 s42, s42, 2
s_add_u32 s42, s42, s39
s_lshl_b32 s42, s42, 5
s_mov_b32 s12, s84
s_mov_b32 s13, s85
s_mov_b32 s14, 2621440
s_mov_b32 s15, 0x20000
buffer_store_dwordx2 v[240:241], v8, s[12:15], s35 offen offset:0
buffer_store_dwordx2 v[242:243], v8, s[12:15], s35 offen offset:32
buffer_store_dwordx2 v[244:245], v8, s[12:15], s35 offen offset:64
buffer_store_dwordx2 v[246:247], v8, s[12:15], s35 offen offset:96
buffer_store_dwordx2 v[248:249], v8, s[12:15], s42 offen
s_waitcnt vmcnt(0)
L_end:
s_endpgm
.section .rodata,"a"
.p2align 6
.amdhsa_kernel interleave_layers__sliding_local_dilated__dense_activation_relu__prompt_kernel
  .amdhsa_next_free_vgpr 512
  .amdhsa_next_free_sgpr 102
  .amdhsa_accum_offset 256
  .amdhsa_group_segment_fixed_size 0
  .amdhsa_kernarg_size 72
  .amdhsa_user_sgpr_count 2
  .amdhsa_user_sgpr_kernarg_segment_ptr 1
  .amdhsa_system_sgpr_workgroup_id_x 1
.end_amdhsa_kernel
```
